```python
import torch

def _softmax(x, axis=-1):
    return torch.softmax(x, dim=axis)
def _gelu(x):
    return torch.nn.functional.gelu(x, approximate="tanh")
def _silu(x):
    return torch.nn.functional.silu(x)
def _sigmoid(x):
    return torch.sigmoid(x)
def _layernorm(x, axis=-1, eps=1e-5):
    m = x.mean(dim=axis, keepdim=True)
    v = x.var(dim=axis, keepdim=True, unbiased=False)
    return (x - m) / torch.sqrt(v + eps)
def _scatter_add(tgt, idx, src, axis=0):
    return tgt.clone().index_add_(axis, idx, src)
def _segment_sum(src, seg, n):
    out = torch.zeros((n,) + src.shape[1:], dtype=src.dtype)
    return out.index_add_(0, seg, src)
def _pad(x, pw):
    flat = tuple(v for pair in reversed(pw) for v in pair)
    return torch.nn.functional.pad(x, flat)

kernel_name = 'concat_heads__gqa_block_cached__gqa_block_cached__near_ridge'

def setup_inputs():

    _w = (lambda a: (lambda t: t.to(torch.bfloat16) if t.is_floating_point() else t)(torch.as_tensor(a)))
    def _A_setup():
        B, Sq, D = 8, 112, 448
        Hq, Hkv, Sk, Dh = 16, 8, 2048, 256
        assert Hq % Hkv == 0, (Hq, Hkv)
        return {
            "x": _w((lambda *s: torch.randn(*s, dtype=torch.bfloat16) * 0.8)(B, Sq, D)),
            "k_cache": _w((lambda *s: torch.randn(*s, dtype=torch.bfloat16) * 0.8)(B, Hkv, Sk, Dh)),
            "v_cache": _w((lambda *s: torch.randn(*s, dtype=torch.bfloat16) * 0.05)(B, Hkv, Sk, Dh)),
            "wq": _w((lambda *s: torch.randn(*s, dtype=torch.bfloat16) * 0.8)(D, Hq * Dh) * (D ** -0.5)),
            "wo": _w((lambda *s: torch.randn(*s, dtype=torch.bfloat16) * 0.05)(Hq * Dh, D) * ((Hq * Dh) ** -0.5)),
        }
    _A_in = _A_setup()

    def _B_setup():
        B, Sq, D = 8, 112, 448
        Hq, Hkv, Sk, Dh = 16, 8, 2048, 256
        assert Hq % Hkv == 0, (Hq, Hkv)
        return {
            "x": _w((lambda *s: torch.randn(*s, dtype=torch.bfloat16) * 0.8)(B, Sq, D)),
            "k_cache": _w((lambda *s: torch.randn(*s, dtype=torch.bfloat16) * 0.8)(B, Hkv, Sk, Dh)),
            "v_cache": _w((lambda *s: torch.randn(*s, dtype=torch.bfloat16) * 0.05)(B, Hkv, Sk, Dh)),
            "wq": _w((lambda *s: torch.randn(*s, dtype=torch.bfloat16) * 0.8)(D, Hq * Dh) * (D ** -0.5)),
            "wo": _w((lambda *s: torch.randn(*s, dtype=torch.bfloat16) * 0.05)(Hq * Dh, D) * ((Hq * Dh) ** -0.5)),
        }
    _B_in = _B_setup()

    return {
        "A_x": _A_in["x"],
        "A_k_cache": _A_in["k_cache"],
        "A_v_cache": _A_in["v_cache"],
        "A_wq": _A_in["wq"],
        "A_wo": _A_in["wo"],
        "B_x": _B_in["x"],
        "B_k_cache": _B_in["k_cache"],
        "B_v_cache": _B_in["v_cache"],
        "B_wq": _B_in["wq"],
        "B_wo": _B_in["wo"],
    }

def reference(A_x, A_k_cache, A_v_cache, A_wq, A_wo, B_x, B_k_cache, B_v_cache, B_wq, B_wo):
    def _A_ref(x, k_cache, v_cache, wq, wo):
        B, Sq, D = x.shape
        Hq, Dh = 16, 256
        Hkv = k_cache.shape[1]
        rep = Hq // Hkv
        q = (lambda x, *d: x.permute(*d))((x @ wq).reshape(B, Sq, Hq, Dh), 0, 2, 1, 3)
        k = (lambda x, n, axis: torch.repeat_interleave(x, n, dim=axis))(k_cache, rep, axis=1)
        v = (lambda x, n, axis: torch.repeat_interleave(x, n, dim=axis))(v_cache, rep, axis=1)
        scores = torch.einsum("bhqd,bhkd->bhqk", q, k) * (Dh ** -0.5)
        p = _softmax(scores, axis=-1)
        o = torch.einsum("bhqk,bhkd->bhqd", p, v)
        return (lambda x, *d: x.permute(*d))(o, 0, 2, 1, 3).reshape(B, Sq, Hq * Dh) @ wo

    def _B_ref(x, k_cache, v_cache, wq, wo):
        B, Sq, D = x.shape
        Hq, Dh = 16, 256
        Hkv = k_cache.shape[1]
        rep = Hq // Hkv
        q = (lambda x, *d: x.permute(*d))((x @ wq).reshape(B, Sq, Hq, Dh), 0, 2, 1, 3)
        k = (lambda x, n, axis: torch.repeat_interleave(x, n, dim=axis))(k_cache, rep, axis=1)
        v = (lambda x, n, axis: torch.repeat_interleave(x, n, dim=axis))(v_cache, rep, axis=1)
        scores = torch.einsum("bhqd,bhkd->bhqk", q, k) * (Dh ** -0.5)
        p = _softmax(scores, axis=-1)
        o = torch.einsum("bhqk,bhkd->bhqd", p, v)
        return (lambda x, *d: x.permute(*d))(o, 0, 2, 1, 3).reshape(B, Sq, Hq * Dh) @ wo

    a = _A_ref(A_x, A_k_cache, A_v_cache, A_wq, A_wo)
    b = _B_ref(B_x, B_k_cache, B_v_cache, B_wq, B_wo)
    return torch.concatenate([a, b], axis=-1)
```

```asm
; @launch grid=(256,1,1) block=(256,1,1) lds=163840
.amdgcn_target "amdgcn-amd-amdhsa--gfx950"
.text
.globl concat_heads__gqa_block_cached__gqa_block_cached__near_ridge_kernel
.p2align 8
.type concat_heads__gqa_block_cached__gqa_block_cached__near_ridge_kernel,@function
concat_heads__gqa_block_cached__gqa_block_cached__near_ridge_kernel:
s_cmp_ge_u32 s2, 256
s_cbranch_scc1 L_end
s_load_dwordx8 s[68:75], s[0:1], 0
s_load_dwordx2 s[76:77], s[0:1], 32
s_load_dwordx8 s[80:87], s[0:1], 40
s_load_dwordx2 s[88:89], s[0:1], 72
s_load_dwordx2 s[28:29], s[0:1], 80
s_load_dwordx2 s[20:21], s[0:1], 96
s_mov_b32 s33, s2
s_and_b32 s34, s2, 7
s_bfe_u32 s51, s2, 0x10003
s_bfe_u32 s46, s2, 0x30004
s_lshr_b32 s47, s2, 7
s_bfe_u32 s48, s2, 0x40003
s_mul_i32 s48, s48, 7
s_bfe_u32 s62, s48, 0x10003
s_lshr_b32 s48, s48, 4
v_lshrrev_b32 v15, 6, v0
v_and_b32 v0, 63, v0
s_nop 0
v_readfirstlane_b32 s32, v15
s_lshl_b32 s49, s48, 19
s_lshl_b32 s48, s48, 7
s_lshl_b32 s63, s62, 18
s_add_u32 s49, s49, s63
s_lshl_b32 s63, s63, 1
v_bfe_u32 v15, v0, 1, 2
v_lshrrev_b32 v31, 4, v0
v_xor_b32 v15, v15, v31
v_lshlrev_b32 v15, 5, v15
v_and_b32 v3, 1, v0
v_lshl_add_u32 v3, v3, 4, v15
s_lshl_b32 s45, s32, 7
v_add_u32 v3, s45, v3
v_lshrrev_b32 v15, 5, v0
v_lshlrev_b32 v15, 3, v15
v_bfe_u32 v120, v0, 3, 2
v_add_u32 v120, v120, v15
v_lshl_add_u32 v120, v120, 13, v3
v_add_u32 v121, 131072, v120
v_add_u32 v122, 32768, v120
v_add_u32 v123, 163840, v120
s_lshl_b32 s45, s32, 2
v_add_u32 v15, s45, v31
v_xor_b32 v15, v15, v0
v_and_b32 v15, 7, v15
s_lshl_b32 s45, s32, 3
s_lshl_b32 s44, s51, 4
s_add_u32 s45, s45, s44
s_mul_i32 s44, s51, 48
v_lshrrev_b32 v124, 3, v0
v_add_u32 v124, s45, v124
v_and_b32 v124, 63, v124
v_add_u32 v124, s44, v124
v_mul_u32_u24 v124, 896, v124
v_lshl_add_u32 v124, v15, 4, v124
v_lshrrev_b32 v125, 3, v0
v_add_u32 v125, s45, v125
v_add_u32 v125, 32, v125
v_and_b32 v125, 63, v125
v_add_u32 v125, s44, v125
v_mul_u32_u24 v125, 896, v125
v_lshl_add_u32 v125, v15, 4, v125
s_lshl_b32 s35, s32, 14
s_add_u32 s36, s35, 65536
s_lshl_b32 s50, s32, 10
s_add_u32 s50, s50, 131072
s_waitcnt lgkmcnt(0)
s_cmp_eq_u32 s47, 0
s_cselect_b32 s16, s68, s80
s_cselect_b32 s17, s69, s81
s_cselect_b32 s4, s70, s82
s_cselect_b32 s5, s71, s83
s_cselect_b32 s8, s72, s84
s_cselect_b32 s9, s73, s85
s_cselect_b32 s12, s74, s86
s_cselect_b32 s13, s75, s87
s_cselect_b32 s24, s76, s88
s_cselect_b32 s25, s77, s89
s_mul_i32 s45, s46, 100352
s_add_u32 s16, s16, s45
s_addc_u32 s17, s17, 0
s_mov_b32 s18, 100352
s_mov_b32 s19, 0x20000
s_lshl_b32 s45, s34, 10
s_add_u32 s12, s12, s45
s_addc_u32 s13, s13, 0
s_sub_u32 s14, 3670016, s45
s_mov_b32 s15, 0x20000
s_mov_b32 s52, s35
s_add_u32 m0, s50, 0
s_nop 0
buffer_load_dwordx4 v124, s[16:19], s48 offen lds
s_add_u32 m0, s50, 4096
s_nop 0
buffer_load_dwordx4 v125, s[16:19], s48 offen lds
s_add_u32 s48, s48, 128
s_sub_u32 s47, s48, 896
s_min_u32 s48, s48, s47
s_add_u32 m0, s52, 65536
s_nop 0
buffer_load_dwordx4 v120, s[12:15], s49 offen offset:0 lds
s_add_u32 m0, s52, 66560
s_nop 0
buffer_load_dwordx4 v121, s[12:15], s49 offen offset:0 lds
s_add_u32 m0, s52, 67584
s_nop 0
buffer_load_dwordx4 v122, s[12:15], s49 offen offset:0 lds
s_add_u32 m0, s52, 68608
s_nop 0
buffer_load_dwordx4 v123, s[12:15], s49 offen offset:0 lds
s_add_u32 m0, s52, 69120
s_nop 0
buffer_load_dwordx4 v120, s[12:15], s49 offen offset:512 lds
s_add_u32 m0, s52, 70144
s_nop 0
buffer_load_dwordx4 v121, s[12:15], s49 offen offset:512 lds
s_add_u32 m0, s52, 71168
s_nop 0
buffer_load_dwordx4 v122, s[12:15], s49 offen offset:512 lds
s_add_u32 m0, s52, 72192
s_nop 0
buffer_load_dwordx4 v123, s[12:15], s49 offen offset:512 lds
s_add_u32 s49, s49, 262144
s_sub_u32 s49, s49, s63
s_add_u32 m0, s52, 73728
s_nop 0
buffer_load_dwordx4 v120, s[12:15], s49 offen offset:0 lds
s_add_u32 m0, s52, 74752
s_nop 0
buffer_load_dwordx4 v121, s[12:15], s49 offen offset:0 lds
s_add_u32 m0, s52, 75776
s_nop 0
buffer_load_dwordx4 v122, s[12:15], s49 offen offset:0 lds
s_add_u32 m0, s52, 76800
s_nop 0
buffer_load_dwordx4 v123, s[12:15], s49 offen offset:0 lds
s_add_u32 m0, s52, 77312
s_nop 0
buffer_load_dwordx4 v120, s[12:15], s49 offen offset:512 lds
s_add_u32 m0, s52, 78336
s_nop 0
buffer_load_dwordx4 v121, s[12:15], s49 offen offset:512 lds
s_add_u32 m0, s52, 79360
s_nop 0
buffer_load_dwordx4 v122, s[12:15], s49 offen offset:512 lds
s_add_u32 m0, s52, 80384
s_nop 0
buffer_load_dwordx4 v123, s[12:15], s49 offen offset:512 lds
s_add_u32 s49, s49, s63
s_add_u32 s49, s49, 262144
s_sub_u32 s47, s49, 3670016
s_min_u32 s49, s49, s47
s_add_u32 m0, s50, 8192
s_nop 0
buffer_load_dwordx4 v124, s[16:19], s48 offen lds
s_add_u32 m0, s50, 12288
s_nop 0
buffer_load_dwordx4 v125, s[16:19], s48 offen lds
s_add_u32 s48, s48, 128
s_sub_u32 s47, s48, 896
s_min_u32 s48, s48, s47
s_lshl_b32 s45, s46, 3
s_add_u32 s45, s45, s34
s_lshl_b32 s45, s45, 20
s_add_u32 s4, s4, s45
s_addc_u32 s5, s5, 0
s_mov_b32 s6, 1048576
s_mov_b32 s7, 0x20000
s_add_u32 s8, s8, s45
s_addc_u32 s9, s9, 0
s_mov_b32 s10, 1048576
s_mov_b32 s11, 0x20000
v_xor_b32 v15, v31, v0
v_and_b32 v15, 7, v15
v_lshrrev_b32 v1, 3, v0
v_lshlrev_b32 v1, 9, v1
v_lshl_add_u32 v1, v15, 4, v1
s_lshl_b32 s45, s32, 13
v_add_u32 v1, s45, v1
v_xor_b32 v2, 64, v1
v_add_u32 v2, 4096, v2
v_lshrrev_b32 v15, 3, v0
v_lshl_add_u32 v3, v15, 9, v3
s_mov_b32 s37, 0
s_mov_b32 s38, 0
s_mul_i32 s45, s34, 458752
s_add_u32 s64, s24, s45
s_addc_u32 s65, s25, 0
s_sub_u32 s24, s64, 256
s_subb_u32 s25, s65, 0
s_mov_b32 s26, 459008
s_mov_b32 s27, 0x20000
s_or_b32 s65, s65, 8388608
s_mov_b32 s66, 2
s_mov_b32 s67, 0x20000
s_mov_b32 s22, 284721152
s_mov_b32 s23, 0x20000
s_mov_b32 s30, 1605632
s_mov_b32 s31, 0x20000
s_lshl_b32 s44, s33, 8
s_add_u32 s44, s44, 65536
s_load_dwordx2 s[56:57], s[20:21], s44
s_and_b32 s44, s33, 0xf8
s_lshl_b32 s45, s32, 1
s_add_u32 s44, s44, s45
s_lshl_b32 s44, s44, 8
s_add_u32 s44, s44, 65536
s_load_dwordx2 s[58:59], s[20:21], s44
s_add_u32 s44, s44, 256
s_load_dwordx2 s[60:61], s[20:21], s44
v_and_b32 v16, 15, v0
v_lshrrev_b32 v17, 4, v0
v_lshrrev_b32 v15, 1, v16
v_xor_b32 v15, v15, v17
v_lshlrev_b32 v15, 4, v15
v_lshl_add_u32 v15, v16, 7, v15
s_lshl_b32 s44, s32, 14
v_add_u32 v4, s44, v15
v_xor_b32 v5, 64, v4
s_lshl_b32 s44, s62, 6
v_xor_b32 v126, s44, v15
v_add_u32 v126, 131072, v126
v_xor_b32 v127, 64, v126
v_lshrrev_b32 v15, 2, v0
v_lshlrev_b32 v15, 7, v15
v_and_b32 v6, 3, v0
v_lshl_add_u32 v15, v6, 3, v15
v_bfe_u32 v6, v0, 3, 2
v_lshl_add_u32 v6, v6, 5, v15
v_add_u32 v6, s36, v6
v_xor_b32 v7, 32, v6
v_xor_b32 v8, 64, v6
v_xor_b32 v9, 96, v6
v_lshlrev_b32 v10, 4, v0
v_add_u32 v10, 131072, v10
s_lshr_b32 s44, s32, 1
s_mul_i32 s44, s44, 7168
s_and_b32 s45, s32, 1
s_lshl_b32 s45, s45, 3
s_add_u32 s44, s44, s45
v_add_u32 v11, s44, v10
v_lshlrev_b32 v12, 5, v16
v_add_u32 v12, 159744, v12
v_lshrrev_b32 v15, 1, v17
v_lshlrev_b32 v15, 8, v15
v_and_b32 v17, 1, v17
v_lshl_add_u32 v15, v17, 3, v15
s_lshl_b32 s44, s32, 11
s_add_u32 s44, s44, 73728
v_add_u32 v15, s44, v15
v_lshl_add_u32 v24, v16, 4, v15
v_add_u32 v27, 57344, v24
v_and_b32 v17, 7, v16
v_lshl_add_u32 v25, v17, 4, v15
v_lshrrev_b32 v17, 3, v16
v_cmp_eq_u32 vcc, s51, v17
v_mov_b32 v17, 0x30000
s_nop 0
v_cndmask_b32 v25, v17, v25, vcc
v_add_u32 v26, 128, v25
v_lshlrev_b32 v15, 3, v0
v_add_u32 v15, 159744, v15
v_mov_b32 v18, 0xff800000
v_mov_b32 v19, 0xff800000
v_mov_b32 v20, 0
v_mov_b32 v14, 160256
ds_write_b64 v15, v[18:19]
ds_write_b32 v14, v20
ds_write_b32 v14, v20 offset:4
s_mov_b32 s43, 0x41400000
s_mov_b32 s42, 0
s_mov_b32 s39, 1
s_mov_b32 s40, 14336
s_getpc_b64 s[92:93]
L_pc:
s_sub_u32 s92, s92, L_pc-concat_heads__gqa_block_cached__gqa_block_cached__near_ridge_kernel
s_subb_u32 s93, s93, 0
s_mov_b32 s94, L_code_end-concat_heads__gqa_block_cached__gqa_block_cached__near_ridge_kernel
s_mov_b32 s95, 0x20000
s_lshr_b32 s44, s33, 3
s_lshl_b32 s44, s44, 2
s_add_u32 s44, s44, s32
s_lshl_b32 s44, s44, 9
v_lshlrev_b32 v31, 7, v0
v_mov_b32 v15, 0x40000000
v_cmp_gt_u32 vcc, 4, v0
s_nop 1
v_cndmask_b32 v31, v15, v31, vcc
buffer_load_dword v13, v31, s[92:95], s44 offen
v_subrev_u32 v20, 65536, v6
v_subrev_u32 v21, 65536, v7
v_subrev_u32 v22, 65536, v8
v_subrev_u32 v23, 65536, v9
s_waitcnt lgkmcnt(0)
s_waitcnt vmcnt(11)
s_barrier
ds_read_b64_tr_b16 v[64:65], v6 offset:0
ds_read_b64_tr_b16 v[66:67], v6 offset:2048
ds_read_b128 v[32:35], v126 offset:0
ds_read_b128 v[36:39], v126 offset:2048
ds_read_b128 v[40:43], v126 offset:4096
ds_read_b128 v[44:47], v126 offset:6144
ds_read_b64_tr_b16 v[68:69], v7 offset:0
ds_read_b64_tr_b16 v[70:71], v7 offset:2048
ds_read_b64_tr_b16 v[72:73], v8 offset:0
ds_read_b64_tr_b16 v[74:75], v8 offset:2048
ds_read_b64_tr_b16 v[76:77], v9 offset:0
ds_read_b64_tr_b16 v[78:79], v9 offset:2048
s_mov_b32 s54, 0x3db8aa3b
s_mov_b32 s55, s54
s_waitcnt lgkmcnt(9)
v_mfma_f32_16x16x32_bf16 v[128:131], v[64:67], v[32:35], 0
s_waitcnt lgkmcnt(8)
ds_read_b64_tr_b16 v[80:81], v6 offset:4096
ds_read_b64_tr_b16 v[82:83], v6 offset:6144
v_mfma_f32_16x16x32_bf16 v[144:147], v[64:67], v[36:39], 0
s_waitcnt lgkmcnt(9)
ds_read_b64_tr_b16 v[84:85], v7 offset:4096
ds_read_b64_tr_b16 v[86:87], v7 offset:6144
v_mfma_f32_16x16x32_bf16 v[160:163], v[64:67], v[40:43], 0
s_waitcnt lgkmcnt(10)
ds_read_b64_tr_b16 v[88:89], v8 offset:4096
ds_read_b64_tr_b16 v[90:91], v8 offset:6144
v_mfma_f32_16x16x32_bf16 v[176:179], v[64:67], v[44:47], 0
s_waitcnt lgkmcnt(10)
s_add_u32 m0, s52, 0
v_mfma_f32_16x16x32_bf16 v[132:135], v[68:71], v[32:35], 0
buffer_load_dwordx4 v120, s[12:15], s49 offen offset:0 lds
v_mfma_f32_16x16x32_bf16 v[148:151], v[68:71], v[36:39], 0
s_waitcnt vmcnt(4)
ds_read_b64_tr_b16 v[92:93], v9 offset:4096
ds_read_b64_tr_b16 v[94:95], v9 offset:6144
v_mfma_f32_16x16x32_bf16 v[164:167], v[68:71], v[40:43], 0
s_add_u32 m0, s52, 1024
v_mfma_f32_16x16x32_bf16 v[180:183], v[68:71], v[44:47], 0
s_waitcnt lgkmcnt(10)
buffer_load_dwordx4 v121, s[12:15], s49 offen offset:0 lds
v_mfma_f32_16x16x32_bf16 v[136:139], v[72:75], v[32:35], 0
s_add_u32 m0, s52, 2048
ds_read_b64_tr_b16 v[96:97], v6 offset:8192
ds_read_b64_tr_b16 v[98:99], v6 offset:10240
v_mfma_f32_16x16x32_bf16 v[152:155], v[72:75], v[36:39], 0
ds_read_b128 v[48:51], v127 offset:0
v_mfma_f32_16x16x32_bf16 v[168:171], v[72:75], v[40:43], 0
buffer_load_dwordx4 v122, s[12:15], s49 offen offset:0 lds
v_mfma_f32_16x16x32_bf16 v[184:187], v[72:75], v[44:47], 0
s_waitcnt lgkmcnt(11)
s_add_u32 m0, s52, 3072
v_mfma_f32_16x16x32_bf16 v[140:143], v[76:79], v[32:35], 0
s_nop 0
ds_read_b64_tr_b16 v[100:101], v7 offset:8192
ds_read_b64_tr_b16 v[102:103], v7 offset:10240
v_mfma_f32_16x16x32_bf16 v[156:159], v[76:79], v[36:39], 0
buffer_load_dwordx4 v123, s[12:15], s49 offen offset:0 lds
v_mfma_f32_16x16x32_bf16 v[172:175], v[76:79], v[40:43], 0
s_add_u32 m0, s52, 3584
ds_read_b128 v[52:55], v127 offset:2048
v_mfma_f32_16x16x32_bf16 v[188:191], v[76:79], v[44:47], 0
s_waitcnt lgkmcnt(12)
v_mfma_f32_16x16x32_bf16 v[192:195], v[80:83], v[32:35], 0
buffer_load_dwordx4 v120, s[12:15], s49 offen offset:512 lds
v_mfma_f32_16x16x32_bf16 v[208:211], v[80:83], v[36:39], 0
s_add_u32 m0, s52, 4608
ds_read_b64_tr_b16 v[104:105], v8 offset:8192
ds_read_b64_tr_b16 v[106:107], v8 offset:10240
v_mfma_f32_16x16x32_bf16 v[224:227], v[80:83], v[40:43], 0
ds_read_b128 v[56:59], v127 offset:4096
v_mfma_f32_16x16x32_bf16 v[240:243], v[80:83], v[44:47], 0
s_waitcnt lgkmcnt(13)
buffer_load_dwordx4 v121, s[12:15], s49 offen offset:512 lds
v_mfma_f32_16x16x32_bf16 v[196:199], v[84:87], v[32:35], 0
s_add_u32 m0, s52, 5632
ds_read_b64_tr_b16 v[108:109], v9 offset:8192
ds_read_b64_tr_b16 v[110:111], v9 offset:10240
v_mfma_f32_16x16x32_bf16 v[212:215], v[84:87], v[36:39], 0
ds_read_b128 v[60:63], v127 offset:6144
v_mfma_f32_16x16x32_bf16 v[228:231], v[84:87], v[40:43], 0
buffer_load_dwordx4 v122, s[12:15], s49 offen offset:512 lds
v_mfma_f32_16x16x32_bf16 v[244:247], v[84:87], v[44:47], 0
s_waitcnt lgkmcnt(14)
s_add_u32 m0, s52, 6656
v_mfma_f32_16x16x32_bf16 v[200:203], v[88:91], v[32:35], 0
s_nop 0
ds_read_b64_tr_b16 v[64:65], v6 offset:12288
ds_read_b64_tr_b16 v[66:67], v6 offset:14336
v_mfma_f32_16x16x32_bf16 v[216:219], v[88:91], v[36:39], 0
buffer_load_dwordx4 v123, s[12:15], s49 offen offset:512 lds
v_mfma_f32_16x16x32_bf16 v[232:235], v[88:91], v[40:43], 0
s_add_u32 s49, s49, 262144
s_sub_u32 s49, s49, s63
s_add_u32 m0, s50, 16384
v_mfma_f32_16x16x32_bf16 v[248:251], v[88:91], v[44:47], 0
s_waitcnt lgkmcnt(14)
v_mfma_f32_16x16x32_bf16 v[204:207], v[92:95], v[32:35], 0
buffer_load_dwordx4 v124, s[16:19], s48 offen lds
v_mfma_f32_16x16x32_bf16 v[220:223], v[92:95], v[36:39], 0
s_add_u32 m0, s50, 20480
ds_read_b64_tr_b16 v[68:69], v7 offset:12288
ds_read_b64_tr_b16 v[70:71], v7 offset:14336
v_mfma_f32_16x16x32_bf16 v[236:239], v[92:95], v[40:43], 0
v_mfma_f32_16x16x32_bf16 v[252:255], v[92:95], v[44:47], 0
s_waitcnt lgkmcnt(13)
buffer_load_dwordx4 v125, s[16:19], s48 offen lds
v_mfma_f32_16x16x32_bf16 v[128:131], v[96:99], v[48:51], v[128:131]
s_waitcnt lgkmcnt(10)
ds_read_b64_tr_b16 v[72:73], v8 offset:12288
ds_read_b64_tr_b16 v[74:75], v8 offset:14336
v_mfma_f32_16x16x32_bf16 v[144:147], v[96:99], v[52:55], v[144:147]
s_waitcnt lgkmcnt(9)
s_add_u32 s48, s48, 128
s_sub_u32 s47, s48, 896
v_mfma_f32_16x16x32_bf16 v[160:163], v[96:99], v[56:59], v[160:163]
s_waitcnt lgkmcnt(6)
s_min_u32 s48, s48, s47
s_add_u32 m0, s52, 8192
v_mfma_f32_16x16x32_bf16 v[176:179], v[96:99], v[60:63], v[176:179]
buffer_load_dwordx4 v120, s[12:15], s49 offen offset:0 lds
v_mfma_f32_16x16x32_bf16 v[132:135], v[100:103], v[48:51], v[132:135]
s_add_u32 m0, s52, 9216
ds_read_b64_tr_b16 v[76:77], v9 offset:12288
ds_read_b64_tr_b16 v[78:79], v9 offset:14336
v_mfma_f32_16x16x32_bf16 v[148:151], v[100:103], v[52:55], v[148:151]
s_waitcnt vmcnt(3)
s_barrier
v_mfma_f32_16x16x32_bf16 v[164:167], v[100:103], v[56:59], v[164:167]
buffer_load_dwordx4 v121, s[12:15], s49 offen offset:0 lds
v_mfma_f32_16x16x32_bf16 v[180:183], v[100:103], v[60:63], v[180:183]
s_add_u32 m0, s52, 10240
v_mfma_f32_16x16x32_bf16 v[136:139], v[104:107], v[48:51], v[136:139]
s_nop 0
ds_read_b64_tr_b16 v[80:81], v20 offset:0
ds_read_b64_tr_b16 v[82:83], v20 offset:2048
v_mfma_f32_16x16x32_bf16 v[152:155], v[104:107], v[52:55], v[152:155]
buffer_load_dwordx4 v122, s[12:15], s49 offen offset:0 lds
v_mfma_f32_16x16x32_bf16 v[168:171], v[104:107], v[56:59], v[168:171]
s_add_u32 m0, s52, 11264
ds_read_b128 v[32:35], v126 offset:8192
v_mfma_f32_16x16x32_bf16 v[184:187], v[104:107], v[60:63], v[184:187]
v_mfma_f32_16x16x32_bf16 v[140:143], v[108:111], v[48:51], v[140:143]
buffer_load_dwordx4 v123, s[12:15], s49 offen offset:0 lds
v_mfma_f32_16x16x32_bf16 v[156:159], v[108:111], v[52:55], v[156:159]
s_add_u32 m0, s52, 11776
ds_read_b64_tr_b16 v[84:85], v21 offset:0
ds_read_b64_tr_b16 v[86:87], v21 offset:2048
v_mfma_f32_16x16x32_bf16 v[172:175], v[108:111], v[56:59], v[172:175]
ds_read_b128 v[36:39], v126 offset:10240
v_mfma_f32_16x16x32_bf16 v[188:191], v[108:111], v[60:63], v[188:191]
s_waitcnt lgkmcnt(12)
buffer_load_dwordx4 v120, s[12:15], s49 offen offset:512 lds
v_mfma_f32_16x16x32_bf16 v[192:195], v[64:67], v[48:51], v[192:195]
s_add_u32 m0, s52, 12800
ds_read_b64_tr_b16 v[88:89], v22 offset:0
ds_read_b64_tr_b16 v[90:91], v22 offset:2048
v_mfma_f32_16x16x32_bf16 v[208:211], v[64:67], v[52:55], v[208:211]
ds_read_b128 v[40:43], v126 offset:12288
v_mfma_f32_16x16x32_bf16 v[224:227], v[64:67], v[56:59], v[224:227]
buffer_load_dwordx4 v121, s[12:15], s49 offen offset:512 lds
v_mfma_f32_16x16x32_bf16 v[240:243], v[64:67], v[60:63], v[240:243]
s_waitcnt lgkmcnt(13)
s_add_u32 m0, s52, 13824
v_mfma_f32_16x16x32_bf16 v[196:199], v[68:71], v[48:51], v[196:199]
s_nop 0
ds_read_b64_tr_b16 v[92:93], v23 offset:0
ds_read_b64_tr_b16 v[94:95], v23 offset:2048
v_mfma_f32_16x16x32_bf16 v[212:215], v[68:71], v[52:55], v[212:215]
buffer_load_dwordx4 v122, s[12:15], s49 offen offset:512 lds
v_mfma_f32_16x16x32_bf16 v[228:231], v[68:71], v[56:59], v[228:231]
s_add_u32 m0, s52, 14848
ds_read_b128 v[44:47], v126 offset:14336
v_mfma_f32_16x16x32_bf16 v[244:247], v[68:71], v[60:63], v[244:247]
s_waitcnt lgkmcnt(14)
v_mfma_f32_16x16x32_bf16 v[200:203], v[72:75], v[48:51], v[200:203]
buffer_load_dwordx4 v123, s[12:15], s49 offen offset:512 lds
v_mfma_f32_16x16x32_bf16 v[216:219], v[72:75], v[52:55], v[216:219]
s_add_u32 s49, s49, s63
ds_read_b64_tr_b16 v[96:97], v20 offset:4096
ds_read_b64_tr_b16 v[98:99], v20 offset:6144
v_mfma_f32_16x16x32_bf16 v[232:235], v[72:75], v[56:59], v[232:235]
s_add_u32 s49, s49, 262144
s_sub_u32 s47, s49, 3670016
s_min_u32 s49, s49, s47
v_mfma_f32_16x16x32_bf16 v[248:251], v[72:75], v[60:63], v[248:251]
s_waitcnt lgkmcnt(14)
s_add_u32 m0, s52, 65536
v_mfma_f32_16x16x32_bf16 v[204:207], v[76:79], v[48:51], v[204:207]
buffer_load_dwordx4 v120, s[12:15], s49 offen offset:0 lds
v_mfma_f32_16x16x32_bf16 v[220:223], v[76:79], v[52:55], v[220:223]
s_add_u32 m0, s52, 66560
ds_read_b64_tr_b16 v[100:101], v21 offset:4096
ds_read_b64_tr_b16 v[102:103], v21 offset:6144
v_mfma_f32_16x16x32_bf16 v[236:239], v[76:79], v[56:59], v[236:239]
v_mfma_f32_16x16x32_bf16 v[252:255], v[76:79], v[60:63], v[252:255]
s_waitcnt lgkmcnt(13)
buffer_load_dwordx4 v121, s[12:15], s49 offen offset:0 lds
v_mfma_f32_16x16x32_bf16 v[128:131], v[80:83], v[32:35], v[128:131]
s_waitcnt lgkmcnt(10)
ds_read_b64_tr_b16 v[104:105], v22 offset:4096
ds_read_b64_tr_b16 v[106:107], v22 offset:6144
v_mfma_f32_16x16x32_bf16 v[144:147], v[80:83], v[36:39], v[144:147]
s_waitcnt lgkmcnt(9)
s_add_u32 m0, s52, 67584
v_mfma_f32_16x16x32_bf16 v[160:163], v[80:83], v[40:43], v[160:163]
s_waitcnt lgkmcnt(6)
buffer_load_dwordx4 v122, s[12:15], s49 offen offset:0 lds
v_mfma_f32_16x16x32_bf16 v[176:179], v[80:83], v[44:47], v[176:179]
s_add_u32 m0, s52, 68608
v_mfma_f32_16x16x32_bf16 v[132:135], v[84:87], v[32:35], v[132:135]
s_nop 0
ds_read_b64_tr_b16 v[108:109], v23 offset:4096
ds_read_b64_tr_b16 v[110:111], v23 offset:6144
v_mfma_f32_16x16x32_bf16 v[148:151], v[84:87], v[36:39], v[148:151]
s_waitcnt vmcnt(3)
buffer_load_dwordx4 v123, s[12:15], s49 offen offset:0 lds
v_mfma_f32_16x16x32_bf16 v[164:167], v[84:87], v[40:43], v[164:167]
s_add_u32 m0, s52, 69120
v_mfma_f32_16x16x32_bf16 v[180:183], v[84:87], v[44:47], v[180:183]
v_mfma_f32_16x16x32_bf16 v[136:139], v[88:91], v[32:35], v[136:139]
buffer_load_dwordx4 v120, s[12:15], s49 offen offset:512 lds
v_mfma_f32_16x16x32_bf16 v[152:155], v[88:91], v[36:39], v[152:155]
s_add_u32 m0, s52, 70144
ds_read_b64_tr_b16 v[64:65], v20 offset:8192
ds_read_b64_tr_b16 v[66:67], v20 offset:10240
v_mfma_f32_16x16x32_bf16 v[168:171], v[88:91], v[40:43], v[168:171]
ds_read_b128 v[48:51], v127 offset:8192
v_mfma_f32_16x16x32_bf16 v[184:187], v[88:91], v[44:47], v[184:187]
buffer_load_dwordx4 v121, s[12:15], s49 offen offset:512 lds
v_mfma_f32_16x16x32_bf16 v[140:143], v[92:95], v[32:35], v[140:143]
s_add_u32 m0, s52, 71168
ds_read_b64_tr_b16 v[68:69], v21 offset:8192
ds_read_b64_tr_b16 v[70:71], v21 offset:10240
v_mfma_f32_16x16x32_bf16 v[156:159], v[92:95], v[36:39], v[156:159]
ds_read_b128 v[52:55], v127 offset:10240
v_mfma_f32_16x16x32_bf16 v[172:175], v[92:95], v[40:43], v[172:175]
buffer_load_dwordx4 v122, s[12:15], s49 offen offset:512 lds
v_mfma_f32_16x16x32_bf16 v[188:191], v[92:95], v[44:47], v[188:191]
s_waitcnt lgkmcnt(12)
s_add_u32 m0, s52, 72192
v_mfma_f32_16x16x32_bf16 v[192:195], v[96:99], v[32:35], v[192:195]
s_nop 0
ds_read_b64_tr_b16 v[72:73], v22 offset:8192
ds_read_b64_tr_b16 v[74:75], v22 offset:10240
v_mfma_f32_16x16x32_bf16 v[208:211], v[96:99], v[36:39], v[208:211]
buffer_load_dwordx4 v123, s[12:15], s49 offen offset:512 lds
v_mfma_f32_16x16x32_bf16 v[224:227], v[96:99], v[40:43], v[224:227]
s_add_u32 s49, s49, 262144
ds_read_b128 v[56:59], v127 offset:12288
s_sub_u32 s49, s49, s63
v_mfma_f32_16x16x32_bf16 v[240:243], v[96:99], v[44:47], v[240:243]
s_waitcnt lgkmcnt(13)
s_add_u32 m0, s50, 0
v_mfma_f32_16x16x32_bf16 v[196:199], v[100:103], v[32:35], v[196:199]
buffer_load_dwordx4 v124, s[16:19], s48 offen lds
v_mfma_f32_16x16x32_bf16 v[212:215], v[100:103], v[36:39], v[212:215]
s_add_u32 m0, s50, 4096
ds_read_b64_tr_b16 v[76:77], v23 offset:8192
ds_read_b64_tr_b16 v[78:79], v23 offset:10240
v_mfma_f32_16x16x32_bf16 v[228:231], v[100:103], v[40:43], v[228:231]
ds_read_b128 v[60:63], v127 offset:14336
v_mfma_f32_16x16x32_bf16 v[244:247], v[100:103], v[44:47], v[244:247]
s_waitcnt lgkmcnt(14)
buffer_load_dwordx4 v125, s[16:19], s48 offen lds
v_mfma_f32_16x16x32_bf16 v[200:203], v[104:107], v[32:35], v[200:203]
s_add_u32 s48, s48, 128
ds_read_b64_tr_b16 v[80:81], v20 offset:12288
ds_read_b64_tr_b16 v[82:83], v20 offset:14336
v_mfma_f32_16x16x32_bf16 v[216:219], v[104:107], v[36:39], v[216:219]
s_sub_u32 s47, s48, 896
s_min_u32 s48, s48, s47
s_add_u32 m0, s52, 73728
v_mfma_f32_16x16x32_bf16 v[232:235], v[104:107], v[40:43], v[232:235]
buffer_load_dwordx4 v120, s[12:15], s49 offen offset:0 lds
v_mfma_f32_16x16x32_bf16 v[248:251], v[104:107], v[44:47], v[248:251]
s_waitcnt lgkmcnt(14)
s_add_u32 m0, s52, 74752
v_mfma_f32_16x16x32_bf16 v[204:207], v[108:111], v[32:35], v[204:207]
s_nop 0
ds_read_b64_tr_b16 v[84:85], v21 offset:12288
ds_read_b64_tr_b16 v[86:87], v21 offset:14336
v_mfma_f32_16x16x32_bf16 v[220:223], v[108:111], v[36:39], v[220:223]
buffer_load_dwordx4 v121, s[12:15], s49 offen offset:0 lds
v_mfma_f32_16x16x32_bf16 v[236:239], v[108:111], v[40:43], v[236:239]
s_add_u32 m0, s52, 75776
v_mfma_f32_16x16x32_bf16 v[252:255], v[108:111], v[44:47], v[252:255]
s_waitcnt lgkmcnt(13)
v_mfma_f32_16x16x32_bf16 v[128:131], v[64:67], v[48:51], v[128:131]
s_waitcnt lgkmcnt(10)
buffer_load_dwordx4 v122, s[12:15], s49 offen offset:0 lds
v_mfma_f32_16x16x32_bf16 v[144:147], v[64:67], v[52:55], v[144:147]
s_waitcnt lgkmcnt(7)
ds_read_b64_tr_b16 v[88:89], v22 offset:12288
ds_read_b64_tr_b16 v[90:91], v22 offset:14336
v_mfma_f32_16x16x32_bf16 v[160:163], v[64:67], v[56:59], v[160:163]
s_waitcnt lgkmcnt(6)
s_add_u32 m0, s52, 76800
v_mfma_f32_16x16x32_bf16 v[176:179], v[64:67], v[60:63], v[176:179]
buffer_load_dwordx4 v123, s[12:15], s49 offen offset:0 lds
v_mfma_f32_16x16x32_bf16 v[132:135], v[68:71], v[48:51], v[132:135]
s_add_u32 m0, s52, 77312
ds_read_b64_tr_b16 v[92:93], v23 offset:12288
ds_read_b64_tr_b16 v[94:95], v23 offset:14336
v_mfma_f32_16x16x32_bf16 v[148:151], v[68:71], v[52:55], v[148:151]
s_waitcnt vmcnt(6)
s_barrier
v_mfma_f32_16x16x32_bf16 v[164:167], v[68:71], v[56:59], v[164:167]
buffer_load_dwordx4 v120, s[12:15], s49 offen offset:512 lds
v_mfma_f32_16x16x32_bf16 v[180:183], v[68:71], v[60:63], v[180:183]
s_add_u32 m0, s52, 78336
v_mfma_f32_16x16x32_bf16 v[136:139], v[72:75], v[48:51], v[136:139]
s_nop 0
ds_read_b64_tr_b16 v[96:97], v6 offset:0
ds_read_b64_tr_b16 v[98:99], v6 offset:2048
v_mfma_f32_16x16x32_bf16 v[152:155], v[72:75], v[52:55], v[152:155]
buffer_load_dwordx4 v121, s[12:15], s49 offen offset:512 lds
v_mfma_f32_16x16x32_bf16 v[168:171], v[72:75], v[56:59], v[168:171]
s_add_u32 m0, s52, 79360
ds_read_b128 v[32:35], v126 offset:16384
v_mfma_f32_16x16x32_bf16 v[184:187], v[72:75], v[60:63], v[184:187]
v_mfma_f32_16x16x32_bf16 v[140:143], v[76:79], v[48:51], v[140:143]
buffer_load_dwordx4 v122, s[12:15], s49 offen offset:512 lds
v_mfma_f32_16x16x32_bf16 v[156:159], v[76:79], v[52:55], v[156:159]
s_add_u32 m0, s52, 80384
ds_read_b64_tr_b16 v[100:101], v7 offset:0
ds_read_b64_tr_b16 v[102:103], v7 offset:2048
v_mfma_f32_16x16x32_bf16 v[172:175], v[76:79], v[56:59], v[172:175]
ds_read_b128 v[36:39], v126 offset:18432
v_mfma_f32_16x16x32_bf16 v[188:191], v[76:79], v[60:63], v[188:191]
s_waitcnt lgkmcnt(12)
buffer_load_dwordx4 v123, s[12:15], s49 offen offset:512 lds
v_mfma_f32_16x16x32_bf16 v[192:195], v[80:83], v[48:51], v[192:195]
s_add_u32 s49, s49, s63
ds_read_b64_tr_b16 v[104:105], v8 offset:0
ds_read_b64_tr_b16 v[106:107], v8 offset:2048
v_mfma_f32_16x16x32_bf16 v[208:211], v[80:83], v[52:55], v[208:211]
s_add_u32 s49, s49, 262144
ds_read_b128 v[40:43], v126 offset:20480
s_sub_u32 s47, s49, 3670016
v_mfma_f32_16x16x32_bf16 v[224:227], v[80:83], v[56:59], v[224:227]
s_min_u32 s49, s49, s47
s_add_u32 m0, s52, 0
v_mfma_f32_16x16x32_bf16 v[240:243], v[80:83], v[60:63], v[240:243]
s_waitcnt lgkmcnt(13)
buffer_load_dwordx4 v120, s[12:15], s49 offen offset:0 lds
v_mfma_f32_16x16x32_bf16 v[196:199], v[84:87], v[48:51], v[196:199]
s_add_u32 m0, s52, 1024
ds_read_b64_tr_b16 v[108:109], v9 offset:0
ds_read_b64_tr_b16 v[110:111], v9 offset:2048
v_mfma_f32_16x16x32_bf16 v[212:215], v[84:87], v[52:55], v[212:215]
ds_read_b128 v[44:47], v126 offset:22528
v_mfma_f32_16x16x32_bf16 v[228:231], v[84:87], v[56:59], v[228:231]
buffer_load_dwordx4 v121, s[12:15], s49 offen offset:0 lds
v_mfma_f32_16x16x32_bf16 v[244:247], v[84:87], v[60:63], v[244:247]
s_waitcnt lgkmcnt(14)
s_add_u32 m0, s52, 2048
v_mfma_f32_16x16x32_bf16 v[200:203], v[88:91], v[48:51], v[200:203]
s_nop 0
ds_read_b64_tr_b16 v[64:65], v6 offset:4096
ds_read_b64_tr_b16 v[66:67], v6 offset:6144
v_mfma_f32_16x16x32_bf16 v[216:219], v[88:91], v[52:55], v[216:219]
buffer_load_dwordx4 v122, s[12:15], s49 offen offset:0 lds
v_mfma_f32_16x16x32_bf16 v[232:235], v[88:91], v[56:59], v[232:235]
s_add_u32 m0, s52, 3072
v_mfma_f32_16x16x32_bf16 v[248:251], v[88:91], v[60:63], v[248:251]
s_waitcnt lgkmcnt(14)
v_mfma_f32_16x16x32_bf16 v[204:207], v[92:95], v[48:51], v[204:207]
buffer_load_dwordx4 v123, s[12:15], s49 offen offset:0 lds
v_mfma_f32_16x16x32_bf16 v[220:223], v[92:95], v[52:55], v[220:223]
s_add_u32 m0, s52, 3584
ds_read_b64_tr_b16 v[68:69], v7 offset:4096
ds_read_b64_tr_b16 v[70:71], v7 offset:6144
v_mfma_f32_16x16x32_bf16 v[236:239], v[92:95], v[56:59], v[236:239]
v_mfma_f32_16x16x32_bf16 v[252:255], v[92:95], v[60:63], v[252:255]
s_waitcnt lgkmcnt(13)
buffer_load_dwordx4 v120, s[12:15], s49 offen offset:512 lds
v_mfma_f32_16x16x32_bf16 v[128:131], v[96:99], v[32:35], v[128:131]
s_waitcnt lgkmcnt(10)
ds_read_b64_tr_b16 v[72:73], v8 offset:4096
ds_read_b64_tr_b16 v[74:75], v8 offset:6144
v_mfma_f32_16x16x32_bf16 v[144:147], v[96:99], v[36:39], v[144:147]
s_waitcnt lgkmcnt(9)
s_add_u32 m0, s52, 4608
v_mfma_f32_16x16x32_bf16 v[160:163], v[96:99], v[40:43], v[160:163]
s_waitcnt lgkmcnt(6)
buffer_load_dwordx4 v121, s[12:15], s49 offen offset:512 lds
v_mfma_f32_16x16x32_bf16 v[176:179], v[96:99], v[44:47], v[176:179]
s_add_u32 m0, s52, 5632
v_mfma_f32_16x16x32_bf16 v[132:135], v[100:103], v[32:35], v[132:135]
s_nop 0
ds_read_b64_tr_b16 v[76:77], v9 offset:4096
ds_read_b64_tr_b16 v[78:79], v9 offset:6144
v_mfma_f32_16x16x32_bf16 v[148:151], v[100:103], v[36:39], v[148:151]
s_waitcnt vmcnt(6)
buffer_load_dwordx4 v122, s[12:15], s49 offen offset:512 lds
v_mfma_f32_16x16x32_bf16 v[164:167], v[100:103], v[40:43], v[164:167]
s_add_u32 m0, s52, 6656
v_mfma_f32_16x16x32_bf16 v[180:183], v[100:103], v[44:47], v[180:183]
v_mfma_f32_16x16x32_bf16 v[136:139], v[104:107], v[32:35], v[136:139]
buffer_load_dwordx4 v123, s[12:15], s49 offen offset:512 lds
v_mfma_f32_16x16x32_bf16 v[152:155], v[104:107], v[36:39], v[152:155]
s_add_u32 s49, s49, 262144
ds_read_b64_tr_b16 v[80:81], v6 offset:8192
ds_read_b64_tr_b16 v[82:83], v6 offset:10240
v_mfma_f32_16x16x32_bf16 v[168:171], v[104:107], v[40:43], v[168:171]
s_sub_u32 s49, s49, s63
ds_read_b128 v[48:51], v127 offset:16384
s_add_u32 m0, s50, 8192
v_mfma_f32_16x16x32_bf16 v[184:187], v[104:107], v[44:47], v[184:187]
buffer_load_dwordx4 v124, s[16:19], s48 offen lds
v_mfma_f32_16x16x32_bf16 v[140:143], v[108:111], v[32:35], v[140:143]
s_add_u32 m0, s50, 12288
ds_read_b64_tr_b16 v[84:85], v7 offset:8192
ds_read_b64_tr_b16 v[86:87], v7 offset:10240
v_mfma_f32_16x16x32_bf16 v[156:159], v[108:111], v[36:39], v[156:159]
ds_read_b128 v[52:55], v127 offset:18432
v_mfma_f32_16x16x32_bf16 v[172:175], v[108:111], v[40:43], v[172:175]
buffer_load_dwordx4 v125, s[16:19], s48 offen lds
v_mfma_f32_16x16x32_bf16 v[188:191], v[108:111], v[44:47], v[188:191]
s_waitcnt lgkmcnt(12)
s_add_u32 s48, s48, 128
s_sub_u32 s47, s48, 896
v_mfma_f32_16x16x32_bf16 v[192:195], v[64:67], v[32:35], v[192:195]
s_min_u32 s48, s48, s47
ds_read_b64_tr_b16 v[88:89], v8 offset:8192
ds_read_b64_tr_b16 v[90:91], v8 offset:10240
v_mfma_f32_16x16x32_bf16 v[208:211], v[64:67], v[36:39], v[208:211]
s_add_u32 m0, s52, 8192
ds_read_b128 v[56:59], v127 offset:20480
v_mfma_f32_16x16x32_bf16 v[224:227], v[64:67], v[40:43], v[224:227]
buffer_load_dwordx4 v120, s[12:15], s49 offen offset:0 lds
v_mfma_f32_16x16x32_bf16 v[240:243], v[64:67], v[44:47], v[240:243]
s_waitcnt lgkmcnt(13)
s_add_u32 m0, s52, 9216
v_mfma_f32_16x16x32_bf16 v[196:199], v[68:71], v[32:35], v[196:199]
s_nop 0
ds_read_b64_tr_b16 v[92:93], v9 offset:8192
ds_read_b64_tr_b16 v[94:95], v9 offset:10240
v_mfma_f32_16x16x32_bf16 v[212:215], v[68:71], v[36:39], v[212:215]
buffer_load_dwordx4 v121, s[12:15], s49 offen offset:0 lds
v_mfma_f32_16x16x32_bf16 v[228:231], v[68:71], v[40:43], v[228:231]
s_add_u32 m0, s52, 10240
ds_read_b128 v[60:63], v127 offset:22528
v_mfma_f32_16x16x32_bf16 v[244:247], v[68:71], v[44:47], v[244:247]
s_waitcnt lgkmcnt(14)
v_mfma_f32_16x16x32_bf16 v[200:203], v[72:75], v[32:35], v[200:203]
buffer_load_dwordx4 v122, s[12:15], s49 offen offset:0 lds
v_mfma_f32_16x16x32_bf16 v[216:219], v[72:75], v[36:39], v[216:219]
s_add_u32 m0, s52, 11264
ds_read_b64_tr_b16 v[96:97], v6 offset:12288
ds_read_b64_tr_b16 v[98:99], v6 offset:14336
v_mfma_f32_16x16x32_bf16 v[232:235], v[72:75], v[40:43], v[232:235]
v_mfma_f32_16x16x32_bf16 v[248:251], v[72:75], v[44:47], v[248:251]
s_waitcnt lgkmcnt(14)
buffer_load_dwordx4 v123, s[12:15], s49 offen offset:0 lds
v_mfma_f32_16x16x32_bf16 v[204:207], v[76:79], v[32:35], v[204:207]
s_add_u32 m0, s52, 11776
ds_read_b64_tr_b16 v[100:101], v7 offset:12288
ds_read_b64_tr_b16 v[102:103], v7 offset:14336
v_mfma_f32_16x16x32_bf16 v[220:223], v[76:79], v[36:39], v[220:223]
v_mfma_f32_16x16x32_bf16 v[236:239], v[76:79], v[40:43], v[236:239]
buffer_load_dwordx4 v120, s[12:15], s49 offen offset:512 lds
v_mfma_f32_16x16x32_bf16 v[252:255], v[76:79], v[44:47], v[252:255]
s_waitcnt lgkmcnt(13)
s_add_u32 m0, s52, 12800
v_mfma_f32_16x16x32_bf16 v[128:131], v[80:83], v[48:51], v[128:131]
s_waitcnt lgkmcnt(10)
ds_read_b64_tr_b16 v[104:105], v8 offset:12288
ds_read_b64_tr_b16 v[106:107], v8 offset:14336
v_mfma_f32_16x16x32_bf16 v[144:147], v[80:83], v[52:55], v[144:147]
s_waitcnt lgkmcnt(9)
buffer_load_dwordx4 v121, s[12:15], s49 offen offset:512 lds
v_mfma_f32_16x16x32_bf16 v[160:163], v[80:83], v[56:59], v[160:163]
s_waitcnt lgkmcnt(6)
s_add_u32 m0, s52, 13824
v_mfma_f32_16x16x32_bf16 v[176:179], v[80:83], v[60:63], v[176:179]
v_mfma_f32_16x16x32_bf16 v[132:135], v[84:87], v[48:51], v[132:135]
buffer_load_dwordx4 v122, s[12:15], s49 offen offset:512 lds
v_mfma_f32_16x16x32_bf16 v[148:151], v[84:87], v[52:55], v[148:151]
s_waitcnt vmcnt(9)
s_barrier
ds_read_b64_tr_b16 v[108:109], v9 offset:12288
v_mfma_f32_16x16x32_bf16 v[164:167], v[84:87], v[56:59], v[164:167]
s_add_u32 m0, s52, 14848
ds_read_b64_tr_b16 v[110:111], v9 offset:14336
v_mfma_f32_16x16x32_bf16 v[180:183], v[84:87], v[60:63], v[180:183]
buffer_load_dwordx4 v123, s[12:15], s49 offen offset:512 lds
v_mfma_f32_16x16x32_bf16 v[136:139], v[88:91], v[48:51], v[136:139]
s_add_u32 s49, s49, s63
ds_read_b64_tr_b16 v[64:65], v20 offset:0
ds_read_b64_tr_b16 v[66:67], v20 offset:2048
v_mfma_f32_16x16x32_bf16 v[152:155], v[88:91], v[52:55], v[152:155]
s_add_u32 s49, s49, 262144
ds_read_b128 v[32:35], v126 offset:0
s_sub_u32 s47, s49, 3670016
v_mfma_f32_16x16x32_bf16 v[168:171], v[88:91], v[56:59], v[168:171]
s_min_u32 s49, s49, s47
s_add_u32 m0, s52, 65536
v_mfma_f32_16x16x32_bf16 v[184:187], v[88:91], v[60:63], v[184:187]
buffer_load_dwordx4 v120, s[12:15], s49 offen offset:0 lds
v_mfma_f32_16x16x32_bf16 v[140:143], v[92:95], v[48:51], v[140:143]
s_add_u32 m0, s52, 66560
ds_read_b64_tr_b16 v[68:69], v21 offset:0
ds_read_b64_tr_b16 v[70:71], v21 offset:2048
v_mfma_f32_16x16x32_bf16 v[156:159], v[92:95], v[52:55], v[156:159]
ds_read_b128 v[36:39], v126 offset:2048
v_mfma_f32_16x16x32_bf16 v[172:175], v[92:95], v[56:59], v[172:175]
buffer_load_dwordx4 v121, s[12:15], s49 offen offset:0 lds
v_mfma_f32_16x16x32_bf16 v[188:191], v[92:95], v[60:63], v[188:191]
s_waitcnt lgkmcnt(12)
s_add_u32 m0, s52, 67584
v_mfma_f32_16x16x32_bf16 v[192:195], v[96:99], v[48:51], v[192:195]
s_nop 0
ds_read_b64_tr_b16 v[72:73], v22 offset:0
ds_read_b64_tr_b16 v[74:75], v22 offset:2048
v_mfma_f32_16x16x32_bf16 v[208:211], v[96:99], v[52:55], v[208:211]
buffer_load_dwordx4 v122, s[12:15], s49 offen offset:0 lds
v_mfma_f32_16x16x32_bf16 v[224:227], v[96:99], v[56:59], v[224:227]
s_add_u32 m0, s52, 68608
ds_read_b128 v[40:43], v126 offset:4096
v_mfma_f32_16x16x32_bf16 v[240:243], v[96:99], v[60:63], v[240:243]
s_waitcnt lgkmcnt(13)
v_mfma_f32_16x16x32_bf16 v[196:199], v[100:103], v[48:51], v[196:199]
buffer_load_dwordx4 v123, s[12:15], s49 offen offset:0 lds
v_mfma_f32_16x16x32_bf16 v[212:215], v[100:103], v[52:55], v[212:215]
s_add_u32 m0, s52, 69120
ds_read_b64_tr_b16 v[76:77], v23 offset:0
ds_read_b64_tr_b16 v[78:79], v23 offset:2048
v_mfma_f32_16x16x32_bf16 v[228:231], v[100:103], v[56:59], v[228:231]
ds_read_b128 v[44:47], v126 offset:6144
v_mfma_f32_16x16x32_bf16 v[244:247], v[100:103], v[60:63], v[244:247]
s_waitcnt lgkmcnt(14)
buffer_load_dwordx4 v120, s[12:15], s49 offen offset:512 lds
v_mfma_f32_16x16x32_bf16 v[200:203], v[104:107], v[48:51], v[200:203]
s_add_u32 m0, s52, 70144
ds_read_b64_tr_b16 v[80:81], v20 offset:4096
ds_read_b64_tr_b16 v[82:83], v20 offset:6144
v_mfma_f32_16x16x32_bf16 v[216:219], v[104:107], v[52:55], v[216:219]
v_mfma_f32_16x16x32_bf16 v[232:235], v[104:107], v[56:59], v[232:235]
buffer_load_dwordx4 v121, s[12:15], s49 offen offset:512 lds
v_mfma_f32_16x16x32_bf16 v[248:251], v[104:107], v[60:63], v[248:251]
s_waitcnt lgkmcnt(14)
s_add_u32 m0, s52, 71168
v_mfma_f32_16x16x32_bf16 v[204:207], v[108:111], v[48:51], v[204:207]
s_nop 0
ds_read_b64_tr_b16 v[84:85], v21 offset:4096
ds_read_b64_tr_b16 v[86:87], v21 offset:6144
v_mfma_f32_16x16x32_bf16 v[220:223], v[108:111], v[52:55], v[220:223]
buffer_load_dwordx4 v122, s[12:15], s49 offen offset:512 lds
v_mfma_f32_16x16x32_bf16 v[236:239], v[108:111], v[56:59], v[236:239]
s_add_u32 m0, s52, 72192
v_mfma_f32_16x16x32_bf16 v[252:255], v[108:111], v[60:63], v[252:255]
s_waitcnt lgkmcnt(13)
v_mfma_f32_16x16x32_bf16 v[128:131], v[64:67], v[32:35], v[128:131]
s_waitcnt lgkmcnt(10)
buffer_load_dwordx4 v123, s[12:15], s49 offen offset:512 lds
v_mfma_f32_16x16x32_bf16 v[144:147], v[64:67], v[36:39], v[144:147]
s_waitcnt lgkmcnt(7)
ds_read_b64_tr_b16 v[88:89], v22 offset:4096
ds_read_b64_tr_b16 v[90:91], v22 offset:6144
v_mfma_f32_16x16x32_bf16 v[160:163], v[64:67], v[40:43], v[160:163]
s_waitcnt lgkmcnt(6)
s_add_u32 s49, s49, 262144
s_sub_u32 s49, s49, s63
v_mfma_f32_16x16x32_bf16 v[176:179], v[64:67], v[44:47], v[176:179]
s_add_u32 m0, s50, 16384
v_mfma_f32_16x16x32_bf16 v[132:135], v[68:71], v[32:35], v[132:135]
buffer_load_dwordx4 v124, s[16:19], s48 offen lds
v_mfma_f32_16x16x32_bf16 v[148:151], v[68:71], v[36:39], v[148:151]
s_waitcnt vmcnt(9)
ds_read_b64_tr_b16 v[92:93], v23 offset:4096
ds_read_b64_tr_b16 v[94:95], v23 offset:6144
v_mfma_f32_16x16x32_bf16 v[164:167], v[68:71], v[40:43], v[164:167]
s_add_u32 m0, s50, 20480
v_mfma_f32_16x16x32_bf16 v[180:183], v[68:71], v[44:47], v[180:183]
buffer_load_dwordx4 v125, s[16:19], s48 offen lds
v_mfma_f32_16x16x32_bf16 v[136:139], v[72:75], v[32:35], v[136:139]
s_add_u32 s48, s48, 128
ds_read_b64_tr_b16 v[96:97], v20 offset:8192
ds_read_b64_tr_b16 v[98:99], v20 offset:10240
v_mfma_f32_16x16x32_bf16 v[152:155], v[72:75], v[36:39], v[152:155]
s_sub_u32 s47, s48, 896
ds_read_b128 v[48:51], v127 offset:0
s_min_u32 s48, s48, s47
v_mfma_f32_16x16x32_bf16 v[168:171], v[72:75], v[40:43], v[168:171]
s_add_u32 m0, s52, 73728
v_mfma_f32_16x16x32_bf16 v[184:187], v[72:75], v[44:47], v[184:187]
buffer_load_dwordx4 v120, s[12:15], s49 offen offset:0 lds
v_mfma_f32_16x16x32_bf16 v[140:143], v[76:79], v[32:35], v[140:143]
s_add_u32 m0, s52, 74752
ds_read_b64_tr_b16 v[100:101], v21 offset:8192
ds_read_b64_tr_b16 v[102:103], v21 offset:10240
v_mfma_f32_16x16x32_bf16 v[156:159], v[76:79], v[36:39], v[156:159]
ds_read_b128 v[52:55], v127 offset:2048
v_mfma_f32_16x16x32_bf16 v[172:175], v[76:79], v[40:43], v[172:175]
buffer_load_dwordx4 v121, s[12:15], s49 offen offset:0 lds
v_mfma_f32_16x16x32_bf16 v[188:191], v[76:79], v[44:47], v[188:191]
s_waitcnt lgkmcnt(12)
s_add_u32 m0, s52, 75776
v_mfma_f32_16x16x32_bf16 v[192:195], v[80:83], v[32:35], v[192:195]
s_nop 0
ds_read_b64_tr_b16 v[104:105], v22 offset:8192
ds_read_b64_tr_b16 v[106:107], v22 offset:10240
v_mfma_f32_16x16x32_bf16 v[208:211], v[80:83], v[36:39], v[208:211]
buffer_load_dwordx4 v122, s[12:15], s49 offen offset:0 lds
v_mfma_f32_16x16x32_bf16 v[224:227], v[80:83], v[40:43], v[224:227]
s_add_u32 m0, s52, 76800
ds_read_b128 v[56:59], v127 offset:4096
v_mfma_f32_16x16x32_bf16 v[240:243], v[80:83], v[44:47], v[240:243]
s_waitcnt lgkmcnt(13)
v_mfma_f32_16x16x32_bf16 v[196:199], v[84:87], v[32:35], v[196:199]
buffer_load_dwordx4 v123, s[12:15], s49 offen offset:0 lds
v_mfma_f32_16x16x32_bf16 v[212:215], v[84:87], v[36:39], v[212:215]
s_add_u32 m0, s52, 77312
ds_read_b64_tr_b16 v[108:109], v23 offset:8192
ds_read_b64_tr_b16 v[110:111], v23 offset:10240
v_mfma_f32_16x16x32_bf16 v[228:231], v[84:87], v[40:43], v[228:231]
ds_read_b128 v[60:63], v127 offset:6144
v_mfma_f32_16x16x32_bf16 v[244:247], v[84:87], v[44:47], v[244:247]
s_waitcnt lgkmcnt(14)
buffer_load_dwordx4 v120, s[12:15], s49 offen offset:512 lds
v_mfma_f32_16x16x32_bf16 v[200:203], v[88:91], v[32:35], v[200:203]
s_add_u32 m0, s52, 78336
ds_read_b64_tr_b16 v[64:65], v20 offset:12288
ds_read_b64_tr_b16 v[66:67], v20 offset:14336
v_mfma_f32_16x16x32_bf16 v[216:219], v[88:91], v[36:39], v[216:219]
v_mfma_f32_16x16x32_bf16 v[232:235], v[88:91], v[40:43], v[232:235]
buffer_load_dwordx4 v121, s[12:15], s49 offen offset:512 lds
v_mfma_f32_16x16x32_bf16 v[248:251], v[88:91], v[44:47], v[248:251]
s_waitcnt lgkmcnt(14)
s_add_u32 m0, s52, 79360
v_mfma_f32_16x16x32_bf16 v[204:207], v[92:95], v[32:35], v[204:207]
s_nop 0
ds_read_b64_tr_b16 v[68:69], v21 offset:12288
ds_read_b64_tr_b16 v[70:71], v21 offset:14336
v_mfma_f32_16x16x32_bf16 v[220:223], v[92:95], v[36:39], v[220:223]
buffer_load_dwordx4 v122, s[12:15], s49 offen offset:512 lds
v_mfma_f32_16x16x32_bf16 v[236:239], v[92:95], v[40:43], v[236:239]
s_add_u32 m0, s52, 80384
v_mfma_f32_16x16x32_bf16 v[252:255], v[92:95], v[44:47], v[252:255]
s_waitcnt lgkmcnt(13)
v_mfma_f32_16x16x32_bf16 v[128:131], v[96:99], v[48:51], v[128:131]
s_waitcnt lgkmcnt(10)
buffer_load_dwordx4 v123, s[12:15], s49 offen offset:512 lds
v_mfma_f32_16x16x32_bf16 v[144:147], v[96:99], v[52:55], v[144:147]
s_waitcnt lgkmcnt(7)
ds_read_b64_tr_b16 v[72:73], v22 offset:12288
ds_read_b64_tr_b16 v[74:75], v22 offset:14336
v_mfma_f32_16x16x32_bf16 v[160:163], v[96:99], v[56:59], v[160:163]
s_waitcnt lgkmcnt(6)
s_add_u32 s49, s49, s63
s_add_u32 s49, s49, 262144
v_mfma_f32_16x16x32_bf16 v[176:179], v[96:99], v[60:63], v[176:179]
s_sub_u32 s47, s49, 3670016
s_min_u32 s49, s49, s47
s_add_u32 m0, s52, 0
v_mfma_f32_16x16x32_bf16 v[132:135], v[100:103], v[48:51], v[132:135]
buffer_load_dwordx4 v120, s[12:15], s49 offen offset:0 lds
v_mfma_f32_16x16x32_bf16 v[148:151], v[100:103], v[52:55], v[148:151]
s_waitcnt vmcnt(11)
s_barrier
ds_read_b64_tr_b16 v[76:77], v23 offset:12288
v_mfma_f32_16x16x32_bf16 v[164:167], v[100:103], v[56:59], v[164:167]
s_add_u32 m0, s52, 1024
ds_read_b64_tr_b16 v[78:79], v23 offset:14336
v_mfma_f32_16x16x32_bf16 v[180:183], v[100:103], v[60:63], v[180:183]
buffer_load_dwordx4 v121, s[12:15], s49 offen offset:0 lds
v_mfma_f32_16x16x32_bf16 v[136:139], v[104:107], v[48:51], v[136:139]
s_add_u32 m0, s52, 2048
ds_read_b64_tr_b16 v[80:81], v6 offset:0
ds_read_b64_tr_b16 v[82:83], v6 offset:2048
v_mfma_f32_16x16x32_bf16 v[152:155], v[104:107], v[52:55], v[152:155]
ds_read_b128 v[32:35], v126 offset:8192
v_mfma_f32_16x16x32_bf16 v[168:171], v[104:107], v[56:59], v[168:171]
buffer_load_dwordx4 v122, s[12:15], s49 offen offset:0 lds
v_mfma_f32_16x16x32_bf16 v[184:187], v[104:107], v[60:63], v[184:187]
s_add_u32 m0, s52, 3072
v_mfma_f32_16x16x32_bf16 v[140:143], v[108:111], v[48:51], v[140:143]
s_nop 0
ds_read_b64_tr_b16 v[84:85], v7 offset:0
ds_read_b64_tr_b16 v[86:87], v7 offset:2048
v_mfma_f32_16x16x32_bf16 v[156:159], v[108:111], v[52:55], v[156:159]
buffer_load_dwordx4 v123, s[12:15], s49 offen offset:0 lds
v_mfma_f32_16x16x32_bf16 v[172:175], v[108:111], v[56:59], v[172:175]
s_add_u32 m0, s52, 3584
ds_read_b128 v[36:39], v126 offset:10240
v_mfma_f32_16x16x32_bf16 v[188:191], v[108:111], v[60:63], v[188:191]
s_waitcnt lgkmcnt(12)
v_mfma_f32_16x16x32_bf16 v[192:195], v[64:67], v[48:51], v[192:195]
buffer_load_dwordx4 v120, s[12:15], s49 offen offset:512 lds
v_mfma_f32_16x16x32_bf16 v[208:211], v[64:67], v[52:55], v[208:211]
s_add_u32 m0, s52, 4608
ds_read_b64_tr_b16 v[88:89], v8 offset:0
ds_read_b64_tr_b16 v[90:91], v8 offset:2048
v_mfma_f32_16x16x32_bf16 v[224:227], v[64:67], v[56:59], v[224:227]
ds_read_b128 v[40:43], v126 offset:12288
v_mfma_f32_16x16x32_bf16 v[240:243], v[64:67], v[60:63], v[240:243]
s_waitcnt lgkmcnt(13)
buffer_load_dwordx4 v121, s[12:15], s49 offen offset:512 lds
v_mfma_f32_16x16x32_bf16 v[196:199], v[68:71], v[48:51], v[196:199]
s_add_u32 m0, s52, 5632
ds_read_b64_tr_b16 v[92:93], v9 offset:0
ds_read_b64_tr_b16 v[94:95], v9 offset:2048
v_mfma_f32_16x16x32_bf16 v[212:215], v[68:71], v[52:55], v[212:215]
ds_read_b128 v[44:47], v126 offset:14336
v_mfma_f32_16x16x32_bf16 v[228:231], v[68:71], v[56:59], v[228:231]
buffer_load_dwordx4 v122, s[12:15], s49 offen offset:512 lds
v_mfma_f32_16x16x32_bf16 v[244:247], v[68:71], v[60:63], v[244:247]
s_waitcnt lgkmcnt(14)
s_add_u32 m0, s52, 6656
v_mfma_f32_16x16x32_bf16 v[200:203], v[72:75], v[48:51], v[200:203]
s_nop 0
ds_read_b64_tr_b16 v[96:97], v6 offset:4096
ds_read_b64_tr_b16 v[98:99], v6 offset:6144
v_mfma_f32_16x16x32_bf16 v[216:219], v[72:75], v[52:55], v[216:219]
buffer_load_dwordx4 v123, s[12:15], s49 offen offset:512 lds
v_mfma_f32_16x16x32_bf16 v[232:235], v[72:75], v[56:59], v[232:235]
s_add_u32 s49, s49, 262144
s_sub_u32 s49, s49, s63
s_add_u32 m0, s50, 0
v_mfma_f32_16x16x32_bf16 v[248:251], v[72:75], v[60:63], v[248:251]
s_waitcnt lgkmcnt(14)
v_mfma_f32_16x16x32_bf16 v[204:207], v[76:79], v[48:51], v[204:207]
buffer_load_dwordx4 v124, s[16:19], s48 offen lds
v_mfma_f32_16x16x32_bf16 v[220:223], v[76:79], v[52:55], v[220:223]
s_add_u32 m0, s50, 4096
ds_read_b64_tr_b16 v[100:101], v7 offset:4096
ds_read_b64_tr_b16 v[102:103], v7 offset:6144
v_mfma_f32_16x16x32_bf16 v[236:239], v[76:79], v[56:59], v[236:239]
v_mfma_f32_16x16x32_bf16 v[252:255], v[76:79], v[60:63], v[252:255]
s_waitcnt lgkmcnt(13)
buffer_load_dwordx4 v125, s[16:19], s48 offen lds
v_mfma_f32_16x16x32_bf16 v[128:131], v[80:83], v[32:35], v[128:131]
s_waitcnt lgkmcnt(10)
ds_read_b64_tr_b16 v[104:105], v8 offset:4096
ds_read_b64_tr_b16 v[106:107], v8 offset:6144
v_mfma_f32_16x16x32_bf16 v[144:147], v[80:83], v[36:39], v[144:147]
s_waitcnt lgkmcnt(9)
s_add_u32 s48, s48, 128
s_sub_u32 s47, s48, 896
v_mfma_f32_16x16x32_bf16 v[160:163], v[80:83], v[40:43], v[160:163]
s_waitcnt lgkmcnt(6)
s_min_u32 s48, s48, s47
s_add_u32 m0, s52, 8192
v_mfma_f32_16x16x32_bf16 v[176:179], v[80:83], v[44:47], v[176:179]
buffer_load_dwordx4 v120, s[12:15], s49 offen offset:0 lds
v_mfma_f32_16x16x32_bf16 v[132:135], v[84:87], v[32:35], v[132:135]
s_add_u32 m0, s52, 9216
ds_read_b64_tr_b16 v[108:109], v9 offset:4096
ds_read_b64_tr_b16 v[110:111], v9 offset:6144
v_mfma_f32_16x16x32_bf16 v[148:151], v[84:87], v[36:39], v[148:151]
s_waitcnt vmcnt(11)
v_mfma_f32_16x16x32_bf16 v[164:167], v[84:87], v[40:43], v[164:167]
buffer_load_dwordx4 v121, s[12:15], s49 offen offset:0 lds
v_mfma_f32_16x16x32_bf16 v[180:183], v[84:87], v[44:47], v[180:183]
s_add_u32 m0, s52, 10240
v_mfma_f32_16x16x32_bf16 v[136:139], v[88:91], v[32:35], v[136:139]
s_nop 0
ds_read_b64_tr_b16 v[64:65], v6 offset:8192
ds_read_b64_tr_b16 v[66:67], v6 offset:10240
v_mfma_f32_16x16x32_bf16 v[152:155], v[88:91], v[36:39], v[152:155]
buffer_load_dwordx4 v122, s[12:15], s49 offen offset:0 lds
v_mfma_f32_16x16x32_bf16 v[168:171], v[88:91], v[40:43], v[168:171]
s_add_u32 m0, s52, 11264
ds_read_b128 v[48:51], v127 offset:8192
v_mfma_f32_16x16x32_bf16 v[184:187], v[88:91], v[44:47], v[184:187]
v_mfma_f32_16x16x32_bf16 v[140:143], v[92:95], v[32:35], v[140:143]
buffer_load_dwordx4 v123, s[12:15], s49 offen offset:0 lds
v_mfma_f32_16x16x32_bf16 v[156:159], v[92:95], v[36:39], v[156:159]
s_add_u32 m0, s52, 11776
ds_read_b64_tr_b16 v[68:69], v7 offset:8192
ds_read_b64_tr_b16 v[70:71], v7 offset:10240
v_mfma_f32_16x16x32_bf16 v[172:175], v[92:95], v[40:43], v[172:175]
ds_read_b128 v[52:55], v127 offset:10240
v_mfma_f32_16x16x32_bf16 v[188:191], v[92:95], v[44:47], v[188:191]
s_waitcnt lgkmcnt(12)
buffer_load_dwordx4 v120, s[12:15], s49 offen offset:512 lds
v_mfma_f32_16x16x32_bf16 v[192:195], v[96:99], v[32:35], v[192:195]
s_add_u32 m0, s52, 12800
ds_read_b64_tr_b16 v[72:73], v8 offset:8192
ds_read_b64_tr_b16 v[74:75], v8 offset:10240
v_mfma_f32_16x16x32_bf16 v[208:211], v[96:99], v[36:39], v[208:211]
ds_read_b128 v[56:59], v127 offset:12288
v_mfma_f32_16x16x32_bf16 v[224:227], v[96:99], v[40:43], v[224:227]
buffer_load_dwordx4 v121, s[12:15], s49 offen offset:512 lds
v_mfma_f32_16x16x32_bf16 v[240:243], v[96:99], v[44:47], v[240:243]
s_waitcnt lgkmcnt(13)
s_add_u32 m0, s52, 13824
v_mfma_f32_16x16x32_bf16 v[196:199], v[100:103], v[32:35], v[196:199]
s_nop 0
ds_read_b64_tr_b16 v[76:77], v9 offset:8192
ds_read_b64_tr_b16 v[78:79], v9 offset:10240
v_mfma_f32_16x16x32_bf16 v[212:215], v[100:103], v[36:39], v[212:215]
buffer_load_dwordx4 v122, s[12:15], s49 offen offset:512 lds
v_mfma_f32_16x16x32_bf16 v[228:231], v[100:103], v[40:43], v[228:231]
s_add_u32 m0, s52, 14848
ds_read_b128 v[60:63], v127 offset:14336
v_mfma_f32_16x16x32_bf16 v[244:247], v[100:103], v[44:47], v[244:247]
s_waitcnt lgkmcnt(14)
v_mfma_f32_16x16x32_bf16 v[200:203], v[104:107], v[32:35], v[200:203]
buffer_load_dwordx4 v123, s[12:15], s49 offen offset:512 lds
v_mfma_f32_16x16x32_bf16 v[216:219], v[104:107], v[36:39], v[216:219]
s_add_u32 s49, s49, s63
ds_read_b64_tr_b16 v[80:81], v6 offset:12288
ds_read_b64_tr_b16 v[82:83], v6 offset:14336
v_mfma_f32_16x16x32_bf16 v[232:235], v[104:107], v[40:43], v[232:235]
s_add_u32 s49, s49, 262144
s_sub_u32 s47, s49, 3670016
s_min_u32 s49, s49, s47
v_mfma_f32_16x16x32_bf16 v[248:251], v[104:107], v[44:47], v[248:251]
s_waitcnt lgkmcnt(14)
v_mfma_f32_16x16x32_bf16 v[204:207], v[108:111], v[32:35], v[204:207]
s_nop 0
ds_read_b64_tr_b16 v[84:85], v7 offset:12288
ds_read_b64_tr_b16 v[86:87], v7 offset:14336
v_mfma_f32_16x16x32_bf16 v[220:223], v[108:111], v[36:39], v[220:223]
v_mfma_f32_16x16x32_bf16 v[236:239], v[108:111], v[40:43], v[236:239]
v_mfma_f32_16x16x32_bf16 v[252:255], v[108:111], v[44:47], v[252:255]
s_waitcnt lgkmcnt(13)
v_mfma_f32_16x16x32_bf16 v[128:131], v[64:67], v[48:51], v[128:131]
s_waitcnt lgkmcnt(10)
ds_read_b64_tr_b16 v[88:89], v8 offset:12288
ds_read_b64_tr_b16 v[90:91], v8 offset:14336
v_mfma_f32_16x16x32_bf16 v[144:147], v[64:67], v[52:55], v[144:147]
s_waitcnt lgkmcnt(9)
s_add_u32 m0, s52, 65536
v_mfma_f32_16x16x32_bf16 v[160:163], v[64:67], v[56:59], v[160:163]
s_waitcnt lgkmcnt(6)
buffer_load_dwordx4 v120, s[12:15], s49 offen offset:0 lds
v_mfma_f32_16x16x32_bf16 v[176:179], v[64:67], v[60:63], v[176:179]
s_add_u32 m0, s52, 66560
v_mfma_f32_16x16x32_bf16 v[132:135], v[68:71], v[48:51], v[132:135]
s_nop 0
ds_read_b64_tr_b16 v[92:93], v9 offset:12288
ds_read_b64_tr_b16 v[94:95], v9 offset:14336
v_mfma_f32_16x16x32_bf16 v[148:151], v[68:71], v[52:55], v[148:151]
s_waitcnt vmcnt(11)
s_barrier
v_mfma_f32_16x16x32_bf16 v[164:167], v[68:71], v[56:59], v[164:167]
buffer_load_dwordx4 v121, s[12:15], s49 offen offset:0 lds
v_mfma_f32_16x16x32_bf16 v[180:183], v[68:71], v[60:63], v[180:183]
s_add_u32 m0, s52, 67584
v_mfma_f32_16x16x32_bf16 v[136:139], v[72:75], v[48:51], v[136:139]
s_nop 0
ds_read_b64_tr_b16 v[96:97], v20 offset:0
ds_read_b64_tr_b16 v[98:99], v20 offset:2048
v_mfma_f32_16x16x32_bf16 v[152:155], v[72:75], v[52:55], v[152:155]
buffer_load_dwordx4 v122, s[12:15], s49 offen offset:0 lds
v_mfma_f32_16x16x32_bf16 v[168:171], v[72:75], v[56:59], v[168:171]
s_add_u32 m0, s52, 68608
ds_read_b128 v[32:35], v126 offset:16384
v_mfma_f32_16x16x32_bf16 v[184:187], v[72:75], v[60:63], v[184:187]
v_mfma_f32_16x16x32_bf16 v[140:143], v[76:79], v[48:51], v[140:143]
buffer_load_dwordx4 v123, s[12:15], s49 offen offset:0 lds
v_mfma_f32_16x16x32_bf16 v[156:159], v[76:79], v[52:55], v[156:159]
s_add_u32 m0, s52, 69120
ds_read_b64_tr_b16 v[100:101], v21 offset:0
ds_read_b64_tr_b16 v[102:103], v21 offset:2048
v_mfma_f32_16x16x32_bf16 v[172:175], v[76:79], v[56:59], v[172:175]
ds_read_b128 v[36:39], v126 offset:18432
v_mfma_f32_16x16x32_bf16 v[188:191], v[76:79], v[60:63], v[188:191]
s_waitcnt lgkmcnt(12)
buffer_load_dwordx4 v120, s[12:15], s49 offen offset:512 lds
v_mfma_f32_16x16x32_bf16 v[192:195], v[80:83], v[48:51], v[192:195]
s_add_u32 m0, s52, 70144
ds_read_b64_tr_b16 v[104:105], v22 offset:0
ds_read_b64_tr_b16 v[106:107], v22 offset:2048
v_mfma_f32_16x16x32_bf16 v[208:211], v[80:83], v[52:55], v[208:211]
ds_read_b128 v[40:43], v126 offset:20480
v_mfma_f32_16x16x32_bf16 v[224:227], v[80:83], v[56:59], v[224:227]
buffer_load_dwordx4 v121, s[12:15], s49 offen offset:512 lds
v_mfma_f32_16x16x32_bf16 v[240:243], v[80:83], v[60:63], v[240:243]
s_waitcnt lgkmcnt(13)
s_add_u32 m0, s52, 71168
v_mfma_f32_16x16x32_bf16 v[196:199], v[84:87], v[48:51], v[196:199]
s_nop 0
ds_read_b64_tr_b16 v[108:109], v23 offset:0
ds_read_b64_tr_b16 v[110:111], v23 offset:2048
v_mfma_f32_16x16x32_bf16 v[212:215], v[84:87], v[52:55], v[212:215]
buffer_load_dwordx4 v122, s[12:15], s49 offen offset:512 lds
v_mfma_f32_16x16x32_bf16 v[228:231], v[84:87], v[56:59], v[228:231]
s_add_u32 m0, s52, 72192
ds_read_b128 v[44:47], v126 offset:22528
v_mfma_f32_16x16x32_bf16 v[244:247], v[84:87], v[60:63], v[244:247]
s_waitcnt lgkmcnt(14)
v_mfma_f32_16x16x32_bf16 v[200:203], v[88:91], v[48:51], v[200:203]
buffer_load_dwordx4 v123, s[12:15], s49 offen offset:512 lds
v_mfma_f32_16x16x32_bf16 v[216:219], v[88:91], v[52:55], v[216:219]
s_add_u32 s49, s49, 262144
ds_read_b64_tr_b16 v[64:65], v20 offset:4096
ds_read_b64_tr_b16 v[66:67], v20 offset:6144
v_mfma_f32_16x16x32_bf16 v[232:235], v[88:91], v[56:59], v[232:235]
s_sub_u32 s49, s49, s63
v_mfma_f32_16x16x32_bf16 v[248:251], v[88:91], v[60:63], v[248:251]
s_waitcnt lgkmcnt(14)
v_mfma_f32_16x16x32_bf16 v[204:207], v[92:95], v[48:51], v[204:207]
s_nop 0
ds_read_b64_tr_b16 v[68:69], v21 offset:4096
ds_read_b64_tr_b16 v[70:71], v21 offset:6144
v_mfma_f32_16x16x32_bf16 v[220:223], v[92:95], v[52:55], v[220:223]
v_mfma_f32_16x16x32_bf16 v[236:239], v[92:95], v[56:59], v[236:239]
v_mfma_f32_16x16x32_bf16 v[252:255], v[92:95], v[60:63], v[252:255]
s_waitcnt lgkmcnt(13)
v_mfma_f32_16x16x32_bf16 v[128:131], v[96:99], v[32:35], v[128:131]
s_waitcnt lgkmcnt(10)
ds_read_b64_tr_b16 v[72:73], v22 offset:4096
ds_read_b64_tr_b16 v[74:75], v22 offset:6144
v_mfma_f32_16x16x32_bf16 v[144:147], v[96:99], v[36:39], v[144:147]
s_waitcnt lgkmcnt(9)
s_add_u32 m0, s52, 73728
v_mfma_f32_16x16x32_bf16 v[160:163], v[96:99], v[40:43], v[160:163]
s_waitcnt lgkmcnt(6)
buffer_load_dwordx4 v120, s[12:15], s49 offen offset:0 lds
v_mfma_f32_16x16x32_bf16 v[176:179], v[96:99], v[44:47], v[176:179]
s_add_u32 m0, s52, 74752
v_mfma_f32_16x16x32_bf16 v[132:135], v[100:103], v[32:35], v[132:135]
s_nop 0
ds_read_b64_tr_b16 v[76:77], v23 offset:4096
ds_read_b64_tr_b16 v[78:79], v23 offset:6144
v_mfma_f32_16x16x32_bf16 v[148:151], v[100:103], v[36:39], v[148:151]
s_waitcnt vmcnt(9)
buffer_load_dwordx4 v121, s[12:15], s49 offen offset:0 lds
v_mfma_f32_16x16x32_bf16 v[164:167], v[100:103], v[40:43], v[164:167]
s_add_u32 m0, s52, 75776
v_mfma_f32_16x16x32_bf16 v[180:183], v[100:103], v[44:47], v[180:183]
v_mfma_f32_16x16x32_bf16 v[136:139], v[104:107], v[32:35], v[136:139]
buffer_load_dwordx4 v122, s[12:15], s49 offen offset:0 lds
v_mfma_f32_16x16x32_bf16 v[152:155], v[104:107], v[36:39], v[152:155]
s_add_u32 m0, s52, 76800
ds_read_b64_tr_b16 v[80:81], v20 offset:8192
ds_read_b64_tr_b16 v[82:83], v20 offset:10240
v_mfma_f32_16x16x32_bf16 v[168:171], v[104:107], v[40:43], v[168:171]
ds_read_b128 v[48:51], v127 offset:16384
v_mfma_f32_16x16x32_bf16 v[184:187], v[104:107], v[44:47], v[184:187]
buffer_load_dwordx4 v123, s[12:15], s49 offen offset:0 lds
v_mfma_f32_16x16x32_bf16 v[140:143], v[108:111], v[32:35], v[140:143]
s_add_u32 m0, s52, 77312
ds_read_b64_tr_b16 v[84:85], v21 offset:8192
ds_read_b64_tr_b16 v[86:87], v21 offset:10240
v_mfma_f32_16x16x32_bf16 v[156:159], v[108:111], v[36:39], v[156:159]
ds_read_b128 v[52:55], v127 offset:18432
v_mfma_f32_16x16x32_bf16 v[172:175], v[108:111], v[40:43], v[172:175]
buffer_load_dwordx4 v120, s[12:15], s49 offen offset:512 lds
v_mfma_f32_16x16x32_bf16 v[188:191], v[108:111], v[44:47], v[188:191]
s_waitcnt lgkmcnt(12)
s_add_u32 m0, s52, 78336
v_mfma_f32_16x16x32_bf16 v[192:195], v[64:67], v[32:35], v[192:195]
s_nop 0
ds_read_b64_tr_b16 v[88:89], v22 offset:8192
ds_read_b64_tr_b16 v[90:91], v22 offset:10240
v_mfma_f32_16x16x32_bf16 v[208:211], v[64:67], v[36:39], v[208:211]
buffer_load_dwordx4 v121, s[12:15], s49 offen offset:512 lds
v_mfma_f32_16x16x32_bf16 v[224:227], v[64:67], v[40:43], v[224:227]
s_add_u32 m0, s52, 79360
ds_read_b128 v[56:59], v127 offset:20480
v_mfma_f32_16x16x32_bf16 v[240:243], v[64:67], v[44:47], v[240:243]
s_waitcnt lgkmcnt(13)
v_mfma_f32_16x16x32_bf16 v[196:199], v[68:71], v[32:35], v[196:199]
buffer_load_dwordx4 v122, s[12:15], s49 offen offset:512 lds
v_mfma_f32_16x16x32_bf16 v[212:215], v[68:71], v[36:39], v[212:215]
s_add_u32 m0, s52, 80384
ds_read_b64_tr_b16 v[92:93], v23 offset:8192
ds_read_b64_tr_b16 v[94:95], v23 offset:10240
v_mfma_f32_16x16x32_bf16 v[228:231], v[68:71], v[40:43], v[228:231]
ds_read_b128 v[60:63], v127 offset:22528
v_mfma_f32_16x16x32_bf16 v[244:247], v[68:71], v[44:47], v[244:247]
s_waitcnt lgkmcnt(14)
buffer_load_dwordx4 v123, s[12:15], s49 offen offset:512 lds
v_mfma_f32_16x16x32_bf16 v[200:203], v[72:75], v[32:35], v[200:203]
s_add_u32 s49, s49, s63
ds_read_b64_tr_b16 v[96:97], v20 offset:12288
ds_read_b64_tr_b16 v[98:99], v20 offset:14336
v_mfma_f32_16x16x32_bf16 v[216:219], v[72:75], v[36:39], v[216:219]
s_add_u32 s49, s49, 262144
s_sub_u32 s47, s49, 3670016
s_min_u32 s49, s49, s47
v_mfma_f32_16x16x32_bf16 v[232:235], v[72:75], v[40:43], v[232:235]
v_mfma_f32_16x16x32_bf16 v[248:251], v[72:75], v[44:47], v[248:251]
s_waitcnt lgkmcnt(14)
v_mfma_f32_16x16x32_bf16 v[204:207], v[76:79], v[32:35], v[204:207]
s_nop 0
ds_read_b64_tr_b16 v[100:101], v21 offset:12288
ds_read_b64_tr_b16 v[102:103], v21 offset:14336
v_mfma_f32_16x16x32_bf16 v[220:223], v[76:79], v[36:39], v[220:223]
v_mfma_f32_16x16x32_bf16 v[236:239], v[76:79], v[40:43], v[236:239]
v_mfma_f32_16x16x32_bf16 v[252:255], v[76:79], v[44:47], v[252:255]
s_waitcnt lgkmcnt(13)
v_mfma_f32_16x16x32_bf16 v[128:131], v[80:83], v[48:51], v[128:131]
s_waitcnt lgkmcnt(10)
ds_read_b64_tr_b16 v[104:105], v22 offset:12288
ds_read_b64_tr_b16 v[106:107], v22 offset:14336
v_mfma_f32_16x16x32_bf16 v[144:147], v[80:83], v[52:55], v[144:147]
s_waitcnt lgkmcnt(9)
s_add_u32 m0, s35, 0
v_mfma_f32_16x16x32_bf16 v[160:163], v[80:83], v[56:59], v[160:163]
s_waitcnt lgkmcnt(6)
buffer_load_dwordx4 v1, s[4:7], s37 offen offset:0 nt lds
v_mfma_f32_16x16x32_bf16 v[176:179], v[80:83], v[60:63], v[176:179]
s_add_u32 m0, s35, 1024
v_mfma_f32_16x16x32_bf16 v[132:135], v[84:87], v[48:51], v[132:135]
s_nop 0
ds_read_b64_tr_b16 v[108:109], v23 offset:12288
ds_read_b64_tr_b16 v[110:111], v23 offset:14336
v_mfma_f32_16x16x32_bf16 v[148:151], v[84:87], v[52:55], v[148:151]
s_waitcnt vmcnt(9)
s_barrier
v_mfma_f32_16x16x32_bf16 v[164:167], v[84:87], v[56:59], v[164:167]
buffer_load_dwordx4 v2, s[4:7], s37 offen offset:0 nt lds
v_mfma_f32_16x16x32_bf16 v[180:183], v[84:87], v[60:63], v[180:183]
s_add_u32 m0, s35, 1920
v_mfma_f32_16x16x32_bf16 v[136:139], v[88:91], v[48:51], v[136:139]
s_nop 0
ds_read_b64_tr_b16 v[64:65], v6 offset:0
ds_read_b64_tr_b16 v[66:67], v6 offset:2048
v_mfma_f32_16x16x32_bf16 v[152:155], v[88:91], v[52:55], v[152:155]
buffer_load_dwordx4 v1, s[4:7], s37 offen offset:128 nt lds
v_mfma_f32_16x16x32_bf16 v[168:171], v[88:91], v[56:59], v[168:171]
s_add_u32 m0, s35, 2944
ds_read_b128 v[32:35], v126 offset:0
v_mfma_f32_16x16x32_bf16 v[184:187], v[88:91], v[60:63], v[184:187]
v_mfma_f32_16x16x32_bf16 v[140:143], v[92:95], v[48:51], v[140:143]
buffer_load_dwordx4 v2, s[4:7], s37 offen offset:128 nt lds
v_mfma_f32_16x16x32_bf16 v[156:159], v[92:95], v[52:55], v[156:159]
s_add_u32 m0, s35, 3840
ds_read_b64_tr_b16 v[68:69], v7 offset:0
ds_read_b64_tr_b16 v[70:71], v7 offset:2048
v_mfma_f32_16x16x32_bf16 v[172:175], v[92:95], v[56:59], v[172:175]
ds_read_b128 v[36:39], v126 offset:2048
v_mfma_f32_16x16x32_bf16 v[188:191], v[92:95], v[60:63], v[188:191]
s_waitcnt lgkmcnt(12)
buffer_load_dwordx4 v1, s[4:7], s37 offen offset:256 nt lds
v_mfma_f32_16x16x32_bf16 v[192:195], v[96:99], v[48:51], v[192:195]
s_add_u32 m0, s35, 4864
ds_read_b64_tr_b16 v[72:73], v8 offset:0
ds_read_b64_tr_b16 v[74:75], v8 offset:2048
v_mfma_f32_16x16x32_bf16 v[208:211], v[96:99], v[52:55], v[208:211]
ds_read_b128 v[40:43], v126 offset:4096
v_mfma_f32_16x16x32_bf16 v[224:227], v[96:99], v[56:59], v[224:227]
buffer_load_dwordx4 v2, s[4:7], s37 offen offset:256 nt lds
v_mfma_f32_16x16x32_bf16 v[240:243], v[96:99], v[60:63], v[240:243]
s_waitcnt lgkmcnt(13)
s_add_u32 m0, s35, 5760
v_mfma_f32_16x16x32_bf16 v[196:199], v[100:103], v[48:51], v[196:199]
s_nop 0
ds_read_b64_tr_b16 v[76:77], v9 offset:0
ds_read_b64_tr_b16 v[78:79], v9 offset:2048
v_mfma_f32_16x16x32_bf16 v[212:215], v[100:103], v[52:55], v[212:215]
buffer_load_dwordx4 v1, s[4:7], s37 offen offset:384 nt lds
v_mfma_f32_16x16x32_bf16 v[228:231], v[100:103], v[56:59], v[228:231]
s_add_u32 m0, s35, 6784
ds_read_b128 v[44:47], v126 offset:6144
v_mfma_f32_16x16x32_bf16 v[244:247], v[100:103], v[60:63], v[244:247]
s_waitcnt lgkmcnt(14)
v_mfma_f32_16x16x32_bf16 v[200:203], v[104:107], v[48:51], v[200:203]
buffer_load_dwordx4 v2, s[4:7], s37 offen offset:384 nt lds
v_mfma_f32_16x16x32_bf16 v[216:219], v[104:107], v[52:55], v[216:219]
s_add_u32 s37, s37, 32768
ds_read_b64_tr_b16 v[80:81], v6 offset:4096
ds_read_b64_tr_b16 v[82:83], v6 offset:6144
v_mfma_f32_16x16x32_bf16 v[232:235], v[104:107], v[56:59], v[232:235]
s_xor_b32 s35, s35, 8192
v_mfma_f32_16x16x32_bf16 v[248:251], v[104:107], v[60:63], v[248:251]
s_waitcnt lgkmcnt(14)
v_mfma_f32_16x16x32_bf16 v[204:207], v[108:111], v[48:51], v[204:207]
s_nop 0
ds_read_b64_tr_b16 v[84:85], v7 offset:4096
ds_read_b64_tr_b16 v[86:87], v7 offset:6144
v_mfma_f32_16x16x32_bf16 v[220:223], v[108:111], v[52:55], v[220:223]
v_mfma_f32_16x16x32_bf16 v[236:239], v[108:111], v[56:59], v[236:239]
v_mfma_f32_16x16x32_bf16 v[252:255], v[108:111], v[60:63], v[252:255]
s_waitcnt lgkmcnt(13)
v_mfma_f32_16x16x32_bf16 v[128:131], v[64:67], v[32:35], v[128:131]
s_waitcnt lgkmcnt(10)
ds_read_b64_tr_b16 v[88:89], v8 offset:4096
ds_read_b64_tr_b16 v[90:91], v8 offset:6144
v_mfma_f32_16x16x32_bf16 v[144:147], v[64:67], v[36:39], v[144:147]
s_waitcnt lgkmcnt(9)
s_add_u32 m0, s35, 0
v_mfma_f32_16x16x32_bf16 v[160:163], v[64:67], v[40:43], v[160:163]
s_waitcnt lgkmcnt(6)
buffer_load_dwordx4 v1, s[4:7], s37 offen offset:0 nt lds
v_mfma_f32_16x16x32_bf16 v[176:179], v[64:67], v[44:47], v[176:179]
s_add_u32 m0, s35, 1024
v_mfma_f32_16x16x32_bf16 v[132:135], v[68:71], v[32:35], v[132:135]
s_nop 0
ds_read_b64_tr_b16 v[92:93], v9 offset:4096
ds_read_b64_tr_b16 v[94:95], v9 offset:6144
v_mfma_f32_16x16x32_bf16 v[148:151], v[68:71], v[36:39], v[148:151]
s_waitcnt vmcnt(9)
buffer_load_dwordx4 v2, s[4:7], s37 offen offset:0 nt lds
v_mfma_f32_16x16x32_bf16 v[164:167], v[68:71], v[40:43], v[164:167]
s_add_u32 m0, s35, 1920
v_mfma_f32_16x16x32_bf16 v[180:183], v[68:71], v[44:47], v[180:183]
v_mfma_f32_16x16x32_bf16 v[136:139], v[72:75], v[32:35], v[136:139]
buffer_load_dwordx4 v1, s[4:7], s37 offen offset:128 nt lds
v_mfma_f32_16x16x32_bf16 v[152:155], v[72:75], v[36:39], v[152:155]
s_add_u32 m0, s35, 2944
ds_read_b64_tr_b16 v[96:97], v6 offset:8192
ds_read_b64_tr_b16 v[98:99], v6 offset:10240
v_mfma_f32_16x16x32_bf16 v[168:171], v[72:75], v[40:43], v[168:171]
ds_read_b128 v[48:51], v127 offset:0
v_mfma_f32_16x16x32_bf16 v[184:187], v[72:75], v[44:47], v[184:187]
buffer_load_dwordx4 v2, s[4:7], s37 offen offset:128 nt lds
v_mfma_f32_16x16x32_bf16 v[140:143], v[76:79], v[32:35], v[140:143]
s_add_u32 m0, s35, 3840
ds_read_b64_tr_b16 v[100:101], v7 offset:8192
ds_read_b64_tr_b16 v[102:103], v7 offset:10240
v_mfma_f32_16x16x32_bf16 v[156:159], v[76:79], v[36:39], v[156:159]
ds_read_b128 v[52:55], v127 offset:2048
v_mfma_f32_16x16x32_bf16 v[172:175], v[76:79], v[40:43], v[172:175]
buffer_load_dwordx4 v1, s[4:7], s37 offen offset:256 nt lds
v_mfma_f32_16x16x32_bf16 v[188:191], v[76:79], v[44:47], v[188:191]
s_waitcnt lgkmcnt(12)
s_add_u32 m0, s35, 4864
v_mfma_f32_16x16x32_bf16 v[192:195], v[80:83], v[32:35], v[192:195]
s_nop 0
ds_read_b64_tr_b16 v[104:105], v8 offset:8192
ds_read_b64_tr_b16 v[106:107], v8 offset:10240
v_mfma_f32_16x16x32_bf16 v[208:211], v[80:83], v[36:39], v[208:211]
buffer_load_dwordx4 v2, s[4:7], s37 offen offset:256 nt lds
v_mfma_f32_16x16x32_bf16 v[224:227], v[80:83], v[40:43], v[224:227]
s_add_u32 m0, s35, 5760
ds_read_b128 v[56:59], v127 offset:4096
v_mfma_f32_16x16x32_bf16 v[240:243], v[80:83], v[44:47], v[240:243]
s_waitcnt lgkmcnt(13)
v_mfma_f32_16x16x32_bf16 v[196:199], v[84:87], v[32:35], v[196:199]
buffer_load_dwordx4 v1, s[4:7], s37 offen offset:384 nt lds
v_mfma_f32_16x16x32_bf16 v[212:215], v[84:87], v[36:39], v[212:215]
s_add_u32 m0, s35, 6784
ds_read_b64_tr_b16 v[108:109], v9 offset:8192
ds_read_b64_tr_b16 v[110:111], v9 offset:10240
v_mfma_f32_16x16x32_bf16 v[228:231], v[84:87], v[40:43], v[228:231]
ds_read_b128 v[60:63], v127 offset:6144
v_mfma_f32_16x16x32_bf16 v[244:247], v[84:87], v[44:47], v[244:247]
s_waitcnt lgkmcnt(14)
buffer_load_dwordx4 v2, s[4:7], s37 offen offset:384 nt lds
v_mfma_f32_16x16x32_bf16 v[200:203], v[88:91], v[32:35], v[200:203]
s_add_u32 s37, s37, 32768
ds_read_b64_tr_b16 v[64:65], v6 offset:12288
ds_read_b64_tr_b16 v[66:67], v6 offset:14336
v_mfma_f32_16x16x32_bf16 v[216:219], v[88:91], v[36:39], v[216:219]
s_xor_b32 s35, s35, 8192
v_mfma_f32_16x16x32_bf16 v[232:235], v[88:91], v[40:43], v[232:235]
v_mfma_f32_16x16x32_bf16 v[248:251], v[88:91], v[44:47], v[248:251]
s_waitcnt lgkmcnt(14)
v_mfma_f32_16x16x32_bf16 v[204:207], v[92:95], v[32:35], v[204:207]
s_nop 0
ds_read_b64_tr_b16 v[68:69], v7 offset:12288
ds_read_b64_tr_b16 v[70:71], v7 offset:14336
v_mfma_f32_16x16x32_bf16 v[220:223], v[92:95], v[36:39], v[220:223]
v_mfma_f32_16x16x32_bf16 v[236:239], v[92:95], v[40:43], v[236:239]
v_mfma_f32_16x16x32_bf16 v[252:255], v[92:95], v[44:47], v[252:255]
s_waitcnt lgkmcnt(13)
v_mfma_f32_16x16x32_bf16 v[128:131], v[96:99], v[48:51], v[128:131]
s_waitcnt lgkmcnt(10)
ds_read_b64_tr_b16 v[72:73], v8 offset:12288
ds_read_b64_tr_b16 v[74:75], v8 offset:14336
v_mfma_f32_16x16x32_bf16 v[144:147], v[96:99], v[52:55], v[144:147]
s_waitcnt lgkmcnt(9)
s_add_u32 m0, s36, 0
s_add_u32 s44, s38, 0
v_mfma_f32_16x16x32_bf16 v[160:163], v[96:99], v[56:59], v[160:163]
s_waitcnt lgkmcnt(6)
buffer_load_dwordx4 v3, s[8:11], s44 offen nt lds
v_mfma_f32_16x16x32_bf16 v[176:179], v[96:99], v[60:63], v[176:179]
s_add_u32 m0, s36, 1024
v_pk_mul_f32 v[128:129], v[128:129], s[54:55]
v_pk_mul_f32 v[130:131], v[130:131], s[54:55]
v_mfma_f32_16x16x32_bf16 v[132:135], v[100:103], v[48:51], v[132:135]
s_add_u32 s44, s38, 4096
ds_read_b64_tr_b16 v[76:77], v9 offset:12288
ds_read_b64_tr_b16 v[78:79], v9 offset:14336
v_mfma_f32_16x16x32_bf16 v[148:151], v[100:103], v[52:55], v[148:151]
buffer_load_dwordx4 v3, s[8:11], s44 offen nt lds
v_mfma_f32_16x16x32_bf16 v[164:167], v[100:103], v[56:59], v[164:167]
s_add_u32 m0, s36, 2048
v_cvt_pk_bf16_f32 v128, v128, v129
v_cvt_pk_bf16_f32 v129, v130, v131
v_mfma_f32_16x16x32_bf16 v[180:183], v[100:103], v[60:63], v[180:183]
s_add_u32 s44, s38, 8192
v_pk_mul_f32 v[144:145], v[144:145], s[54:55]
v_pk_mul_f32 v[146:147], v[146:147], s[54:55]
v_mfma_f32_16x16x32_bf16 v[136:139], v[104:107], v[48:51], v[136:139]
buffer_load_dwordx4 v3, s[8:11], s44 offen nt lds
v_mfma_f32_16x16x32_bf16 v[152:155], v[104:107], v[52:55], v[152:155]
s_add_u32 m0, s36, 3072
v_cvt_pk_bf16_f32 v144, v144, v145
v_cvt_pk_bf16_f32 v145, v146, v147
v_mfma_f32_16x16x32_bf16 v[168:171], v[104:107], v[56:59], v[168:171]
s_add_u32 s44, s38, 12288
v_pk_mul_f32 v[160:161], v[160:161], s[54:55]
v_pk_mul_f32 v[162:163], v[162:163], s[54:55]
v_mfma_f32_16x16x32_bf16 v[184:187], v[104:107], v[60:63], v[184:187]
buffer_load_dwordx4 v3, s[8:11], s44 offen nt lds
v_mfma_f32_16x16x32_bf16 v[140:143], v[108:111], v[48:51], v[140:143]
s_add_u32 m0, s36, 4096
v_cvt_pk_bf16_f32 v160, v160, v161
v_cvt_pk_bf16_f32 v161, v162, v163
v_mfma_f32_16x16x32_bf16 v[156:159], v[108:111], v[52:55], v[156:159]
s_add_u32 s44, s38, 16384
v_pk_mul_f32 v[176:177], v[176:177], s[54:55]
v_pk_mul_f32 v[178:179], v[178:179], s[54:55]
v_mfma_f32_16x16x32_bf16 v[172:175], v[108:111], v[56:59], v[172:175]
buffer_load_dwordx4 v3, s[8:11], s44 offen nt lds
v_mfma_f32_16x16x32_bf16 v[188:191], v[108:111], v[60:63], v[188:191]
s_waitcnt lgkmcnt(6)
v_cvt_pk_bf16_f32 v176, v176, v177
v_cvt_pk_bf16_f32 v177, v178, v179
v_mfma_f32_16x16x32_bf16 v[192:195], v[64:67], v[48:51], v[192:195]
s_add_u32 m0, s36, 5120
v_pk_mul_f32 v[132:133], v[132:133], s[54:55]
v_pk_mul_f32 v[134:135], v[134:135], s[54:55]
v_mfma_f32_16x16x32_bf16 v[208:211], v[64:67], v[52:55], v[208:211]
s_add_u32 s44, s38, 20480
buffer_load_dwordx4 v3, s[8:11], s44 offen nt lds
v_mfma_f32_16x16x32_bf16 v[224:227], v[64:67], v[56:59], v[224:227]
s_add_u32 m0, s36, 6144
v_cvt_pk_bf16_f32 v132, v132, v133
v_cvt_pk_bf16_f32 v133, v134, v135
v_mfma_f32_16x16x32_bf16 v[240:243], v[64:67], v[60:63], v[240:243]
s_waitcnt lgkmcnt(4)
v_pk_mul_f32 v[148:149], v[148:149], s[54:55]
v_pk_mul_f32 v[150:151], v[150:151], s[54:55]
v_mfma_f32_16x16x32_bf16 v[196:199], v[68:71], v[48:51], v[196:199]
s_add_u32 s44, s38, 24576
buffer_load_dwordx4 v3, s[8:11], s44 offen nt lds
v_mfma_f32_16x16x32_bf16 v[212:215], v[68:71], v[52:55], v[212:215]
s_add_u32 m0, s36, 7168
v_cvt_pk_bf16_f32 v148, v148, v149
v_cvt_pk_bf16_f32 v149, v150, v151
v_mfma_f32_16x16x32_bf16 v[228:231], v[68:71], v[56:59], v[228:231]
s_add_u32 s44, s38, 28672
v_pk_mul_f32 v[164:165], v[164:165], s[54:55]
v_pk_mul_f32 v[166:167], v[166:167], s[54:55]
v_mfma_f32_16x16x32_bf16 v[244:247], v[68:71], v[60:63], v[244:247]
s_waitcnt lgkmcnt(2)
buffer_load_dwordx4 v3, s[8:11], s44 offen nt lds
v_mfma_f32_16x16x32_bf16 v[200:203], v[72:75], v[48:51], v[200:203]
s_add_u32 s38, s38, 32768
v_cvt_pk_bf16_f32 v164, v164, v165
v_cvt_pk_bf16_f32 v165, v166, v167
v_mfma_f32_16x16x32_bf16 v[216:219], v[72:75], v[52:55], v[216:219]
s_xor_b32 s36, s36, 8192
v_pk_mul_f32 v[180:181], v[180:181], s[54:55]
v_pk_mul_f32 v[182:183], v[182:183], s[54:55]
v_mfma_f32_16x16x32_bf16 v[232:235], v[72:75], v[56:59], v[232:235]
v_cvt_pk_bf16_f32 v180, v180, v181
v_cvt_pk_bf16_f32 v181, v182, v183
v_mfma_f32_16x16x32_bf16 v[248:251], v[72:75], v[60:63], v[248:251]
s_waitcnt lgkmcnt(0)
v_pk_mul_f32 v[136:137], v[136:137], s[54:55]
v_pk_mul_f32 v[138:139], v[138:139], s[54:55]
v_mfma_f32_16x16x32_bf16 v[204:207], v[76:79], v[48:51], v[204:207]
v_cvt_pk_bf16_f32 v136, v136, v137
v_cvt_pk_bf16_f32 v137, v138, v139
v_mfma_f32_16x16x32_bf16 v[220:223], v[76:79], v[52:55], v[220:223]
v_pk_mul_f32 v[152:153], v[152:153], s[54:55]
v_pk_mul_f32 v[154:155], v[154:155], s[54:55]
v_mfma_f32_16x16x32_bf16 v[236:239], v[76:79], v[56:59], v[236:239]
v_cvt_pk_bf16_f32 v152, v152, v153
v_cvt_pk_bf16_f32 v153, v154, v155
v_mfma_f32_16x16x32_bf16 v[252:255], v[76:79], v[60:63], v[252:255]
v_pk_mul_f32 v[168:169], v[168:169], s[54:55]
v_pk_mul_f32 v[170:171], v[170:171], s[54:55]
s_waitcnt lgkmcnt(0)
s_barrier
s_waitcnt vmcnt(16)
ds_read_b128 a[224:227], v4 offset:0
ds_read_b128 a[228:231], v5 offset:0
ds_read_b128 a[232:235], v4 offset:2048
ds_read_b128 a[236:239], v5 offset:2048
ds_read_b128 a[240:243], v4 offset:4096
ds_read_b128 a[244:247], v5 offset:4096
ds_read_b128 a[248:251], v4 offset:6144
ds_read_b128 a[252:255], v5 offset:6144
v_xor_b32 v4, 8192, v4
v_xor_b32 v5, 8192, v5
v_cvt_pk_bf16_f32 v168, v168, v169
v_cvt_pk_bf16_f32 v169, v170, v171
v_pk_mul_f32 v[184:185], v[184:185], s[54:55]
v_pk_mul_f32 v[186:187], v[186:187], s[54:55]
v_cvt_pk_bf16_f32 v184, v184, v185
v_cvt_pk_bf16_f32 v185, v186, v187
v_pk_mul_f32 v[140:141], v[140:141], s[54:55]
v_pk_mul_f32 v[142:143], v[142:143], s[54:55]
v_cvt_pk_bf16_f32 v140, v140, v141
v_cvt_pk_bf16_f32 v141, v142, v143
v_pk_mul_f32 v[156:157], v[156:157], s[54:55]
v_pk_mul_f32 v[158:159], v[158:159], s[54:55]
v_cvt_pk_bf16_f32 v156, v156, v157
v_cvt_pk_bf16_f32 v157, v158, v159
v_pk_mul_f32 v[172:173], v[172:173], s[54:55]
v_pk_mul_f32 v[174:175], v[174:175], s[54:55]
v_cvt_pk_bf16_f32 v172, v172, v173
v_cvt_pk_bf16_f32 v173, v174, v175
v_pk_mul_f32 v[188:189], v[188:189], s[54:55]
v_pk_mul_f32 v[190:191], v[190:191], s[54:55]
v_cvt_pk_bf16_f32 v188, v188, v189
v_cvt_pk_bf16_f32 v189, v190, v191
v_pk_mul_f32 v[192:193], v[192:193], s[54:55]
v_pk_mul_f32 v[194:195], v[194:195], s[54:55]
v_cvt_pk_bf16_f32 v192, v192, v193
v_cvt_pk_bf16_f32 v193, v194, v195
v_pk_mul_f32 v[208:209], v[208:209], s[54:55]
v_pk_mul_f32 v[210:211], v[210:211], s[54:55]
v_cvt_pk_bf16_f32 v208, v208, v209
v_cvt_pk_bf16_f32 v209, v210, v211
v_pk_mul_f32 v[224:225], v[224:225], s[54:55]
v_pk_mul_f32 v[226:227], v[226:227], s[54:55]
v_cvt_pk_bf16_f32 v224, v224, v225
v_cvt_pk_bf16_f32 v225, v226, v227
v_pk_mul_f32 v[240:241], v[240:241], s[54:55]
v_pk_mul_f32 v[242:243], v[242:243], s[54:55]
v_cvt_pk_bf16_f32 v240, v240, v241
v_cvt_pk_bf16_f32 v241, v242, v243
v_pk_mul_f32 v[196:197], v[196:197], s[54:55]
v_pk_mul_f32 v[198:199], v[198:199], s[54:55]
v_cvt_pk_bf16_f32 v196, v196, v197
v_cvt_pk_bf16_f32 v197, v198, v199
v_pk_mul_f32 v[212:213], v[212:213], s[54:55]
v_pk_mul_f32 v[214:215], v[214:215], s[54:55]
v_cvt_pk_bf16_f32 v212, v212, v213
v_cvt_pk_bf16_f32 v213, v214, v215
v_pk_mul_f32 v[228:229], v[228:229], s[54:55]
v_pk_mul_f32 v[230:231], v[230:231], s[54:55]
v_cvt_pk_bf16_f32 v228, v228, v229
v_cvt_pk_bf16_f32 v229, v230, v231
v_pk_mul_f32 v[244:245], v[244:245], s[54:55]
v_pk_mul_f32 v[246:247], v[246:247], s[54:55]
v_cvt_pk_bf16_f32 v244, v244, v245
v_cvt_pk_bf16_f32 v245, v246, v247
v_pk_mul_f32 v[200:201], v[200:201], s[54:55]
v_pk_mul_f32 v[202:203], v[202:203], s[54:55]
v_cvt_pk_bf16_f32 v200, v200, v201
v_cvt_pk_bf16_f32 v201, v202, v203
v_pk_mul_f32 v[216:217], v[216:217], s[54:55]
v_pk_mul_f32 v[218:219], v[218:219], s[54:55]
v_cvt_pk_bf16_f32 v216, v216, v217
v_cvt_pk_bf16_f32 v217, v218, v219
v_pk_mul_f32 v[232:233], v[232:233], s[54:55]
v_pk_mul_f32 v[234:235], v[234:235], s[54:55]
v_cvt_pk_bf16_f32 v232, v232, v233
v_cvt_pk_bf16_f32 v233, v234, v235
v_pk_mul_f32 v[248:249], v[248:249], s[54:55]
v_pk_mul_f32 v[250:251], v[250:251], s[54:55]
v_cvt_pk_bf16_f32 v248, v248, v249
v_cvt_pk_bf16_f32 v249, v250, v251
v_pk_mul_f32 v[204:205], v[204:205], s[54:55]
v_pk_mul_f32 v[206:207], v[206:207], s[54:55]
v_cvt_pk_bf16_f32 v204, v204, v205
v_cvt_pk_bf16_f32 v205, v206, v207
v_pk_mul_f32 v[220:221], v[220:221], s[54:55]
v_pk_mul_f32 v[222:223], v[222:223], s[54:55]
v_cvt_pk_bf16_f32 v220, v220, v221
v_cvt_pk_bf16_f32 v221, v222, v223
v_pk_mul_f32 v[236:237], v[236:237], s[54:55]
v_pk_mul_f32 v[238:239], v[238:239], s[54:55]
v_cvt_pk_bf16_f32 v236, v236, v237
v_cvt_pk_bf16_f32 v237, v238, v239
v_pk_mul_f32 v[252:253], v[252:253], s[54:55]
v_pk_mul_f32 v[254:255], v[254:255], s[54:55]
v_cvt_pk_bf16_f32 v252, v252, v253
v_cvt_pk_bf16_f32 v253, v254, v255
s_waitcnt lgkmcnt(0)
ds_write_b64 v24, v[128:129] offset:0
ds_write_b64 v24, v[132:133] offset:512
ds_write_b64 v24, v[136:137] offset:1024
ds_write_b64 v24, v[140:141] offset:1536
s_add_u32 m0, s35, 0
s_nop 0
buffer_load_dwordx4 v1, s[4:7], s37 offen offset:0 nt lds
ds_write_b64 v24, v[144:145] offset:16384
ds_write_b64 v24, v[148:149] offset:16896
ds_write_b64 v24, v[152:153] offset:17408
ds_write_b64 v24, v[156:157] offset:17920
s_add_u32 m0, s35, 1024
s_nop 0
buffer_load_dwordx4 v2, s[4:7], s37 offen offset:0 nt lds
ds_write_b64 v24, v[160:161] offset:32768
ds_write_b64 v24, v[164:165] offset:33280
ds_write_b64 v24, v[168:169] offset:33792
ds_write_b64 v24, v[172:173] offset:34304
s_add_u32 m0, s35, 1920
s_nop 0
buffer_load_dwordx4 v1, s[4:7], s37 offen offset:128 nt lds
ds_write_b64 v25, v[176:177] offset:49152
ds_write_b64 v25, v[180:181] offset:49664
ds_write_b64 v25, v[184:185] offset:50176
s_waitcnt lgkmcnt(8)
ds_write_b64 v25, v[188:189] offset:50688
s_add_u32 m0, s35, 2944
s_nop 0
buffer_load_dwordx4 v2, s[4:7], s37 offen offset:128 nt lds
ds_write_b64 v27, v[192:193] offset:0
ds_write_b64 v27, v[196:197] offset:512
ds_write_b64 v27, v[200:201] offset:1024
ds_write_b64 v27, v[204:205] offset:1536
s_add_u32 m0, s35, 3840
s_nop 0
buffer_load_dwordx4 v1, s[4:7], s37 offen offset:256 nt lds
ds_write_b64 v27, v[208:209] offset:8192
ds_write_b64 v27, v[212:213] offset:8704
s_waitcnt lgkmcnt(8)
ds_write_b64 v27, v[216:217] offset:9216
ds_write_b64 v27, v[220:221] offset:9728
s_add_u32 m0, s35, 4864
s_nop 0
buffer_load_dwordx4 v2, s[4:7], s37 offen offset:256 nt lds
ds_write_b64 v27, v[224:225] offset:16384
ds_write_b64 v27, v[228:229] offset:16896
ds_write_b64 v27, v[232:233] offset:17408
ds_write_b64 v27, v[236:237] offset:17920
s_add_u32 m0, s35, 5760
s_nop 0
buffer_load_dwordx4 v1, s[4:7], s37 offen offset:384 nt lds
ds_write_b64 v26, v[240:241] offset:49152
s_waitcnt lgkmcnt(8)
ds_write_b64 v26, v[244:245] offset:49664
ds_write_b64 v26, v[248:249] offset:50176
ds_write_b64 v26, v[252:253] offset:50688
s_add_u32 m0, s35, 6784
s_nop 0
buffer_load_dwordx4 v2, s[4:7], s37 offen offset:384 nt lds
s_add_u32 s37, s37, 32768
s_xor_b32 s35, s35, 8192
v_lshlrev_b32 v15, 4, v0
v_add_u32 v15, 73728, v15
v_mov_b32 v32, 0
v_mov_b32 v33, 0
v_mov_b32 v34, 0
v_mov_b32 v35, 0
v_mov_b32 v36, 0
v_mov_b32 v37, 0
v_mov_b32 v38, 0
v_mov_b32 v39, 0
v_mov_b32 v40, 0
v_mov_b32 v41, 0
v_mov_b32 v42, 0
v_mov_b32 v43, 0
v_mov_b32 v44, 0
v_mov_b32 v45, 0
v_mov_b32 v46, 0
v_mov_b32 v47, 0
v_mov_b32 v48, 0
v_mov_b32 v49, 0
v_mov_b32 v50, 0
v_mov_b32 v51, 0
v_mov_b32 v52, 0
v_mov_b32 v53, 0
v_mov_b32 v54, 0
v_mov_b32 v55, 0
v_mov_b32 v56, 0
v_mov_b32 v57, 0
v_mov_b32 v58, 0
v_mov_b32 v59, 0
s_bfe_u32 s48, s33, 0x40003
s_mul_i32 s48, s48, 28672
s_mul_i32 s44, s32, 256
s_add_u32 s48, s48, s44
s_mov_b32 s41, 99
s_waitcnt lgkmcnt(0)
v_mov_b32 v24, 0
v_mov_b32 v25, 0
v_mov_b32 v26, 0
v_mov_b32 v27, 0
v_mov_b32 v28, 0
v_mov_b32 v29, 0
v_mov_b32 v30, 0
s_barrier
ds_read_b128 a[0:3], v15 offset:0
ds_read_b128 a[4:7], v15 offset:1024
ds_read_b128 a[8:11], v15 offset:2048
ds_read_b128 a[12:15], v15 offset:3072
ds_read_b128 a[16:19], v15 offset:4096
ds_read_b128 a[20:23], v15 offset:5120
ds_read_b128 a[24:27], v15 offset:6144
ds_read_b128 a[28:31], v15 offset:7168
ds_read_b128 a[32:35], v15 offset:16384
ds_read_b128 a[36:39], v15 offset:17408
ds_read_b128 a[40:43], v15 offset:18432
ds_read_b128 a[44:47], v15 offset:19456
s_waitcnt lgkmcnt(11)
v_mfma_f32_16x16x32_bf16 v[60:63], a[224:227], a[0:3], v[32:35]
s_waitcnt lgkmcnt(10)
ds_read_b128 a[48:51], v15 offset:20480
v_mfma_f32_16x16x32_bf16 v[60:63], a[228:231], a[4:7], v[60:63]
s_waitcnt lgkmcnt(10)
ds_read_b128 a[52:55], v15 offset:21504
v_mfma_f32_16x16x32_bf16 v[60:63], a[232:235], a[8:11], v[60:63]
s_waitcnt lgkmcnt(10)
ds_read_b128 a[56:59], v15 offset:22528
v_mfma_f32_16x16x32_bf16 v[60:63], a[236:239], a[12:15], v[60:63]
s_waitcnt lgkmcnt(7)
ds_read_b128 a[60:63], v15 offset:23552
v_mfma_f32_16x16x32_bf16 v[60:63], a[240:243], a[16:19], v[60:63]
ds_read_b128 a[64:67], v15 offset:32768
v_mfma_f32_16x16x32_bf16 v[60:63], a[244:247], a[20:23], v[60:63]
ds_read_b128 a[68:71], v15 offset:33792
v_mfma_f32_16x16x32_bf16 v[60:63], a[248:251], a[24:27], v[60:63]
ds_read_b128 a[72:75], v15 offset:34816
v_mfma_f32_16x16x32_bf16 v[60:63], a[252:255], a[28:31], v[60:63]
s_waitcnt lgkmcnt(7)
ds_read_b128 a[76:79], v15 offset:35840
v_mfma_f32_16x16x32_bf16 v[64:67], a[224:227], a[32:35], v[36:39]
ds_read_b128 a[80:83], v15 offset:36864
v_mfma_f32_16x16x32_bf16 v[64:67], a[228:231], a[36:39], v[64:67]
ds_read_b128 a[84:87], v15 offset:37888
v_mfma_f32_16x16x32_bf16 v[64:67], a[232:235], a[40:43], v[64:67]
ds_read_b128 a[88:91], v15 offset:38912
v_mfma_f32_16x16x32_bf16 v[64:67], a[236:239], a[44:47], v[64:67]
s_waitcnt lgkmcnt(7)
ds_read_b128 a[92:95], v15 offset:39936
v_mfma_f32_16x16x32_bf16 v[64:67], a[240:243], a[48:51], v[64:67]
ds_read_b128 a[96:99], v15 offset:49152
v_mfma_f32_16x16x32_bf16 v[64:67], a[244:247], a[52:55], v[64:67]
ds_read_b128 a[100:103], v15 offset:50176
v_mfma_f32_16x16x32_bf16 v[64:67], a[248:251], a[56:59], v[64:67]
ds_read_b128 a[104:107], v15 offset:51200
v_mfma_f32_16x16x32_bf16 v[64:67], a[252:255], a[60:63], v[64:67]
s_waitcnt lgkmcnt(7)
ds_read_b128 a[108:111], v15 offset:52224
v_mfma_f32_16x16x32_bf16 v[68:71], a[224:227], a[64:67], v[40:43]
ds_read_b128 a[112:115], v15 offset:53248
v_mfma_f32_16x16x32_bf16 v[68:71], a[228:231], a[68:71], v[68:71]
ds_read_b128 a[116:119], v15 offset:54272
v_mfma_f32_16x16x32_bf16 v[68:71], a[232:235], a[72:75], v[68:71]
ds_read_b128 a[120:123], v15 offset:55296
v_mfma_f32_16x16x32_bf16 v[68:71], a[236:239], a[76:79], v[68:71]
s_waitcnt lgkmcnt(7)
ds_read_b128 a[124:127], v15 offset:56320
v_mfma_f32_16x16x32_bf16 v[68:71], a[240:243], a[80:83], v[68:71]
ds_read_b128 a[128:131], v10 offset:0
v_mfma_f32_16x16x32_bf16 v[68:71], a[244:247], a[84:87], v[68:71]
ds_read_b128 a[132:135], v10 offset:1024
v_mfma_f32_16x16x32_bf16 v[68:71], a[248:251], a[88:91], v[68:71]
ds_read_b128 a[136:139], v10 offset:2048
v_mfma_f32_16x16x32_bf16 v[68:71], a[252:255], a[92:95], v[68:71]
s_waitcnt lgkmcnt(7)
ds_read_b128 a[140:143], v10 offset:3072
v_mfma_f32_16x16x32_bf16 v[72:75], a[224:227], a[96:99], v[44:47]
ds_read_b128 a[144:147], v10 offset:4096
v_mfma_f32_16x16x32_bf16 v[72:75], a[228:231], a[100:103], v[72:75]
ds_read_b128 a[148:151], v10 offset:5120
v_mfma_f32_16x16x32_bf16 v[72:75], a[232:235], a[104:107], v[72:75]
ds_read_b128 a[152:155], v10 offset:6144
v_mfma_f32_16x16x32_bf16 v[72:75], a[236:239], a[108:111], v[72:75]
s_waitcnt lgkmcnt(7)
ds_read_b128 a[156:159], v10 offset:7168
v_mfma_f32_16x16x32_bf16 v[72:75], a[240:243], a[112:115], v[72:75]
ds_read_b128 a[160:163], v10 offset:8192
v_mfma_f32_16x16x32_bf16 v[72:75], a[244:247], a[116:119], v[72:75]
ds_read_b128 a[164:167], v10 offset:9216
v_mfma_f32_16x16x32_bf16 v[72:75], a[248:251], a[120:123], v[72:75]
ds_read_b128 a[168:171], v10 offset:10240
v_mfma_f32_16x16x32_bf16 v[72:75], a[252:255], a[124:127], v[72:75]
s_waitcnt lgkmcnt(7)
ds_read_b128 a[172:175], v10 offset:11264
v_mfma_f32_16x16x32_bf16 v[76:79], a[224:227], a[128:131], v[48:51]
s_barrier
ds_read_b128 a[176:179], v10 offset:12288
v_mfma_f32_16x16x32_bf16 v[76:79], a[228:231], a[132:135], v[76:79]
s_add_u32 m0, s36, 0
ds_read_b128 a[180:183], v10 offset:13312
s_add_u32 s44, s38, 0
v_mfma_f32_16x16x32_bf16 v[76:79], a[232:235], a[136:139], v[76:79]
ds_read_b128 a[184:187], v10 offset:14336
v_mfma_f32_16x16x32_bf16 v[76:79], a[236:239], a[140:143], v[76:79]
s_waitcnt lgkmcnt(7)
ds_read_b128 a[188:191], v10 offset:15360
v_mfma_f32_16x16x32_bf16 v[76:79], a[240:243], a[144:147], v[76:79]
ds_read_b128 a[192:195], v10 offset:16384
v_mfma_f32_16x16x32_bf16 v[76:79], a[244:247], a[148:151], v[76:79]
ds_read_b128 a[196:199], v10 offset:17408
v_mfma_f32_16x16x32_bf16 v[76:79], a[248:251], a[152:155], v[76:79]
ds_read_b128 a[200:203], v10 offset:18432
v_mfma_f32_16x16x32_bf16 v[76:79], a[252:255], a[156:159], v[76:79]
s_waitcnt lgkmcnt(7)
ds_read_b128 a[204:207], v10 offset:19456
v_mfma_f32_16x16x32_bf16 v[80:83], a[224:227], a[160:163], v[52:55]
ds_read_b128 a[208:211], v10 offset:20480
v_mfma_f32_16x16x32_bf16 v[80:83], a[228:231], a[164:167], v[80:83]
ds_read_b128 a[212:215], v10 offset:21504
v_mfma_f32_16x16x32_bf16 v[80:83], a[232:235], a[168:171], v[80:83]
ds_read_b128 a[216:219], v10 offset:22528
v_mfma_f32_16x16x32_bf16 v[80:83], a[236:239], a[172:175], v[80:83]
s_waitcnt lgkmcnt(7)
ds_read_b128 a[220:223], v10 offset:23552
v_mfma_f32_16x16x32_bf16 v[80:83], a[240:243], a[176:179], v[80:83]
buffer_load_dwordx4 v3, s[8:11], s44 offen nt lds
v_mfma_f32_16x16x32_bf16 v[80:83], a[244:247], a[180:183], v[80:83]
s_add_u32 m0, s36, 1024
s_add_u32 s44, s38, 4096
v_mfma_f32_16x16x32_bf16 v[80:83], a[248:251], a[184:187], v[80:83]
buffer_load_dwordx4 v3, s[8:11], s44 offen nt lds
v_mfma_f32_16x16x32_bf16 v[80:83], a[252:255], a[188:191], v[80:83]
s_waitcnt lgkmcnt(4)
s_add_u32 m0, s36, 2048
s_add_u32 s44, s38, 8192
v_mfma_f32_16x16x32_bf16 v[84:87], a[224:227], a[192:195], v[56:59]
buffer_load_dwordx4 v3, s[8:11], s44 offen nt lds
v_mfma_f32_16x16x32_bf16 v[84:87], a[228:231], a[196:199], v[84:87]
s_add_u32 m0, s36, 3072
s_add_u32 s44, s38, 12288
v_mfma_f32_16x16x32_bf16 v[84:87], a[232:235], a[200:203], v[84:87]
buffer_load_dwordx4 v3, s[8:11], s44 offen nt lds
v_mfma_f32_16x16x32_bf16 v[84:87], a[236:239], a[204:207], v[84:87]
s_waitcnt lgkmcnt(0)
s_add_u32 m0, s36, 4096
s_add_u32 s44, s38, 16384
v_mfma_f32_16x16x32_bf16 v[84:87], a[240:243], a[208:211], v[84:87]
buffer_load_dwordx4 v3, s[8:11], s44 offen nt lds
v_mfma_f32_16x16x32_bf16 v[84:87], a[244:247], a[212:215], v[84:87]
s_add_u32 m0, s36, 5120
s_add_u32 s44, s38, 20480
v_mfma_f32_16x16x32_bf16 v[84:87], a[248:251], a[216:219], v[84:87]
buffer_load_dwordx4 v3, s[8:11], s44 offen nt lds
v_mfma_f32_16x16x32_bf16 v[84:87], a[252:255], a[220:223], v[84:87]
s_add_u32 m0, s36, 6144
s_add_u32 s44, s38, 24576
buffer_load_dwordx4 v3, s[8:11], s44 offen nt lds
s_add_u32 m0, s36, 7168
s_add_u32 s44, s38, 28672
buffer_load_dwordx4 v3, s[8:11], s44 offen nt lds
s_add_u32 s38, s38, 32768
s_xor_b32 s36, s36, 8192
s_nop 7
v_max3_f32 v15, v60, v61, v62
v_max_f32 v15, v15, v63
v_sub_f32 v15, v15, v32
ds_max_f32 v12, v15 offset:0
v_max3_f32 v15, v64, v65, v66
v_max_f32 v15, v15, v67
v_sub_f32 v15, v15, v36
ds_max_f32 v12, v15 offset:4
v_max3_f32 v15, v68, v69, v70
v_max_f32 v15, v15, v71
v_sub_f32 v15, v15, v40
ds_max_f32 v12, v15 offset:8
v_max3_f32 v15, v72, v73, v74
v_max_f32 v15, v15, v75
v_sub_f32 v15, v15, v44
ds_max_f32 v12, v15 offset:12
v_max3_f32 v15, v76, v77, v78
v_max_f32 v15, v15, v79
v_sub_f32 v15, v15, v48
ds_max_f32 v12, v15 offset:16
v_max3_f32 v15, v80, v81, v82
v_max_f32 v15, v15, v83
v_sub_f32 v15, v15, v52
ds_max_f32 v12, v15 offset:20
v_max3_f32 v15, v84, v85, v86
v_max_f32 v15, v15, v87
v_sub_f32 v15, v15, v56
ds_max_f32 v12, v15 offset:24
v_mov_b32 v15, s39
ds_write_b32 v14, v15
s_waitcnt lgkmcnt(0)
s_barrier
ds_read_b128 v[16:19], v12
ds_read_b128 v[20:23], v12 offset:16
s_waitcnt lgkmcnt(0)
s_barrier
v_add_f32 v16, v16, v32
v_sub_f32 v60, v60, v16
v_sub_f32 v32, v32, v16
v_sub_f32 v61, v61, v16
v_sub_f32 v33, v33, v16
v_sub_f32 v62, v62, v16
v_sub_f32 v34, v34, v16
v_sub_f32 v63, v63, v16
v_sub_f32 v35, v35, v16
v_add_f32 v17, v17, v36
v_sub_f32 v64, v64, v17
v_sub_f32 v36, v36, v17
v_sub_f32 v65, v65, v17
v_sub_f32 v37, v37, v17
v_sub_f32 v66, v66, v17
v_sub_f32 v38, v38, v17
v_sub_f32 v67, v67, v17
v_sub_f32 v39, v39, v17
v_add_f32 v18, v18, v40
v_sub_f32 v68, v68, v18
v_sub_f32 v40, v40, v18
v_sub_f32 v69, v69, v18
v_sub_f32 v41, v41, v18
v_sub_f32 v70, v70, v18
v_sub_f32 v42, v42, v18
v_sub_f32 v71, v71, v18
v_sub_f32 v43, v43, v18
v_add_f32 v19, v19, v44
v_sub_f32 v72, v72, v19
v_sub_f32 v44, v44, v19
v_sub_f32 v73, v73, v19
v_sub_f32 v45, v45, v19
v_sub_f32 v74, v74, v19
v_sub_f32 v46, v46, v19
v_sub_f32 v75, v75, v19
v_sub_f32 v47, v47, v19
v_add_f32 v20, v20, v48
v_sub_f32 v76, v76, v20
v_sub_f32 v48, v48, v20
v_sub_f32 v77, v77, v20
v_sub_f32 v49, v49, v20
v_sub_f32 v78, v78, v20
v_sub_f32 v50, v50, v20
v_sub_f32 v79, v79, v20
v_sub_f32 v51, v51, v20
v_add_f32 v21, v21, v52
v_sub_f32 v80, v80, v21
v_sub_f32 v52, v52, v21
v_sub_f32 v81, v81, v21
v_sub_f32 v53, v53, v21
v_sub_f32 v82, v82, v21
v_sub_f32 v54, v54, v21
v_sub_f32 v83, v83, v21
v_sub_f32 v55, v55, v21
v_add_f32 v22, v22, v56
v_sub_f32 v84, v84, v22
v_sub_f32 v56, v56, v22
v_sub_f32 v85, v85, v22
v_sub_f32 v57, v57, v22
v_sub_f32 v86, v86, v22
v_sub_f32 v58, v58, v22
v_sub_f32 v87, v87, v22
v_sub_f32 v59, v59, v22
s_nop 1
s_waitcnt lgkmcnt(0)
s_nop 0
v_exp_f32 v60, v60
v_exp_f32 v61, v61
v_add_f32 v24, v24, v60
v_add_f32 v24, v24, v61
v_cvt_pk_bf16_f32 v60, v60, v61
v_exp_f32 v62, v62
v_exp_f32 v63, v63
v_add_f32 v24, v24, v62
v_add_f32 v24, v24, v63
v_cvt_pk_bf16_f32 v61, v62, v63
ds_write_b64 v11, v[60:61] offset:0
s_waitcnt vmcnt(24)
ds_read_b128 a[224:227], v4 offset:0
s_waitcnt lgkmcnt(0)
v_mfma_f32_16x16x32_bf16 v[60:63], a[224:227], a[0:3], v[32:35]
s_waitcnt vmcnt(16)
ds_read_b128 a[228:231], v5 offset:0
v_xor_b32 v14, 4, v14
s_waitcnt lgkmcnt(0)
v_mfma_f32_16x16x32_bf16 v[60:63], a[228:231], a[4:7], v[60:63]
ds_read_b128 a[232:235], v4 offset:2048
s_waitcnt lgkmcnt(0)
v_mfma_f32_16x16x32_bf16 v[60:63], a[232:235], a[8:11], v[60:63]
ds_read_b128 a[236:239], v5 offset:2048
s_waitcnt lgkmcnt(0)
v_mfma_f32_16x16x32_bf16 v[60:63], a[236:239], a[12:15], v[60:63]
ds_read_b128 a[240:243], v4 offset:4096
s_waitcnt lgkmcnt(0)
v_mfma_f32_16x16x32_bf16 v[60:63], a[240:243], a[16:19], v[60:63]
ds_read_b128 a[244:247], v5 offset:4096
s_waitcnt lgkmcnt(0)
v_mfma_f32_16x16x32_bf16 v[60:63], a[244:247], a[20:23], v[60:63]
ds_read_b128 a[248:251], v4 offset:6144
s_waitcnt lgkmcnt(0)
v_mfma_f32_16x16x32_bf16 v[60:63], a[248:251], a[24:27], v[60:63]
ds_read_b128 a[252:255], v5 offset:6144
v_xor_b32 v4, 8192, v4
s_waitcnt lgkmcnt(0)
v_mfma_f32_16x16x32_bf16 v[60:63], a[252:255], a[28:31], v[60:63]
ds_read_b64_tr_b16 v[88:89], v6 offset:0
v_xor_b32 v5, 8192, v5
v_exp_f32 v64, v64
v_exp_f32 v65, v65
v_add_f32 v25, v25, v64
v_add_f32 v25, v25, v65
v_cvt_pk_bf16_f32 v64, v64, v65
v_exp_f32 v66, v66
v_exp_f32 v67, v67
v_max3_f32 v13, v60, v61, v62
v_max_f32 v13, v13, v63
v_add_f32 v25, v25, v66
v_add_f32 v25, v25, v67
v_cvt_pk_bf16_f32 v65, v66, v67
ds_write_b64 v11, v[64:65] offset:1024
s_nop 2
v_mfma_f32_16x16x32_bf16 v[64:67], a[224:227], a[32:35], v[36:39]
ds_read_b64_tr_b16 v[90:91], v6 offset:2048
v_mfma_f32_16x16x32_bf16 v[64:67], a[228:231], a[36:39], v[64:67]
ds_read_b64_tr_b16 v[92:93], v6 offset:4096
v_mfma_f32_16x16x32_bf16 v[64:67], a[232:235], a[40:43], v[64:67]
ds_read_b64_tr_b16 v[94:95], v6 offset:6144
v_mfma_f32_16x16x32_bf16 v[64:67], a[236:239], a[44:47], v[64:67]
ds_read_b64_tr_b16 v[96:97], v7 offset:0
v_mfma_f32_16x16x32_bf16 v[64:67], a[240:243], a[48:51], v[64:67]
ds_read_b64_tr_b16 v[98:99], v7 offset:2048
v_mfma_f32_16x16x32_bf16 v[64:67], a[244:247], a[52:55], v[64:67]
ds_read_b64_tr_b16 v[100:101], v7 offset:4096
v_mfma_f32_16x16x32_bf16 v[64:67], a[248:251], a[56:59], v[64:67]
ds_read_b64_tr_b16 v[102:103], v7 offset:6144
v_mfma_f32_16x16x32_bf16 v[64:67], a[252:255], a[60:63], v[64:67]
ds_read_b64_tr_b16 v[104:105], v8 offset:0
v_exp_f32 v68, v68
v_exp_f32 v69, v69
v_add_f32 v26, v26, v68
v_add_f32 v26, v26, v69
v_cvt_pk_bf16_f32 v68, v68, v69
v_exp_f32 v70, v70
v_exp_f32 v71, v71
v_add_f32 v26, v26, v70
v_max3_f32 v13, v13, v64, v65
v_max3_f32 v13, v13, v66, v67
v_add_f32 v26, v26, v71
v_cvt_pk_bf16_f32 v69, v70, v71
ds_write_b64 v11, v[68:69] offset:2048
s_nop 2
v_mfma_f32_16x16x32_bf16 v[68:71], a[224:227], a[64:67], v[40:43]
ds_read_b64_tr_b16 v[106:107], v8 offset:2048
v_mfma_f32_16x16x32_bf16 v[68:71], a[228:231], a[68:71], v[68:71]
ds_read_b64_tr_b16 v[108:109], v8 offset:4096
v_mfma_f32_16x16x32_bf16 v[68:71], a[232:235], a[72:75], v[68:71]
ds_read_b64_tr_b16 v[110:111], v8 offset:6144
v_mfma_f32_16x16x32_bf16 v[68:71], a[236:239], a[76:79], v[68:71]
ds_read_b64_tr_b16 v[112:113], v9 offset:0
v_mfma_f32_16x16x32_bf16 v[68:71], a[240:243], a[80:83], v[68:71]
ds_read_b64_tr_b16 v[114:115], v9 offset:2048
v_mfma_f32_16x16x32_bf16 v[68:71], a[244:247], a[84:87], v[68:71]
ds_read_b64_tr_b16 v[116:117], v9 offset:4096
v_mfma_f32_16x16x32_bf16 v[68:71], a[248:251], a[88:91], v[68:71]
ds_read_b64_tr_b16 v[118:119], v9 offset:6144
v_xor_b32 v6, 8192, v6
v_mfma_f32_16x16x32_bf16 v[68:71], a[252:255], a[92:95], v[68:71]
buffer_load_dword v31, v0, s[64:67], s48 idxen
v_exp_f32 v72, v72
v_exp_f32 v73, v73
v_add_f32 v27, v27, v72
v_add_f32 v27, v27, v73
v_cvt_pk_bf16_f32 v72, v72, v73
v_exp_f32 v74, v74
v_exp_f32 v75, v75
v_add_f32 v27, v27, v74
v_max3_f32 v13, v13, v68, v69
v_max3_f32 v13, v13, v70, v71
v_add_f32 v27, v27, v75
v_cvt_pk_bf16_f32 v73, v74, v75
ds_write_b64 v11, v[72:73] offset:3072
s_nop 2
v_mfma_f32_16x16x32_bf16 v[72:75], a[224:227], a[96:99], v[44:47]
v_exp_f32 v76, v76
v_mfma_f32_16x16x32_bf16 v[72:75], a[228:231], a[100:103], v[72:75]
v_exp_f32 v77, v77
v_mfma_f32_16x16x32_bf16 v[72:75], a[232:235], a[104:107], v[72:75]
v_exp_f32 v78, v78
v_mfma_f32_16x16x32_bf16 v[72:75], a[236:239], a[108:111], v[72:75]
v_exp_f32 v79, v79
v_mfma_f32_16x16x32_bf16 v[72:75], a[240:243], a[112:115], v[72:75]
v_exp_f32 v80, v80
v_mfma_f32_16x16x32_bf16 v[72:75], a[244:247], a[116:119], v[72:75]
v_exp_f32 v81, v81
v_mfma_f32_16x16x32_bf16 v[72:75], a[248:251], a[120:123], v[72:75]
v_exp_f32 v82, v82
v_mfma_f32_16x16x32_bf16 v[72:75], a[252:255], a[124:127], v[72:75]
v_exp_f32 v83, v83
v_add_f32 v28, v28, v76
v_add_f32 v28, v28, v77
v_cvt_pk_bf16_f32 v76, v76, v77
v_add_f32 v28, v28, v78
v_add_f32 v28, v28, v79
v_cvt_pk_bf16_f32 v77, v78, v79
ds_write_b64 v11, v[76:77] offset:4096
s_nop 2
v_mfma_f32_16x16x32_bf16 v[76:79], a[224:227], a[128:131], v[48:51]
v_max3_f32 v13, v13, v72, v73
v_max3_f32 v13, v13, v74, v75
v_mfma_f32_16x16x32_bf16 v[76:79], a[228:231], a[132:135], v[76:79]
v_exp_f32 v84, v84
v_mfma_f32_16x16x32_bf16 v[76:79], a[232:235], a[136:139], v[76:79]
v_exp_f32 v85, v85
v_mfma_f32_16x16x32_bf16 v[76:79], a[236:239], a[140:143], v[76:79]
v_exp_f32 v86, v86
v_mfma_f32_16x16x32_bf16 v[76:79], a[240:243], a[144:147], v[76:79]
v_exp_f32 v87, v87
v_mfma_f32_16x16x32_bf16 v[76:79], a[244:247], a[148:151], v[76:79]
v_add_f32 v29, v29, v80
v_add_f32 v29, v29, v81
v_mfma_f32_16x16x32_bf16 v[76:79], a[248:251], a[152:155], v[76:79]
v_cvt_pk_bf16_f32 v80, v80, v81
v_add_f32 v29, v29, v82
v_mfma_f32_16x16x32_bf16 v[76:79], a[252:255], a[156:159], v[76:79]
v_add_f32 v29, v29, v83
v_cvt_pk_bf16_f32 v81, v82, v83
ds_write_b64 v11, v[80:81] offset:5120
s_nop 2
v_mfma_f32_16x16x32_bf16 v[80:83], a[224:227], a[160:163], v[52:55]
v_add_f32 v30, v30, v84
v_add_f32 v30, v30, v85
v_mfma_f32_16x16x32_bf16 v[80:83], a[228:231], a[164:167], v[80:83]
v_max3_f32 v13, v13, v76, v77
v_max3_f32 v13, v13, v78, v79
v_mfma_f32_16x16x32_bf16 v[80:83], a[232:235], a[168:171], v[80:83]
v_cvt_pk_bf16_f32 v84, v84, v85
v_add_f32 v30, v30, v86
v_mfma_f32_16x16x32_bf16 v[80:83], a[236:239], a[172:175], v[80:83]
v_add_f32 v30, v30, v87
v_cvt_pk_bf16_f32 v85, v86, v87
v_mfma_f32_16x16x32_bf16 v[80:83], a[240:243], a[176:179], v[80:83]
ds_write_b64 v11, v[84:85] offset:6144
v_add_u32 v11, s40, v11
v_mfma_f32_16x16x32_bf16 v[80:83], a[244:247], a[180:183], v[80:83]
s_sub_u32 s40, 0, s40
v_xor_b32 v7, 8192, v7
v_xor_b32 v8, 8192, v8
v_mfma_f32_16x16x32_bf16 v[80:83], a[248:251], a[184:187], v[80:83]
s_add_u32 s39, s39, 1
v_xor_b32 v9, 8192, v9
v_mfma_f32_16x16x32_bf16 v[80:83], a[252:255], a[188:191], v[80:83]
v_mfma_f32_16x16x32_bf16 v[84:87], a[224:227], a[192:195], v[56:59]
v_mfma_f32_16x16x32_bf16 v[84:87], a[228:231], a[196:199], v[84:87]
v_mfma_f32_16x16x32_bf16 v[84:87], a[232:235], a[200:203], v[84:87]
v_mfma_f32_16x16x32_bf16 v[84:87], a[236:239], a[204:207], v[84:87]
v_mfma_f32_16x16x32_bf16 v[84:87], a[240:243], a[208:211], v[84:87]
v_mfma_f32_16x16x32_bf16 v[84:87], a[244:247], a[212:215], v[84:87]
v_mfma_f32_16x16x32_bf16 v[84:87], a[248:251], a[216:219], v[84:87]
v_mfma_f32_16x16x32_bf16 v[84:87], a[252:255], a[220:223], v[84:87]
s_nop 0
v_max3_f32 v13, v13, v80, v81
v_max3_f32 v13, v13, v82, v83
s_nop 5
v_max3_f32 v13, v13, v84, v85
v_max3_f32 v13, v13, v86, v87
v_cmp_lt_f32 vcc, s43, v13
s_nop 0
s_cbranch_vccnz L_tr0
L_rt0:
s_waitcnt lgkmcnt(0)
s_barrier
ds_read_b32 v15, v14
ds_read_b128 v[120:123], v10 offset:0
ds_read_b128 v[124:127], v10 offset:7168
ds_read_b128 v[128:131], v10 offset:1024
ds_read_b128 v[132:135], v10 offset:8192
ds_read_b128 v[136:139], v10 offset:2048
ds_read_b128 v[140:143], v10 offset:9216
s_waitcnt lgkmcnt(4)
v_mfma_f32_16x16x32_bf16 v[144:147], v[88:91], v[120:123], 0
s_nop 0
v_cmp_eq_u32 vcc, s39, v15
v_mfma_f32_16x16x32_bf16 v[144:147], v[92:95], v[124:127], v[144:147]
s_cbranch_vccnz L_tr1
L_rt1:
v_exp_f32 v60, v60
v_mfma_f32_16x16x32_bf16 v[148:151], v[96:99], v[120:123], 0
v_exp_f32 v61, v61
v_mfma_f32_16x16x32_bf16 v[148:151], v[100:103], v[124:127], v[148:151]
v_exp_f32 v62, v62
v_mfma_f32_16x16x32_bf16 v[152:155], v[104:107], v[120:123], 0
s_waitcnt vmcnt(9)
v_exp_f32 v63, v63
v_mfma_f32_16x16x32_bf16 v[152:155], v[108:111], v[124:127], v[152:155]
ds_read_b128 a[224:227], v4 offset:0
v_add_f32 v24, v24, v60
v_mfma_f32_16x16x32_bf16 v[156:159], v[112:115], v[120:123], 0
v_exp_f32 v64, v64
v_mfma_f32_16x16x32_bf16 v[156:159], v[116:119], v[124:127], v[156:159]
s_waitcnt lgkmcnt(3)
ds_read_b128 a[228:231], v5 offset:0
v_add_f32 v24, v24, v61
v_mfma_f32_16x16x32_bf16 v[160:163], v[88:91], v[128:131], 0
ds_read_b128 v[120:123], v10 offset:3072
v_cvt_pk_bf16_f32 v60, v60, v61
v_mfma_f32_16x16x32_bf16 v[160:163], v[92:95], v[132:135], v[160:163]
ds_read_b128 v[124:127], v10 offset:10240
v_add_f32 v24, v24, v62
v_mfma_f32_16x16x32_bf16 v[164:167], v[96:99], v[128:131], 0
ds_read_b128 a[232:235], v4 offset:2048
v_add_f32 v24, v24, v63
v_mfma_f32_16x16x32_bf16 v[164:167], v[100:103], v[132:135], v[164:167]
ds_read_b128 a[236:239], v5 offset:2048
v_cvt_pk_bf16_f32 v61, v62, v63
v_mfma_f32_16x16x32_bf16 v[168:171], v[104:107], v[128:131], 0
ds_write_b64 v11, v[60:61] offset:0
v_add_f32 v25, v25, v64
v_mfma_f32_16x16x32_bf16 v[168:171], v[108:111], v[132:135], v[168:171]
ds_read_b128 a[240:243], v4 offset:4096
v_xor_b32 v14, 4, v14
v_mfma_f32_16x16x32_bf16 v[172:175], v[112:115], v[128:131], 0
v_exp_f32 v65, v65
v_mfma_f32_16x16x32_bf16 v[172:175], v[116:119], v[132:135], v[172:175]
s_waitcnt lgkmcnt(8)
ds_read_b128 a[244:247], v5 offset:4096
v_add_f32 v25, v25, v65
v_mfma_f32_16x16x32_bf16 v[176:179], v[88:91], v[136:139], 0
ds_read_b128 v[128:131], v10 offset:4096
v_cvt_pk_bf16_f32 v64, v64, v65
v_mfma_f32_16x16x32_bf16 v[176:179], v[92:95], v[140:143], v[176:179]
ds_read_b128 v[132:135], v10 offset:11264
v_mfma_f32_16x16x32_bf16 v[180:183], v[96:99], v[136:139], 0
ds_read_b128 a[248:251], v4 offset:6144
v_mfma_f32_16x16x32_bf16 v[180:183], v[100:103], v[140:143], v[180:183]
ds_read_b128 a[252:255], v5 offset:6144
v_xor_b32 v4, 8192, v4
v_mfma_f32_16x16x32_bf16 v[184:187], v[104:107], v[136:139], 0
v_exp_f32 v66, v66
v_mfma_f32_16x16x32_bf16 v[184:187], v[108:111], v[140:143], v[184:187]
v_exp_f32 v67, v67
v_mfma_f32_16x16x32_bf16 v[188:191], v[112:115], v[136:139], 0
v_exp_f32 v68, v68
v_mfma_f32_16x16x32_bf16 v[188:191], v[116:119], v[140:143], v[188:191]
s_waitcnt lgkmcnt(9)
v_exp_f32 v69, v69
v_mfma_f32_16x16x32_bf16 v[192:195], v[88:91], v[120:123], 0
ds_read_b128 v[136:139], v10 offset:5120
v_add_f32 v25, v25, v66
v_mfma_f32_16x16x32_bf16 v[192:195], v[92:95], v[124:127], v[192:195]
ds_read_b128 v[140:143], v10 offset:12288
v_add_f32 v25, v25, v67
v_mfma_f32_16x16x32_bf16 v[196:199], v[96:99], v[120:123], 0
s_add_u32 m0, s35, 0
v_exp_f32 v70, v70
v_mfma_f32_16x16x32_bf16 v[196:199], v[100:103], v[124:127], v[196:199]
buffer_load_dwordx4 v1, s[4:7], s37 offen offset:0 nt lds
v_mfma_f32_16x16x32_bf16 v[200:203], v[104:107], v[120:123], 0
v_exp_f32 v71, v71
v_mfma_f32_16x16x32_bf16 v[200:203], v[108:111], v[124:127], v[200:203]
v_exp_f32 v72, v72
v_mfma_f32_16x16x32_bf16 v[204:207], v[112:115], v[120:123], 0
s_add_u32 m0, s35, 1024
v_exp_f32 v73, v73
v_mfma_f32_16x16x32_bf16 v[204:207], v[116:119], v[124:127], v[204:207]
s_waitcnt lgkmcnt(4)
buffer_load_dwordx4 v2, s[4:7], s37 offen offset:0 nt lds
v_mfma_f32_16x16x32_bf16 v[208:211], v[88:91], v[128:131], 0
ds_read_b128 v[120:123], v10 offset:6144
v_cvt_pk_bf16_f32 v65, v66, v67
v_mfma_f32_16x16x32_bf16 v[208:211], v[92:95], v[132:135], v[208:211]
ds_write_b64 v11, v[64:65] offset:1024
v_add_f32 v26, v26, v68
v_mfma_f32_16x16x32_bf16 v[212:215], v[96:99], v[128:131], 0
s_add_u32 m0, s35, 1920
ds_read_b128 v[124:127], v10 offset:13312
v_add_f32 v26, v26, v69
v_mfma_f32_16x16x32_bf16 v[212:215], v[100:103], v[132:135], v[212:215]
buffer_load_dwordx4 v1, s[4:7], s37 offen offset:128 nt lds
v_mfma_f32_16x16x32_bf16 v[216:219], v[104:107], v[128:131], 0
v_exp_f32 v74, v74
v_mfma_f32_16x16x32_bf16 v[216:219], v[108:111], v[132:135], v[216:219]
v_exp_f32 v75, v75
v_mfma_f32_16x16x32_bf16 v[220:223], v[112:115], v[128:131], 0
s_add_u32 m0, s35, 2944
v_exp_f32 v76, v76
v_mfma_f32_16x16x32_bf16 v[220:223], v[116:119], v[132:135], v[220:223]
s_waitcnt lgkmcnt(3)
buffer_load_dwordx4 v2, s[4:7], s37 offen offset:128 nt lds
v_mfma_f32_16x16x32_bf16 v[224:227], v[88:91], v[136:139], 0
v_exp_f32 v77, v77
v_mfma_f32_16x16x32_bf16 v[224:227], v[92:95], v[140:143], v[224:227]
v_exp_f32 v78, v78
v_mfma_f32_16x16x32_bf16 v[228:231], v[96:99], v[136:139], 0
s_add_u32 m0, s35, 3840
v_exp_f32 v79, v79
v_mfma_f32_16x16x32_bf16 v[228:231], v[100:103], v[140:143], v[228:231]
buffer_load_dwordx4 v1, s[4:7], s37 offen offset:256 nt lds
v_mfma_f32_16x16x32_bf16 v[232:235], v[104:107], v[136:139], 0
v_exp_f32 v80, v80
v_mfma_f32_16x16x32_bf16 v[232:235], v[108:111], v[140:143], v[232:235]
v_exp_f32 v81, v81
v_mfma_f32_16x16x32_bf16 v[236:239], v[112:115], v[136:139], 0
s_add_u32 m0, s35, 4864
v_exp_f32 v82, v82
v_mfma_f32_16x16x32_bf16 v[236:239], v[116:119], v[140:143], v[236:239]
s_waitcnt lgkmcnt(0)
buffer_load_dwordx4 v2, s[4:7], s37 offen offset:256 nt lds
v_mfma_f32_16x16x32_bf16 v[240:243], v[88:91], v[120:123], 0
v_exp_f32 v83, v83
v_mfma_f32_16x16x32_bf16 v[240:243], v[92:95], v[124:127], v[240:243]
v_exp_f32 v84, v84
v_mfma_f32_16x16x32_bf16 v[244:247], v[96:99], v[120:123], 0
s_add_u32 m0, s35, 5760
v_exp_f32 v85, v85
v_mfma_f32_16x16x32_bf16 v[244:247], v[100:103], v[124:127], v[244:247]
buffer_load_dwordx4 v1, s[4:7], s37 offen offset:384 nt lds
v_mfma_f32_16x16x32_bf16 v[248:251], v[104:107], v[120:123], 0
v_exp_f32 v86, v86
v_mfma_f32_16x16x32_bf16 v[248:251], v[108:111], v[124:127], v[248:251]
v_exp_f32 v87, v87
v_mfma_f32_16x16x32_bf16 v[252:255], v[112:115], v[120:123], 0
s_add_u32 m0, s35, 6784
v_cvt_pk_bf16_f32 v68, v68, v69
v_add_f32 v26, v26, v70
v_mfma_f32_16x16x32_bf16 v[252:255], v[116:119], v[124:127], v[252:255]
buffer_load_dwordx4 v2, s[4:7], s37 offen offset:384 nt lds
v_mfma_f32_16x16x32_bf16 v[60:63], a[224:227], a[0:3], v[32:35]
s_waitcnt vmcnt(9)
v_add_f32 v26, v26, v71
v_cvt_pk_bf16_f32 v69, v70, v71
v_mfma_f32_16x16x32_bf16 v[60:63], a[228:231], a[4:7], v[60:63]
s_add_u32 s37, s37, 32768
ds_write_b64 v11, v[68:69] offset:2048
v_add_f32 v27, v27, v72
v_mfma_f32_16x16x32_bf16 v[60:63], a[232:235], a[8:11], v[60:63]
s_xor_b32 s35, s35, 8192
ds_read_b64_tr_b16 v[88:89], v6 offset:0
v_add_f32 v27, v27, v73
v_mfma_f32_16x16x32_bf16 v[60:63], a[236:239], a[12:15], v[60:63]
s_cmp_lg_u32 s42, 0
ds_read_b64_tr_b16 v[90:91], v6 offset:2048
v_cvt_pk_bf16_f32 v72, v72, v73
v_mfma_f32_16x16x32_bf16 v[60:63], a[240:243], a[16:19], v[60:63]
s_cbranch_scc1 L_tr2
L_rt2:
ds_read_b64_tr_b16 v[92:93], v6 offset:4096
v_add_f32 v27, v27, v74
v_mfma_f32_16x16x32_bf16 v[60:63], a[244:247], a[20:23], v[60:63]
s_add_u32 m0, s36, 0
ds_read_b64_tr_b16 v[94:95], v6 offset:6144
v_add_f32 v27, v27, v75
v_mfma_f32_16x16x32_bf16 v[60:63], a[248:251], a[24:27], v[60:63]
s_add_u32 s44, s38, 0
ds_read_b64_tr_b16 v[96:97], v7 offset:0
v_cvt_pk_bf16_f32 v73, v74, v75
v_mfma_f32_16x16x32_bf16 v[60:63], a[252:255], a[28:31], v[60:63]
ds_write_b64 v11, v[72:73] offset:3072
v_add_f32 v28, v28, v76
v_mfma_f32_16x16x32_bf16 v[64:67], a[224:227], a[32:35], v[36:39]
ds_read_b64_tr_b16 v[98:99], v7 offset:2048
v_add_f32 v28, v28, v77
v_mfma_f32_16x16x32_bf16 v[64:67], a[228:231], a[36:39], v[64:67]
ds_read_b64_tr_b16 v[100:101], v7 offset:4096
v_cvt_pk_bf16_f32 v76, v76, v77
v_mfma_f32_16x16x32_bf16 v[64:67], a[232:235], a[40:43], v[64:67]
ds_read_b64_tr_b16 v[102:103], v7 offset:6144
v_max3_f32 v13, v60, v61, v62
v_mfma_f32_16x16x32_bf16 v[64:67], a[236:239], a[44:47], v[64:67]
ds_read_b64_tr_b16 v[104:105], v8 offset:0
v_max_f32 v13, v13, v63
v_mfma_f32_16x16x32_bf16 v[64:67], a[240:243], a[48:51], v[64:67]
ds_read_b64_tr_b16 v[106:107], v8 offset:2048
v_add_f32 v28, v28, v78
v_mfma_f32_16x16x32_bf16 v[64:67], a[244:247], a[52:55], v[64:67]
ds_read_b64_tr_b16 v[108:109], v8 offset:4096
v_add_f32 v28, v28, v79
v_mfma_f32_16x16x32_bf16 v[64:67], a[248:251], a[56:59], v[64:67]
ds_read_b64_tr_b16 v[110:111], v8 offset:6144
v_cvt_pk_bf16_f32 v77, v78, v79
v_mfma_f32_16x16x32_bf16 v[64:67], a[252:255], a[60:63], v[64:67]
ds_write_b64 v11, v[76:77] offset:4096
v_add_f32 v29, v29, v80
v_mfma_f32_16x16x32_bf16 v[68:71], a[224:227], a[64:67], v[40:43]
ds_read_b64_tr_b16 v[112:113], v9 offset:0
v_add_f32 v29, v29, v81
v_mfma_f32_16x16x32_bf16 v[68:71], a[228:231], a[68:71], v[68:71]
ds_read_b64_tr_b16 v[114:115], v9 offset:2048
v_cvt_pk_bf16_f32 v80, v80, v81
v_mfma_f32_16x16x32_bf16 v[68:71], a[232:235], a[72:75], v[68:71]
ds_read_b64_tr_b16 v[116:117], v9 offset:4096
v_max3_f32 v13, v13, v64, v65
v_mfma_f32_16x16x32_bf16 v[68:71], a[236:239], a[76:79], v[68:71]
ds_read_b64_tr_b16 v[118:119], v9 offset:6144
v_max3_f32 v13, v13, v66, v67
v_mfma_f32_16x16x32_bf16 v[68:71], a[240:243], a[80:83], v[68:71]
buffer_load_dwordx4 v3, s[8:11], s44 offen nt lds
v_mfma_f32_16x16x32_bf16 v[68:71], a[244:247], a[84:87], v[68:71]
s_add_u32 m0, s36, 1024
v_add_f32 v29, v29, v82
v_add_f32 v29, v29, v83
v_mfma_f32_16x16x32_bf16 v[68:71], a[248:251], a[88:91], v[68:71]
s_add_u32 s44, s38, 4096
v_cvt_pk_bf16_f32 v81, v82, v83
v_add_f32 v30, v30, v84
v_mfma_f32_16x16x32_bf16 v[68:71], a[252:255], a[92:95], v[68:71]
ds_write_b64 v11, v[80:81] offset:5120
v_add_f32 v30, v30, v85
v_mfma_f32_16x16x32_bf16 v[72:75], a[224:227], a[96:99], v[44:47]
buffer_load_dwordx4 v3, s[8:11], s44 offen nt lds
v_mfma_f32_16x16x32_bf16 v[72:75], a[228:231], a[100:103], v[72:75]
s_add_u32 m0, s36, 2048
v_cvt_pk_bf16_f32 v84, v84, v85
v_add_f32 v30, v30, v86
v_mfma_f32_16x16x32_bf16 v[72:75], a[232:235], a[104:107], v[72:75]
s_add_u32 s44, s38, 8192
v_max3_f32 v13, v13, v68, v69
v_max3_f32 v13, v13, v70, v71
v_mfma_f32_16x16x32_bf16 v[72:75], a[236:239], a[108:111], v[72:75]
v_add_f32 v30, v30, v87
v_cvt_pk_bf16_f32 v85, v86, v87
v_mfma_f32_16x16x32_bf16 v[72:75], a[240:243], a[112:115], v[72:75]
ds_write_b64 v11, v[84:85] offset:6144
v_add_u32 v11, s40, v11
v_mfma_f32_16x16x32_bf16 v[72:75], a[244:247], a[116:119], v[72:75]
buffer_load_dwordx4 v3, s[8:11], s44 offen nt lds
v_mfma_f32_16x16x32_bf16 v[72:75], a[248:251], a[120:123], v[72:75]
s_add_u32 m0, s36, 3072
v_subrev_u32 v10, s40, v10
v_xor_b32 v5, 8192, v5
v_mfma_f32_16x16x32_bf16 v[72:75], a[252:255], a[124:127], v[72:75]
s_add_u32 s44, s38, 12288
v_xor_b32 v6, 8192, v6
v_xor_b32 v7, 8192, v7
v_mfma_f32_16x16x32_bf16 v[76:79], a[224:227], a[128:131], v[48:51]
v_xor_b32 v8, 8192, v8
v_xor_b32 v9, 8192, v9
v_mfma_f32_16x16x32_bf16 v[76:79], a[228:231], a[132:135], v[76:79]
buffer_load_dwordx4 v3, s[8:11], s44 offen nt lds
v_mfma_f32_16x16x32_bf16 v[76:79], a[232:235], a[136:139], v[76:79]
s_add_u32 m0, s36, 4096
v_max3_f32 v13, v13, v72, v73
v_max3_f32 v13, v13, v74, v75
v_mfma_f32_16x16x32_bf16 v[76:79], a[236:239], a[140:143], v[76:79]
s_add_u32 s44, s38, 16384
v_mfma_f32_16x16x32_bf16 v[76:79], a[240:243], a[144:147], v[76:79]
v_mfma_f32_16x16x32_bf16 v[76:79], a[244:247], a[148:151], v[76:79]
buffer_load_dwordx4 v3, s[8:11], s44 offen nt lds
v_mfma_f32_16x16x32_bf16 v[76:79], a[248:251], a[152:155], v[76:79]
s_add_u32 m0, s36, 5120
s_add_u32 s44, s38, 20480
v_mfma_f32_16x16x32_bf16 v[76:79], a[252:255], a[156:159], v[76:79]
v_mfma_f32_16x16x32_bf16 v[80:83], a[224:227], a[160:163], v[52:55]
v_mfma_f32_16x16x32_bf16 v[80:83], a[228:231], a[164:167], v[80:83]
buffer_load_dwordx4 v3, s[8:11], s44 offen nt lds
v_mfma_f32_16x16x32_bf16 v[80:83], a[232:235], a[168:171], v[80:83]
s_add_u32 m0, s36, 6144
s_add_u32 s44, s38, 24576
v_mfma_f32_16x16x32_bf16 v[80:83], a[236:239], a[172:175], v[80:83]
v_mfma_f32_16x16x32_bf16 v[80:83], a[240:243], a[176:179], v[80:83]
v_mfma_f32_16x16x32_bf16 v[80:83], a[244:247], a[180:183], v[80:83]
buffer_load_dwordx4 v3, s[8:11], s44 offen nt lds
v_mfma_f32_16x16x32_bf16 v[80:83], a[248:251], a[184:187], v[80:83]
s_add_u32 m0, s36, 7168
v_max3_f32 v13, v13, v76, v77
v_max3_f32 v13, v13, v78, v79
v_mfma_f32_16x16x32_bf16 v[80:83], a[252:255], a[188:191], v[80:83]
s_add_u32 s44, s38, 28672
v_mfma_f32_16x16x32_bf16 v[84:87], a[224:227], a[192:195], v[56:59]
v_mfma_f32_16x16x32_bf16 v[84:87], a[228:231], a[196:199], v[84:87]
buffer_load_dwordx4 v3, s[8:11], s44 offen nt lds
v_mfma_f32_16x16x32_bf16 v[84:87], a[232:235], a[200:203], v[84:87]
s_add_u32 s38, s38, 32768
s_xor_b32 s36, s36, 8192
v_mfma_f32_16x16x32_bf16 v[84:87], a[236:239], a[204:207], v[84:87]
v_mfma_f32_16x16x32_bf16 v[84:87], a[240:243], a[208:211], v[84:87]
v_max3_f32 v13, v13, v80, v81
v_max3_f32 v13, v13, v82, v83
v_mfma_f32_16x16x32_bf16 v[84:87], a[244:247], a[212:215], v[84:87]
buffer_load_dword v31, v0, s[64:67], s48 idxen
v_mfma_f32_16x16x32_bf16 v[84:87], a[248:251], a[216:219], v[84:87]
s_add_u32 s48, s48, 1024
s_sub_u32 s40, 0, s40
s_add_u32 s39, s39, 1
v_mfma_f32_16x16x32_bf16 v[84:87], a[252:255], a[220:223], v[84:87]
s_nop 8
v_max3_f32 v13, v13, v84, v85
v_max3_f32 v13, v13, v86, v87
v_cmp_lt_f32 vcc, s43, v13
s_nop 0
s_cbranch_vccnz L_tr3
L_rt3:
s_mov_b32 s41, 27
.p2align 6
L_loop:
s_waitcnt lgkmcnt(0)
s_barrier
ds_read_b32 v15, v14
ds_read_b128 v[120:123], v10 offset:0
ds_read_b128 v[124:127], v10 offset:7168
ds_read_b128 v[128:131], v10 offset:1024
ds_read_b128 v[132:135], v10 offset:8192
ds_read_b128 v[136:139], v10 offset:2048
ds_read_b128 v[140:143], v10 offset:9216
s_waitcnt lgkmcnt(4)
v_mfma_f32_16x16x32_bf16 v[144:147], v[88:91], v[120:123], v[144:147]
s_nop 0
v_cmp_eq_u32 vcc, s39, v15
v_mfma_f32_16x16x32_bf16 v[144:147], v[92:95], v[124:127], v[144:147]
s_cbranch_vccnz L_tr4
L_rt4:
v_exp_f32 v60, v60
v_mfma_f32_16x16x32_bf16 v[148:151], v[96:99], v[120:123], v[148:151]
v_exp_f32 v61, v61
v_mfma_f32_16x16x32_bf16 v[148:151], v[100:103], v[124:127], v[148:151]
v_exp_f32 v62, v62
v_mfma_f32_16x16x32_bf16 v[152:155], v[104:107], v[120:123], v[152:155]
s_waitcnt vmcnt(9)
v_exp_f32 v63, v63
v_mfma_f32_16x16x32_bf16 v[152:155], v[108:111], v[124:127], v[152:155]
ds_read_b128 a[224:227], v4 offset:0
v_add_f32 v24, v24, v60
v_mfma_f32_16x16x32_bf16 v[156:159], v[112:115], v[120:123], v[156:159]
v_exp_f32 v64, v64
v_mfma_f32_16x16x32_bf16 v[156:159], v[116:119], v[124:127], v[156:159]
s_waitcnt lgkmcnt(3)
ds_read_b128 a[228:231], v5 offset:0
v_add_f32 v24, v24, v61
v_mfma_f32_16x16x32_bf16 v[160:163], v[88:91], v[128:131], v[160:163]
ds_read_b128 v[120:123], v10 offset:3072
v_cvt_pk_bf16_f32 v60, v60, v61
v_mfma_f32_16x16x32_bf16 v[160:163], v[92:95], v[132:135], v[160:163]
ds_read_b128 v[124:127], v10 offset:10240
v_add_f32 v24, v24, v62
v_mfma_f32_16x16x32_bf16 v[164:167], v[96:99], v[128:131], v[164:167]
ds_read_b128 a[232:235], v4 offset:2048
v_add_f32 v24, v24, v63
v_mfma_f32_16x16x32_bf16 v[164:167], v[100:103], v[132:135], v[164:167]
ds_read_b128 a[236:239], v5 offset:2048
v_cvt_pk_bf16_f32 v61, v62, v63
v_mfma_f32_16x16x32_bf16 v[168:171], v[104:107], v[128:131], v[168:171]
ds_write_b64 v11, v[60:61] offset:0
v_add_f32 v25, v25, v64
v_mfma_f32_16x16x32_bf16 v[168:171], v[108:111], v[132:135], v[168:171]
ds_read_b128 a[240:243], v4 offset:4096
v_xor_b32 v14, 4, v14
v_mfma_f32_16x16x32_bf16 v[172:175], v[112:115], v[128:131], v[172:175]
v_exp_f32 v65, v65
v_mfma_f32_16x16x32_bf16 v[172:175], v[116:119], v[132:135], v[172:175]
s_waitcnt lgkmcnt(8)
ds_read_b128 a[244:247], v5 offset:4096
v_add_f32 v25, v25, v65
v_mfma_f32_16x16x32_bf16 v[176:179], v[88:91], v[136:139], v[176:179]
ds_read_b128 v[128:131], v10 offset:4096
v_cvt_pk_bf16_f32 v64, v64, v65
v_mfma_f32_16x16x32_bf16 v[176:179], v[92:95], v[140:143], v[176:179]
ds_read_b128 v[132:135], v10 offset:11264
v_mfma_f32_16x16x32_bf16 v[180:183], v[96:99], v[136:139], v[180:183]
ds_read_b128 a[248:251], v4 offset:6144
v_mfma_f32_16x16x32_bf16 v[180:183], v[100:103], v[140:143], v[180:183]
ds_read_b128 a[252:255], v5 offset:6144
v_xor_b32 v4, 8192, v4
v_mfma_f32_16x16x32_bf16 v[184:187], v[104:107], v[136:139], v[184:187]
v_exp_f32 v66, v66
v_mfma_f32_16x16x32_bf16 v[184:187], v[108:111], v[140:143], v[184:187]
v_exp_f32 v67, v67
v_mfma_f32_16x16x32_bf16 v[188:191], v[112:115], v[136:139], v[188:191]
v_exp_f32 v68, v68
v_mfma_f32_16x16x32_bf16 v[188:191], v[116:119], v[140:143], v[188:191]
s_waitcnt lgkmcnt(9)
v_exp_f32 v69, v69
v_mfma_f32_16x16x32_bf16 v[192:195], v[88:91], v[120:123], v[192:195]
ds_read_b128 v[136:139], v10 offset:5120
v_add_f32 v25, v25, v66
v_mfma_f32_16x16x32_bf16 v[192:195], v[92:95], v[124:127], v[192:195]
ds_read_b128 v[140:143], v10 offset:12288
v_add_f32 v25, v25, v67
v_mfma_f32_16x16x32_bf16 v[196:199], v[96:99], v[120:123], v[196:199]
s_add_u32 m0, s35, 0
v_exp_f32 v70, v70
v_mfma_f32_16x16x32_bf16 v[196:199], v[100:103], v[124:127], v[196:199]
buffer_load_dwordx4 v1, s[4:7], s37 offen offset:0 nt lds
v_mfma_f32_16x16x32_bf16 v[200:203], v[104:107], v[120:123], v[200:203]
v_exp_f32 v71, v71
v_mfma_f32_16x16x32_bf16 v[200:203], v[108:111], v[124:127], v[200:203]
v_exp_f32 v72, v72
v_mfma_f32_16x16x32_bf16 v[204:207], v[112:115], v[120:123], v[204:207]
s_add_u32 m0, s35, 1024
v_exp_f32 v73, v73
v_mfma_f32_16x16x32_bf16 v[204:207], v[116:119], v[124:127], v[204:207]
s_waitcnt lgkmcnt(4)
buffer_load_dwordx4 v2, s[4:7], s37 offen offset:0 nt lds
v_mfma_f32_16x16x32_bf16 v[208:211], v[88:91], v[128:131], v[208:211]
ds_read_b128 v[120:123], v10 offset:6144
v_cvt_pk_bf16_f32 v65, v66, v67
v_mfma_f32_16x16x32_bf16 v[208:211], v[92:95], v[132:135], v[208:211]
ds_write_b64 v11, v[64:65] offset:1024
v_add_f32 v26, v26, v68
v_mfma_f32_16x16x32_bf16 v[212:215], v[96:99], v[128:131], v[212:215]
s_add_u32 m0, s35, 1920
ds_read_b128 v[124:127], v10 offset:13312
v_add_f32 v26, v26, v69
v_mfma_f32_16x16x32_bf16 v[212:215], v[100:103], v[132:135], v[212:215]
buffer_load_dwordx4 v1, s[4:7], s37 offen offset:128 nt lds
v_mfma_f32_16x16x32_bf16 v[216:219], v[104:107], v[128:131], v[216:219]
v_exp_f32 v74, v74
v_mfma_f32_16x16x32_bf16 v[216:219], v[108:111], v[132:135], v[216:219]
v_exp_f32 v75, v75
v_mfma_f32_16x16x32_bf16 v[220:223], v[112:115], v[128:131], v[220:223]
s_add_u32 m0, s35, 2944
v_exp_f32 v76, v76
v_mfma_f32_16x16x32_bf16 v[220:223], v[116:119], v[132:135], v[220:223]
s_waitcnt lgkmcnt(3)
buffer_load_dwordx4 v2, s[4:7], s37 offen offset:128 nt lds
v_mfma_f32_16x16x32_bf16 v[224:227], v[88:91], v[136:139], v[224:227]
v_exp_f32 v77, v77
v_mfma_f32_16x16x32_bf16 v[224:227], v[92:95], v[140:143], v[224:227]
v_exp_f32 v78, v78
v_mfma_f32_16x16x32_bf16 v[228:231], v[96:99], v[136:139], v[228:231]
s_add_u32 m0, s35, 3840
v_exp_f32 v79, v79
v_mfma_f32_16x16x32_bf16 v[228:231], v[100:103], v[140:143], v[228:231]
buffer_load_dwordx4 v1, s[4:7], s37 offen offset:256 nt lds
v_mfma_f32_16x16x32_bf16 v[232:235], v[104:107], v[136:139], v[232:235]
v_exp_f32 v80, v80
v_mfma_f32_16x16x32_bf16 v[232:235], v[108:111], v[140:143], v[232:235]
v_exp_f32 v81, v81
v_mfma_f32_16x16x32_bf16 v[236:239], v[112:115], v[136:139], v[236:239]
s_add_u32 m0, s35, 4864
v_exp_f32 v82, v82
v_mfma_f32_16x16x32_bf16 v[236:239], v[116:119], v[140:143], v[236:239]
s_waitcnt lgkmcnt(0)
buffer_load_dwordx4 v2, s[4:7], s37 offen offset:256 nt lds
v_mfma_f32_16x16x32_bf16 v[240:243], v[88:91], v[120:123], v[240:243]
v_exp_f32 v83, v83
v_mfma_f32_16x16x32_bf16 v[240:243], v[92:95], v[124:127], v[240:243]
v_exp_f32 v84, v84
v_mfma_f32_16x16x32_bf16 v[244:247], v[96:99], v[120:123], v[244:247]
s_add_u32 m0, s35, 5760
v_exp_f32 v85, v85
v_mfma_f32_16x16x32_bf16 v[244:247], v[100:103], v[124:127], v[244:247]
buffer_load_dwordx4 v1, s[4:7], s37 offen offset:384 nt lds
v_mfma_f32_16x16x32_bf16 v[248:251], v[104:107], v[120:123], v[248:251]
v_exp_f32 v86, v86
v_mfma_f32_16x16x32_bf16 v[248:251], v[108:111], v[124:127], v[248:251]
v_exp_f32 v87, v87
v_mfma_f32_16x16x32_bf16 v[252:255], v[112:115], v[120:123], v[252:255]
s_add_u32 m0, s35, 6784
v_cvt_pk_bf16_f32 v68, v68, v69
v_add_f32 v26, v26, v70
v_mfma_f32_16x16x32_bf16 v[252:255], v[116:119], v[124:127], v[252:255]
buffer_load_dwordx4 v2, s[4:7], s37 offen offset:384 nt lds
v_mfma_f32_16x16x32_bf16 v[60:63], a[224:227], a[0:3], v[32:35]
s_waitcnt vmcnt(9)
v_add_f32 v26, v26, v71
v_cvt_pk_bf16_f32 v69, v70, v71
v_mfma_f32_16x16x32_bf16 v[60:63], a[228:231], a[4:7], v[60:63]
s_add_u32 s37, s37, 32768
ds_write_b64 v11, v[68:69] offset:2048
v_add_f32 v27, v27, v72
v_mfma_f32_16x16x32_bf16 v[60:63], a[232:235], a[8:11], v[60:63]
s_xor_b32 s35, s35, 8192
ds_read_b64_tr_b16 v[88:89], v6 offset:0
v_add_f32 v27, v27, v73
v_mfma_f32_16x16x32_bf16 v[60:63], a[236:239], a[12:15], v[60:63]
s_cmp_lg_u32 s42, 0
ds_read_b64_tr_b16 v[90:91], v6 offset:2048
v_cvt_pk_bf16_f32 v72, v72, v73
v_mfma_f32_16x16x32_bf16 v[60:63], a[240:243], a[16:19], v[60:63]
s_cbranch_scc1 L_tr5
L_rt5:
ds_read_b64_tr_b16 v[92:93], v6 offset:4096
v_add_f32 v27, v27, v74
v_mfma_f32_16x16x32_bf16 v[60:63], a[244:247], a[20:23], v[60:63]
s_add_u32 m0, s36, 0
ds_read_b64_tr_b16 v[94:95], v6 offset:6144
v_add_f32 v27, v27, v75
v_mfma_f32_16x16x32_bf16 v[60:63], a[248:251], a[24:27], v[60:63]
s_add_u32 s44, s38, 0
ds_read_b64_tr_b16 v[96:97], v7 offset:0
v_cvt_pk_bf16_f32 v73, v74, v75
v_mfma_f32_16x16x32_bf16 v[60:63], a[252:255], a[28:31], v[60:63]
ds_write_b64 v11, v[72:73] offset:3072
v_add_f32 v28, v28, v76
v_mfma_f32_16x16x32_bf16 v[64:67], a[224:227], a[32:35], v[36:39]
ds_read_b64_tr_b16 v[98:99], v7 offset:2048
v_add_f32 v28, v28, v77
v_mfma_f32_16x16x32_bf16 v[64:67], a[228:231], a[36:39], v[64:67]
ds_read_b64_tr_b16 v[100:101], v7 offset:4096
v_cvt_pk_bf16_f32 v76, v76, v77
v_mfma_f32_16x16x32_bf16 v[64:67], a[232:235], a[40:43], v[64:67]
ds_read_b64_tr_b16 v[102:103], v7 offset:6144
v_max3_f32 v13, v60, v61, v62
v_mfma_f32_16x16x32_bf16 v[64:67], a[236:239], a[44:47], v[64:67]
ds_read_b64_tr_b16 v[104:105], v8 offset:0
v_max_f32 v13, v13, v63
v_mfma_f32_16x16x32_bf16 v[64:67], a[240:243], a[48:51], v[64:67]
ds_read_b64_tr_b16 v[106:107], v8 offset:2048
v_add_f32 v28, v28, v78
v_mfma_f32_16x16x32_bf16 v[64:67], a[244:247], a[52:55], v[64:67]
ds_read_b64_tr_b16 v[108:109], v8 offset:4096
v_add_f32 v28, v28, v79
v_mfma_f32_16x16x32_bf16 v[64:67], a[248:251], a[56:59], v[64:67]
ds_read_b64_tr_b16 v[110:111], v8 offset:6144
v_cvt_pk_bf16_f32 v77, v78, v79
v_mfma_f32_16x16x32_bf16 v[64:67], a[252:255], a[60:63], v[64:67]
ds_write_b64 v11, v[76:77] offset:4096
v_add_f32 v29, v29, v80
v_mfma_f32_16x16x32_bf16 v[68:71], a[224:227], a[64:67], v[40:43]
ds_read_b64_tr_b16 v[112:113], v9 offset:0
v_add_f32 v29, v29, v81
v_mfma_f32_16x16x32_bf16 v[68:71], a[228:231], a[68:71], v[68:71]
ds_read_b64_tr_b16 v[114:115], v9 offset:2048
v_cvt_pk_bf16_f32 v80, v80, v81
v_mfma_f32_16x16x32_bf16 v[68:71], a[232:235], a[72:75], v[68:71]
ds_read_b64_tr_b16 v[116:117], v9 offset:4096
v_max3_f32 v13, v13, v64, v65
v_mfma_f32_16x16x32_bf16 v[68:71], a[236:239], a[76:79], v[68:71]
ds_read_b64_tr_b16 v[118:119], v9 offset:6144
v_max3_f32 v13, v13, v66, v67
v_mfma_f32_16x16x32_bf16 v[68:71], a[240:243], a[80:83], v[68:71]
buffer_load_dwordx4 v3, s[8:11], s44 offen nt lds
v_mfma_f32_16x16x32_bf16 v[68:71], a[244:247], a[84:87], v[68:71]
s_add_u32 m0, s36, 1024
v_add_f32 v29, v29, v82
v_add_f32 v29, v29, v83
v_mfma_f32_16x16x32_bf16 v[68:71], a[248:251], a[88:91], v[68:71]
s_add_u32 s44, s38, 4096
v_cvt_pk_bf16_f32 v81, v82, v83
v_add_f32 v30, v30, v84
v_mfma_f32_16x16x32_bf16 v[68:71], a[252:255], a[92:95], v[68:71]
ds_write_b64 v11, v[80:81] offset:5120
v_add_f32 v30, v30, v85
v_mfma_f32_16x16x32_bf16 v[72:75], a[224:227], a[96:99], v[44:47]
buffer_load_dwordx4 v3, s[8:11], s44 offen nt lds
v_mfma_f32_16x16x32_bf16 v[72:75], a[228:231], a[100:103], v[72:75]
s_add_u32 m0, s36, 2048
v_cvt_pk_bf16_f32 v84, v84, v85
v_add_f32 v30, v30, v86
v_mfma_f32_16x16x32_bf16 v[72:75], a[232:235], a[104:107], v[72:75]
s_add_u32 s44, s38, 8192
v_max3_f32 v13, v13, v68, v69
v_max3_f32 v13, v13, v70, v71
v_mfma_f32_16x16x32_bf16 v[72:75], a[236:239], a[108:111], v[72:75]
v_add_f32 v30, v30, v87
v_cvt_pk_bf16_f32 v85, v86, v87
v_mfma_f32_16x16x32_bf16 v[72:75], a[240:243], a[112:115], v[72:75]
ds_write_b64 v11, v[84:85] offset:6144
v_add_u32 v11, s40, v11
v_mfma_f32_16x16x32_bf16 v[72:75], a[244:247], a[116:119], v[72:75]
buffer_load_dwordx4 v3, s[8:11], s44 offen nt lds
v_mfma_f32_16x16x32_bf16 v[72:75], a[248:251], a[120:123], v[72:75]
s_add_u32 m0, s36, 3072
v_subrev_u32 v10, s40, v10
v_xor_b32 v5, 8192, v5
v_mfma_f32_16x16x32_bf16 v[72:75], a[252:255], a[124:127], v[72:75]
s_add_u32 s44, s38, 12288
v_xor_b32 v6, 8192, v6
v_xor_b32 v7, 8192, v7
v_mfma_f32_16x16x32_bf16 v[76:79], a[224:227], a[128:131], v[48:51]
v_xor_b32 v8, 8192, v8
v_xor_b32 v9, 8192, v9
v_mfma_f32_16x16x32_bf16 v[76:79], a[228:231], a[132:135], v[76:79]
buffer_load_dwordx4 v3, s[8:11], s44 offen nt lds
v_mfma_f32_16x16x32_bf16 v[76:79], a[232:235], a[136:139], v[76:79]
s_add_u32 m0, s36, 4096
v_max3_f32 v13, v13, v72, v73
v_max3_f32 v13, v13, v74, v75
v_mfma_f32_16x16x32_bf16 v[76:79], a[236:239], a[140:143], v[76:79]
s_add_u32 s44, s38, 16384
v_mfma_f32_16x16x32_bf16 v[76:79], a[240:243], a[144:147], v[76:79]
v_mfma_f32_16x16x32_bf16 v[76:79], a[244:247], a[148:151], v[76:79]
buffer_load_dwordx4 v3, s[8:11], s44 offen nt lds
v_mfma_f32_16x16x32_bf16 v[76:79], a[248:251], a[152:155], v[76:79]
s_add_u32 m0, s36, 5120
s_add_u32 s44, s38, 20480
v_mfma_f32_16x16x32_bf16 v[76:79], a[252:255], a[156:159], v[76:79]
v_mfma_f32_16x16x32_bf16 v[80:83], a[224:227], a[160:163], v[52:55]
v_mfma_f32_16x16x32_bf16 v[80:83], a[228:231], a[164:167], v[80:83]
buffer_load_dwordx4 v3, s[8:11], s44 offen nt lds
v_mfma_f32_16x16x32_bf16 v[80:83], a[232:235], a[168:171], v[80:83]
s_add_u32 m0, s36, 6144
s_add_u32 s44, s38, 24576
v_mfma_f32_16x16x32_bf16 v[80:83], a[236:239], a[172:175], v[80:83]
v_mfma_f32_16x16x32_bf16 v[80:83], a[240:243], a[176:179], v[80:83]
v_mfma_f32_16x16x32_bf16 v[80:83], a[244:247], a[180:183], v[80:83]
buffer_load_dwordx4 v3, s[8:11], s44 offen nt lds
v_mfma_f32_16x16x32_bf16 v[80:83], a[248:251], a[184:187], v[80:83]
s_add_u32 m0, s36, 7168
v_max3_f32 v13, v13, v76, v77
v_max3_f32 v13, v13, v78, v79
v_mfma_f32_16x16x32_bf16 v[80:83], a[252:255], a[188:191], v[80:83]
s_add_u32 s44, s38, 28672
v_mfma_f32_16x16x32_bf16 v[84:87], a[224:227], a[192:195], v[56:59]
v_mfma_f32_16x16x32_bf16 v[84:87], a[228:231], a[196:199], v[84:87]
buffer_load_dwordx4 v3, s[8:11], s44 offen nt lds
v_mfma_f32_16x16x32_bf16 v[84:87], a[232:235], a[200:203], v[84:87]
s_add_u32 s38, s38, 32768
s_xor_b32 s36, s36, 8192
v_mfma_f32_16x16x32_bf16 v[84:87], a[236:239], a[204:207], v[84:87]
v_mfma_f32_16x16x32_bf16 v[84:87], a[240:243], a[208:211], v[84:87]
v_max3_f32 v13, v13, v80, v81
v_max3_f32 v13, v13, v82, v83
v_mfma_f32_16x16x32_bf16 v[84:87], a[244:247], a[212:215], v[84:87]
buffer_load_dword v31, v0, s[64:67], s48 idxen
v_mfma_f32_16x16x32_bf16 v[84:87], a[248:251], a[216:219], v[84:87]
s_add_u32 s48, s48, 1024
s_sub_u32 s40, 0, s40
s_add_u32 s39, s39, 1
v_mfma_f32_16x16x32_bf16 v[84:87], a[252:255], a[220:223], v[84:87]
s_nop 8
v_max3_f32 v13, v13, v84, v85
v_max3_f32 v13, v13, v86, v87
v_cmp_lt_f32 vcc, s43, v13
s_nop 0
s_cbranch_vccnz L_tr6
L_rt6:
s_sub_u32 s41, s41, 1
s_cmp_lg_u32 s41, 0
s_cbranch_scc1 L_loop
s_waitcnt lgkmcnt(0)
s_barrier
ds_read_b32 v15, v14
ds_read_b128 v[120:123], v10 offset:0
ds_read_b128 v[124:127], v10 offset:7168
ds_read_b128 v[128:131], v10 offset:1024
ds_read_b128 v[132:135], v10 offset:8192
ds_read_b128 v[136:139], v10 offset:2048
ds_read_b128 v[140:143], v10 offset:9216
s_waitcnt lgkmcnt(4)
v_mfma_f32_16x16x32_bf16 v[144:147], v[88:91], v[120:123], v[144:147]
s_nop 0
v_cmp_eq_u32 vcc, s39, v15
v_mfma_f32_16x16x32_bf16 v[144:147], v[92:95], v[124:127], v[144:147]
s_cbranch_vccnz L_tr7
L_rt7:
v_exp_f32 v60, v60
v_mfma_f32_16x16x32_bf16 v[148:151], v[96:99], v[120:123], v[148:151]
v_exp_f32 v61, v61
v_mfma_f32_16x16x32_bf16 v[148:151], v[100:103], v[124:127], v[148:151]
v_exp_f32 v62, v62
v_mfma_f32_16x16x32_bf16 v[152:155], v[104:107], v[120:123], v[152:155]
s_waitcnt vmcnt(9)
v_exp_f32 v63, v63
v_mfma_f32_16x16x32_bf16 v[152:155], v[108:111], v[124:127], v[152:155]
ds_read_b128 a[224:227], v4 offset:0
v_add_f32 v24, v24, v60
v_mfma_f32_16x16x32_bf16 v[156:159], v[112:115], v[120:123], v[156:159]
s_add_u32 m0, s35, 0
v_exp_f32 v64, v64
v_mfma_f32_16x16x32_bf16 v[156:159], v[116:119], v[124:127], v[156:159]
s_waitcnt lgkmcnt(3)
ds_read_b128 a[228:231], v5 offset:0
v_add_f32 v24, v24, v61
v_mfma_f32_16x16x32_bf16 v[160:163], v[88:91], v[128:131], v[160:163]
ds_read_b128 v[120:123], v10 offset:3072
v_cvt_pk_bf16_f32 v60, v60, v61
v_mfma_f32_16x16x32_bf16 v[160:163], v[92:95], v[132:135], v[160:163]
ds_read_b128 v[124:127], v10 offset:10240
v_add_f32 v24, v24, v62
v_mfma_f32_16x16x32_bf16 v[164:167], v[96:99], v[128:131], v[164:167]
ds_read_b128 a[232:235], v4 offset:2048
v_add_f32 v24, v24, v63
v_mfma_f32_16x16x32_bf16 v[164:167], v[100:103], v[132:135], v[164:167]
ds_read_b128 a[236:239], v5 offset:2048
v_cvt_pk_bf16_f32 v61, v62, v63
v_mfma_f32_16x16x32_bf16 v[168:171], v[104:107], v[128:131], v[168:171]
ds_write_b64 v11, v[60:61] offset:0
v_add_f32 v25, v25, v64
v_mfma_f32_16x16x32_bf16 v[168:171], v[108:111], v[132:135], v[168:171]
ds_read_b128 a[240:243], v4 offset:4096
v_xor_b32 v14, 4, v14
v_mfma_f32_16x16x32_bf16 v[172:175], v[112:115], v[128:131], v[172:175]
buffer_load_dwordx4 v1, s[4:7], s37 offen offset:0 nt lds
v_mfma_f32_16x16x32_bf16 v[172:175], v[116:119], v[132:135], v[172:175]
s_waitcnt lgkmcnt(8)
ds_read_b128 a[244:247], v5 offset:4096
s_add_u32 m0, s35, 1024
v_mfma_f32_16x16x32_bf16 v[176:179], v[88:91], v[136:139], v[176:179]
ds_read_b128 v[128:131], v10 offset:4096
v_mfma_f32_16x16x32_bf16 v[176:179], v[92:95], v[140:143], v[176:179]
ds_read_b128 v[132:135], v10 offset:11264
v_mfma_f32_16x16x32_bf16 v[180:183], v[96:99], v[136:139], v[180:183]
ds_read_b128 a[248:251], v4 offset:6144
v_mfma_f32_16x16x32_bf16 v[180:183], v[100:103], v[140:143], v[180:183]
ds_read_b128 a[252:255], v5 offset:6144
v_xor_b32 v4, 8192, v4
v_mfma_f32_16x16x32_bf16 v[184:187], v[104:107], v[136:139], v[184:187]
buffer_load_dwordx4 v2, s[4:7], s37 offen offset:0 nt lds
v_mfma_f32_16x16x32_bf16 v[184:187], v[108:111], v[140:143], v[184:187]
s_add_u32 m0, s35, 1920
v_exp_f32 v65, v65
v_mfma_f32_16x16x32_bf16 v[188:191], v[112:115], v[136:139], v[188:191]
v_exp_f32 v66, v66
v_mfma_f32_16x16x32_bf16 v[188:191], v[116:119], v[140:143], v[188:191]
s_waitcnt lgkmcnt(9)
v_exp_f32 v67, v67
v_mfma_f32_16x16x32_bf16 v[192:195], v[88:91], v[120:123], v[192:195]
ds_read_b128 v[136:139], v10 offset:5120
v_add_f32 v25, v25, v65
v_mfma_f32_16x16x32_bf16 v[192:195], v[92:95], v[124:127], v[192:195]
ds_read_b128 v[140:143], v10 offset:12288
v_cvt_pk_bf16_f32 v64, v64, v65
v_mfma_f32_16x16x32_bf16 v[196:199], v[96:99], v[120:123], v[196:199]
buffer_load_dwordx4 v1, s[4:7], s37 offen offset:128 nt lds
v_mfma_f32_16x16x32_bf16 v[196:199], v[100:103], v[124:127], v[196:199]
s_add_u32 m0, s35, 2944
v_exp_f32 v68, v68
v_mfma_f32_16x16x32_bf16 v[200:203], v[104:107], v[120:123], v[200:203]
v_exp_f32 v69, v69
v_mfma_f32_16x16x32_bf16 v[200:203], v[108:111], v[124:127], v[200:203]
v_exp_f32 v70, v70
v_mfma_f32_16x16x32_bf16 v[204:207], v[112:115], v[120:123], v[204:207]
buffer_load_dwordx4 v2, s[4:7], s37 offen offset:128 nt lds
v_mfma_f32_16x16x32_bf16 v[204:207], v[116:119], v[124:127], v[204:207]
s_waitcnt lgkmcnt(4)
v_exp_f32 v71, v71
v_mfma_f32_16x16x32_bf16 v[208:211], v[88:91], v[128:131], v[208:211]
s_add_u32 m0, s35, 3840
ds_read_b128 v[120:123], v10 offset:6144
v_add_f32 v25, v25, v66
v_mfma_f32_16x16x32_bf16 v[208:211], v[92:95], v[132:135], v[208:211]
ds_read_b128 v[124:127], v10 offset:13312
v_add_f32 v25, v25, v67
v_mfma_f32_16x16x32_bf16 v[212:215], v[96:99], v[128:131], v[212:215]
buffer_load_dwordx4 v1, s[4:7], s37 offen offset:256 nt lds
v_mfma_f32_16x16x32_bf16 v[212:215], v[100:103], v[132:135], v[212:215]
s_add_u32 m0, s35, 4864
v_exp_f32 v72, v72
v_mfma_f32_16x16x32_bf16 v[216:219], v[104:107], v[128:131], v[216:219]
v_exp_f32 v73, v73
v_mfma_f32_16x16x32_bf16 v[216:219], v[108:111], v[132:135], v[216:219]
v_exp_f32 v74, v74
v_mfma_f32_16x16x32_bf16 v[220:223], v[112:115], v[128:131], v[220:223]
buffer_load_dwordx4 v2, s[4:7], s37 offen offset:256 nt lds
v_mfma_f32_16x16x32_bf16 v[220:223], v[116:119], v[132:135], v[220:223]
s_waitcnt lgkmcnt(2)
v_exp_f32 v75, v75
v_mfma_f32_16x16x32_bf16 v[224:227], v[88:91], v[136:139], v[224:227]
s_add_u32 m0, s35, 5760
v_exp_f32 v76, v76
v_mfma_f32_16x16x32_bf16 v[224:227], v[92:95], v[140:143], v[224:227]
v_exp_f32 v77, v77
v_mfma_f32_16x16x32_bf16 v[228:231], v[96:99], v[136:139], v[228:231]
buffer_load_dwordx4 v1, s[4:7], s37 offen offset:384 nt lds
v_mfma_f32_16x16x32_bf16 v[228:231], v[100:103], v[140:143], v[228:231]
s_add_u32 m0, s35, 6784
v_exp_f32 v78, v78
v_mfma_f32_16x16x32_bf16 v[232:235], v[104:107], v[136:139], v[232:235]
v_exp_f32 v79, v79
v_mfma_f32_16x16x32_bf16 v[232:235], v[108:111], v[140:143], v[232:235]
v_exp_f32 v80, v80
v_mfma_f32_16x16x32_bf16 v[236:239], v[112:115], v[136:139], v[236:239]
buffer_load_dwordx4 v2, s[4:7], s37 offen offset:384 nt lds
v_mfma_f32_16x16x32_bf16 v[236:239], v[116:119], v[140:143], v[236:239]
s_waitcnt lgkmcnt(0)
v_exp_f32 v81, v81
v_mfma_f32_16x16x32_bf16 v[240:243], v[88:91], v[120:123], v[240:243]
s_add_u32 s37, s37, 32768
v_exp_f32 v82, v82
v_mfma_f32_16x16x32_bf16 v[240:243], v[92:95], v[124:127], v[240:243]
s_xor_b32 s35, s35, 8192
v_exp_f32 v83, v83
v_mfma_f32_16x16x32_bf16 v[244:247], v[96:99], v[120:123], v[244:247]
v_exp_f32 v84, v84
v_mfma_f32_16x16x32_bf16 v[244:247], v[100:103], v[124:127], v[244:247]
v_exp_f32 v85, v85
v_mfma_f32_16x16x32_bf16 v[248:251], v[104:107], v[120:123], v[248:251]
v_exp_f32 v86, v86
v_mfma_f32_16x16x32_bf16 v[248:251], v[108:111], v[124:127], v[248:251]
v_exp_f32 v87, v87
v_mfma_f32_16x16x32_bf16 v[252:255], v[112:115], v[120:123], v[252:255]
v_cvt_pk_bf16_f32 v65, v66, v67
v_add_f32 v26, v26, v68
v_mfma_f32_16x16x32_bf16 v[252:255], v[116:119], v[124:127], v[252:255]
ds_write_b64 v11, v[64:65] offset:1024
v_add_f32 v26, v26, v69
v_mfma_f32_16x16x32_bf16 v[60:63], a[224:227], a[0:3], v[32:35]
s_waitcnt vmcnt(9)
v_cvt_pk_bf16_f32 v68, v68, v69
v_add_f32 v26, v26, v70
v_mfma_f32_16x16x32_bf16 v[60:63], a[228:231], a[4:7], v[60:63]
s_cmp_lg_u32 s42, 0
ds_read_b64_tr_b16 v[88:89], v6 offset:0
v_add_f32 v26, v26, v71
v_mfma_f32_16x16x32_bf16 v[60:63], a[232:235], a[8:11], v[60:63]
s_cbranch_scc1 L_tr8
L_rt8:
ds_read_b64_tr_b16 v[90:91], v6 offset:2048
v_cvt_pk_bf16_f32 v69, v70, v71
v_mfma_f32_16x16x32_bf16 v[60:63], a[236:239], a[12:15], v[60:63]
s_add_u32 m0, s36, 0
ds_write_b64 v11, v[68:69] offset:2048
v_add_f32 v27, v27, v72
v_mfma_f32_16x16x32_bf16 v[60:63], a[240:243], a[16:19], v[60:63]
s_add_u32 s44, s38, 0
ds_read_b64_tr_b16 v[92:93], v6 offset:4096
v_add_f32 v27, v27, v73
v_mfma_f32_16x16x32_bf16 v[60:63], a[244:247], a[20:23], v[60:63]
ds_read_b64_tr_b16 v[94:95], v6 offset:6144
v_cvt_pk_bf16_f32 v72, v72, v73
v_mfma_f32_16x16x32_bf16 v[60:63], a[248:251], a[24:27], v[60:63]
ds_read_b64_tr_b16 v[96:97], v7 offset:0
v_add_f32 v27, v27, v74
v_mfma_f32_16x16x32_bf16 v[60:63], a[252:255], a[28:31], v[60:63]
ds_read_b64_tr_b16 v[98:99], v7 offset:2048
v_add_f32 v27, v27, v75
v_mfma_f32_16x16x32_bf16 v[64:67], a[224:227], a[32:35], v[36:39]
ds_read_b64_tr_b16 v[100:101], v7 offset:4096
v_cvt_pk_bf16_f32 v73, v74, v75
v_mfma_f32_16x16x32_bf16 v[64:67], a[228:231], a[36:39], v[64:67]
ds_write_b64 v11, v[72:73] offset:3072
v_add_f32 v28, v28, v76
v_mfma_f32_16x16x32_bf16 v[64:67], a[232:235], a[40:43], v[64:67]
ds_read_b64_tr_b16 v[102:103], v7 offset:6144
v_max3_f32 v13, v60, v61, v62
v_mfma_f32_16x16x32_bf16 v[64:67], a[236:239], a[44:47], v[64:67]
ds_read_b64_tr_b16 v[104:105], v8 offset:0
v_max_f32 v13, v13, v63
v_mfma_f32_16x16x32_bf16 v[64:67], a[240:243], a[48:51], v[64:67]
ds_read_b64_tr_b16 v[106:107], v8 offset:2048
v_add_f32 v28, v28, v77
v_mfma_f32_16x16x32_bf16 v[64:67], a[244:247], a[52:55], v[64:67]
ds_read_b64_tr_b16 v[108:109], v8 offset:4096
v_cvt_pk_bf16_f32 v76, v76, v77
v_mfma_f32_16x16x32_bf16 v[64:67], a[248:251], a[56:59], v[64:67]
ds_read_b64_tr_b16 v[110:111], v8 offset:6144
v_add_f32 v28, v28, v78
v_mfma_f32_16x16x32_bf16 v[64:67], a[252:255], a[60:63], v[64:67]
ds_read_b64_tr_b16 v[112:113], v9 offset:0
v_add_f32 v28, v28, v79
v_mfma_f32_16x16x32_bf16 v[68:71], a[224:227], a[64:67], v[40:43]
ds_read_b64_tr_b16 v[114:115], v9 offset:2048
v_cvt_pk_bf16_f32 v77, v78, v79
v_mfma_f32_16x16x32_bf16 v[68:71], a[228:231], a[68:71], v[68:71]
ds_write_b64 v11, v[76:77] offset:4096
v_add_f32 v29, v29, v80
v_mfma_f32_16x16x32_bf16 v[68:71], a[232:235], a[72:75], v[68:71]
ds_read_b64_tr_b16 v[116:117], v9 offset:4096
v_max3_f32 v13, v13, v64, v65
v_mfma_f32_16x16x32_bf16 v[68:71], a[236:239], a[76:79], v[68:71]
ds_read_b64_tr_b16 v[118:119], v9 offset:6144
v_max3_f32 v13, v13, v66, v67
v_mfma_f32_16x16x32_bf16 v[68:71], a[240:243], a[80:83], v[68:71]
buffer_load_dwordx4 v3, s[8:11], s44 offen nt lds
v_mfma_f32_16x16x32_bf16 v[68:71], a[244:247], a[84:87], v[68:71]
s_add_u32 m0, s36, 1024
v_add_f32 v29, v29, v81
v_cvt_pk_bf16_f32 v80, v80, v81
v_mfma_f32_16x16x32_bf16 v[68:71], a[248:251], a[88:91], v[68:71]
s_add_u32 s44, s38, 4096
v_add_f32 v29, v29, v82
v_add_f32 v29, v29, v83
v_mfma_f32_16x16x32_bf16 v[68:71], a[252:255], a[92:95], v[68:71]
v_cvt_pk_bf16_f32 v81, v82, v83
v_add_f32 v30, v30, v84
v_mfma_f32_16x16x32_bf16 v[72:75], a[224:227], a[96:99], v[44:47]
ds_write_b64 v11, v[80:81] offset:5120
v_add_f32 v30, v30, v85
v_mfma_f32_16x16x32_bf16 v[72:75], a[228:231], a[100:103], v[72:75]
buffer_load_dwordx4 v3, s[8:11], s44 offen nt lds
v_mfma_f32_16x16x32_bf16 v[72:75], a[232:235], a[104:107], v[72:75]
s_add_u32 m0, s36, 2048
v_max3_f32 v13, v13, v68, v69
v_max3_f32 v13, v13, v70, v71
v_mfma_f32_16x16x32_bf16 v[72:75], a[236:239], a[108:111], v[72:75]
s_add_u32 s44, s38, 8192
v_cvt_pk_bf16_f32 v84, v84, v85
v_add_f32 v30, v30, v86
v_mfma_f32_16x16x32_bf16 v[72:75], a[240:243], a[112:115], v[72:75]
v_add_f32 v30, v30, v87
v_cvt_pk_bf16_f32 v85, v86, v87
v_mfma_f32_16x16x32_bf16 v[72:75], a[244:247], a[116:119], v[72:75]
ds_write_b64 v11, v[84:85] offset:6144
v_add_u32 v11, s40, v11
v_mfma_f32_16x16x32_bf16 v[72:75], a[248:251], a[120:123], v[72:75]
buffer_load_dwordx4 v3, s[8:11], s44 offen nt lds
v_mfma_f32_16x16x32_bf16 v[72:75], a[252:255], a[124:127], v[72:75]
s_add_u32 m0, s36, 3072
v_subrev_u32 v10, s40, v10
v_xor_b32 v5, 8192, v5
v_mfma_f32_16x16x32_bf16 v[76:79], a[224:227], a[128:131], v[48:51]
s_add_u32 s44, s38, 12288
v_xor_b32 v6, 8192, v6
v_xor_b32 v7, 8192, v7
v_mfma_f32_16x16x32_bf16 v[76:79], a[228:231], a[132:135], v[76:79]
v_xor_b32 v8, 8192, v8
v_max3_f32 v13, v13, v72, v73
v_mfma_f32_16x16x32_bf16 v[76:79], a[232:235], a[136:139], v[76:79]
buffer_load_dwordx4 v3, s[8:11], s44 offen nt lds
v_mfma_f32_16x16x32_bf16 v[76:79], a[236:239], a[140:143], v[76:79]
s_add_u32 m0, s36, 4096
v_max3_f32 v13, v13, v74, v75
v_xor_b32 v9, 8192, v9
v_mfma_f32_16x16x32_bf16 v[76:79], a[240:243], a[144:147], v[76:79]
s_add_u32 s44, s38, 16384
v_mfma_f32_16x16x32_bf16 v[76:79], a[244:247], a[148:151], v[76:79]
v_mfma_f32_16x16x32_bf16 v[76:79], a[248:251], a[152:155], v[76:79]
buffer_load_dwordx4 v3, s[8:11], s44 offen nt lds
v_mfma_f32_16x16x32_bf16 v[76:79], a[252:255], a[156:159], v[76:79]
s_add_u32 m0, s36, 5120
s_add_u32 s44, s38, 20480
v_mfma_f32_16x16x32_bf16 v[80:83], a[224:227], a[160:163], v[52:55]
v_mfma_f32_16x16x32_bf16 v[80:83], a[228:231], a[164:167], v[80:83]
v_mfma_f32_16x16x32_bf16 v[80:83], a[232:235], a[168:171], v[80:83]
buffer_load_dwordx4 v3, s[8:11], s44 offen nt lds
v_mfma_f32_16x16x32_bf16 v[80:83], a[236:239], a[172:175], v[80:83]
s_add_u32 m0, s36, 6144
s_add_u32 s44, s38, 24576
v_mfma_f32_16x16x32_bf16 v[80:83], a[240:243], a[176:179], v[80:83]
v_max3_f32 v13, v13, v76, v77
v_max3_f32 v13, v13, v78, v79
v_mfma_f32_16x16x32_bf16 v[80:83], a[244:247], a[180:183], v[80:83]
v_mfma_f32_16x16x32_bf16 v[80:83], a[248:251], a[184:187], v[80:83]
buffer_load_dwordx4 v3, s[8:11], s44 offen nt lds
v_mfma_f32_16x16x32_bf16 v[80:83], a[252:255], a[188:191], v[80:83]
s_add_u32 m0, s36, 7168
s_add_u32 s44, s38, 28672
v_mfma_f32_16x16x32_bf16 v[84:87], a[224:227], a[192:195], v[56:59]
v_mfma_f32_16x16x32_bf16 v[84:87], a[228:231], a[196:199], v[84:87]
v_mfma_f32_16x16x32_bf16 v[84:87], a[232:235], a[200:203], v[84:87]
buffer_load_dwordx4 v3, s[8:11], s44 offen nt lds
v_mfma_f32_16x16x32_bf16 v[84:87], a[236:239], a[204:207], v[84:87]
s_add_u32 s38, s38, 32768
s_xor_b32 s36, s36, 8192
s_sub_u32 s40, 0, s40
v_mfma_f32_16x16x32_bf16 v[84:87], a[240:243], a[208:211], v[84:87]
s_add_u32 s39, s39, 1
v_max3_f32 v13, v13, v80, v81
v_max3_f32 v13, v13, v82, v83
v_mfma_f32_16x16x32_bf16 v[84:87], a[244:247], a[212:215], v[84:87]
v_mfma_f32_16x16x32_bf16 v[84:87], a[248:251], a[216:219], v[84:87]
v_mfma_f32_16x16x32_bf16 v[84:87], a[252:255], a[220:223], v[84:87]
s_nop 8
v_max3_f32 v13, v13, v84, v85
v_max3_f32 v13, v13, v86, v87
v_cmp_lt_f32 vcc, s43, v13
s_nop 0
s_cbranch_vccnz L_tr9
L_rt9:
s_waitcnt lgkmcnt(0)
s_barrier
ds_read_b32 v15, v14
ds_read_b128 v[120:123], v10 offset:0
ds_read_b128 v[124:127], v10 offset:7168
ds_read_b128 v[128:131], v10 offset:1024
ds_read_b128 v[132:135], v10 offset:8192
ds_read_b128 v[136:139], v10 offset:2048
ds_read_b128 v[140:143], v10 offset:9216
s_waitcnt lgkmcnt(4)
v_mfma_f32_16x16x32_bf16 v[144:147], v[88:91], v[120:123], v[144:147]
s_nop 0
v_cmp_eq_u32 vcc, s39, v15
s_mul_i32 s52, s32, 7168
v_mfma_f32_16x16x32_bf16 v[144:147], v[92:95], v[124:127], v[144:147]
s_cbranch_vccnz L_tr10
L_rt10:
v_exp_f32 v60, v60
v_mfma_f32_16x16x32_bf16 v[148:151], v[96:99], v[120:123], v[148:151]
s_add_u32 m0, s36, 0
v_exp_f32 v61, v61
v_mfma_f32_16x16x32_bf16 v[148:151], v[100:103], v[124:127], v[148:151]
s_add_u32 s44, s38, 0
buffer_load_dwordx4 v3, s[8:11], s44 offen nt lds
v_mfma_f32_16x16x32_bf16 v[152:155], v[104:107], v[120:123], v[152:155]
s_waitcnt vmcnt(9)
v_exp_f32 v62, v62
v_mfma_f32_16x16x32_bf16 v[152:155], v[108:111], v[124:127], v[152:155]
ds_read_b128 a[224:227], v4 offset:0
v_add_f32 v24, v24, v60
v_mfma_f32_16x16x32_bf16 v[156:159], v[112:115], v[120:123], v[156:159]
s_add_u32 m0, s36, 1024
v_exp_f32 v63, v63
v_mfma_f32_16x16x32_bf16 v[156:159], v[116:119], v[124:127], v[156:159]
s_waitcnt lgkmcnt(3)
ds_read_b128 a[228:231], v5 offset:0
v_add_f32 v24, v24, v61
v_mfma_f32_16x16x32_bf16 v[160:163], v[88:91], v[128:131], v[160:163]
s_add_u32 s44, s38, 4096
ds_read_b128 v[120:123], v10 offset:3072
v_cvt_pk_bf16_f32 v60, v60, v61
v_mfma_f32_16x16x32_bf16 v[160:163], v[92:95], v[132:135], v[160:163]
ds_read_b128 v[124:127], v10 offset:10240
v_add_f32 v24, v24, v62
v_mfma_f32_16x16x32_bf16 v[164:167], v[96:99], v[128:131], v[164:167]
ds_read_b128 a[232:235], v4 offset:2048
v_add_f32 v24, v24, v63
v_mfma_f32_16x16x32_bf16 v[164:167], v[100:103], v[132:135], v[164:167]
ds_read_b128 a[236:239], v5 offset:2048
v_cvt_pk_bf16_f32 v61, v62, v63
v_mfma_f32_16x16x32_bf16 v[168:171], v[104:107], v[128:131], v[168:171]
ds_write_b64 v11, v[60:61] offset:0
v_xor_b32 v14, 4, v14
v_mfma_f32_16x16x32_bf16 v[168:171], v[108:111], v[132:135], v[168:171]
ds_read_b128 a[240:243], v4 offset:4096
v_mfma_f32_16x16x32_bf16 v[172:175], v[112:115], v[128:131], v[172:175]
buffer_load_dwordx4 v3, s[8:11], s44 offen nt lds
v_mfma_f32_16x16x32_bf16 v[172:175], v[116:119], v[132:135], v[172:175]
s_waitcnt lgkmcnt(8)
ds_read_b128 a[244:247], v5 offset:4096
s_add_u32 m0, s36, 2048
v_mfma_f32_16x16x32_bf16 v[176:179], v[88:91], v[136:139], v[176:179]
s_add_u32 s44, s38, 8192
ds_read_b128 v[128:131], v10 offset:4096
v_mfma_f32_16x16x32_bf16 v[176:179], v[92:95], v[140:143], v[176:179]
ds_read_b128 v[132:135], v10 offset:11264
v_mfma_f32_16x16x32_bf16 v[180:183], v[96:99], v[136:139], v[180:183]
ds_read_b128 a[248:251], v4 offset:6144
v_mfma_f32_16x16x32_bf16 v[180:183], v[100:103], v[140:143], v[180:183]
ds_read_b128 a[252:255], v5 offset:6144
v_mfma_f32_16x16x32_bf16 v[184:187], v[104:107], v[136:139], v[184:187]
buffer_load_dwordx4 v3, s[8:11], s44 offen nt lds
v_mfma_f32_16x16x32_bf16 v[184:187], v[108:111], v[140:143], v[184:187]
s_add_u32 m0, s36, 3072
v_exp_f32 v64, v64
v_mfma_f32_16x16x32_bf16 v[188:191], v[112:115], v[136:139], v[188:191]
s_add_u32 s44, s38, 12288
v_exp_f32 v65, v65
v_mfma_f32_16x16x32_bf16 v[188:191], v[116:119], v[140:143], v[188:191]
s_waitcnt lgkmcnt(9)
v_exp_f32 v66, v66
v_mfma_f32_16x16x32_bf16 v[192:195], v[88:91], v[120:123], v[192:195]
ds_read_b128 v[136:139], v10 offset:5120
v_add_f32 v25, v25, v64
v_mfma_f32_16x16x32_bf16 v[192:195], v[92:95], v[124:127], v[192:195]
ds_read_b128 v[140:143], v10 offset:12288
v_add_f32 v25, v25, v65
v_mfma_f32_16x16x32_bf16 v[196:199], v[96:99], v[120:123], v[196:199]
buffer_load_dwordx4 v3, s[8:11], s44 offen nt lds
v_mfma_f32_16x16x32_bf16 v[196:199], v[100:103], v[124:127], v[196:199]
s_add_u32 m0, s36, 4096
v_exp_f32 v67, v67
v_mfma_f32_16x16x32_bf16 v[200:203], v[104:107], v[120:123], v[200:203]
s_add_u32 s44, s38, 16384
v_exp_f32 v68, v68
v_mfma_f32_16x16x32_bf16 v[200:203], v[108:111], v[124:127], v[200:203]
v_exp_f32 v69, v69
v_mfma_f32_16x16x32_bf16 v[204:207], v[112:115], v[120:123], v[204:207]
buffer_load_dwordx4 v3, s[8:11], s44 offen nt lds
v_mfma_f32_16x16x32_bf16 v[204:207], v[116:119], v[124:127], v[204:207]
s_waitcnt lgkmcnt(4)
v_exp_f32 v70, v70
v_mfma_f32_16x16x32_bf16 v[208:211], v[88:91], v[128:131], v[208:211]
s_add_u32 m0, s36, 5120
ds_read_b128 v[120:123], v10 offset:6144
v_cvt_pk_bf16_f32 v64, v64, v65
v_mfma_f32_16x16x32_bf16 v[208:211], v[92:95], v[132:135], v[208:211]
s_add_u32 s44, s38, 20480
ds_read_b128 v[124:127], v10 offset:13312
v_add_f32 v25, v25, v66
v_mfma_f32_16x16x32_bf16 v[212:215], v[96:99], v[128:131], v[212:215]
buffer_load_dwordx4 v3, s[8:11], s44 offen nt lds
v_mfma_f32_16x16x32_bf16 v[212:215], v[100:103], v[132:135], v[212:215]
s_add_u32 m0, s36, 6144
v_exp_f32 v71, v71
v_mfma_f32_16x16x32_bf16 v[216:219], v[104:107], v[128:131], v[216:219]
s_add_u32 s44, s38, 24576
v_exp_f32 v72, v72
v_mfma_f32_16x16x32_bf16 v[216:219], v[108:111], v[132:135], v[216:219]
v_exp_f32 v73, v73
v_mfma_f32_16x16x32_bf16 v[220:223], v[112:115], v[128:131], v[220:223]
buffer_load_dwordx4 v3, s[8:11], s44 offen nt lds
v_mfma_f32_16x16x32_bf16 v[220:223], v[116:119], v[132:135], v[220:223]
s_waitcnt lgkmcnt(2)
v_exp_f32 v74, v74
v_mfma_f32_16x16x32_bf16 v[224:227], v[88:91], v[136:139], v[224:227]
s_add_u32 m0, s36, 7168
v_exp_f32 v75, v75
v_mfma_f32_16x16x32_bf16 v[224:227], v[92:95], v[140:143], v[224:227]
s_add_u32 s44, s38, 28672
v_exp_f32 v76, v76
v_mfma_f32_16x16x32_bf16 v[228:231], v[96:99], v[136:139], v[228:231]
buffer_load_dwordx4 v3, s[8:11], s44 offen nt lds
v_mfma_f32_16x16x32_bf16 v[228:231], v[100:103], v[140:143], v[228:231]
s_add_u32 s38, s38, 32768
v_exp_f32 v77, v77
v_mfma_f32_16x16x32_bf16 v[232:235], v[104:107], v[136:139], v[232:235]
s_xor_b32 s36, s36, 8192
v_exp_f32 v78, v78
v_mfma_f32_16x16x32_bf16 v[232:235], v[108:111], v[140:143], v[232:235]
v_exp_f32 v79, v79
v_mfma_f32_16x16x32_bf16 v[236:239], v[112:115], v[136:139], v[236:239]
v_exp_f32 v80, v80
v_mfma_f32_16x16x32_bf16 v[236:239], v[116:119], v[140:143], v[236:239]
s_waitcnt lgkmcnt(0)
v_exp_f32 v81, v81
v_mfma_f32_16x16x32_bf16 v[240:243], v[88:91], v[120:123], v[240:243]
v_exp_f32 v82, v82
v_mfma_f32_16x16x32_bf16 v[240:243], v[92:95], v[124:127], v[240:243]
v_exp_f32 v83, v83
v_mfma_f32_16x16x32_bf16 v[244:247], v[96:99], v[120:123], v[244:247]
v_exp_f32 v84, v84
v_mfma_f32_16x16x32_bf16 v[244:247], v[100:103], v[124:127], v[244:247]
v_exp_f32 v85, v85
v_mfma_f32_16x16x32_bf16 v[248:251], v[104:107], v[120:123], v[248:251]
v_exp_f32 v86, v86
v_mfma_f32_16x16x32_bf16 v[248:251], v[108:111], v[124:127], v[248:251]
v_exp_f32 v87, v87
v_mfma_f32_16x16x32_bf16 v[252:255], v[112:115], v[120:123], v[252:255]
v_add_f32 v25, v25, v67
v_cvt_pk_bf16_f32 v65, v66, v67
v_mfma_f32_16x16x32_bf16 v[252:255], v[116:119], v[124:127], v[252:255]
ds_write_b64 v11, v[64:65] offset:1024
v_add_f32 v26, v26, v68
v_mfma_f32_16x16x32_bf16 v[60:63], a[224:227], a[0:3], v[32:35]
s_waitcnt vmcnt(8)
v_add_f32 v26, v26, v69
v_cvt_pk_bf16_f32 v68, v68, v69
v_mfma_f32_16x16x32_bf16 v[60:63], a[228:231], a[4:7], v[60:63]
s_cmp_lg_u32 s42, 0
ds_read_b64_tr_b16 v[88:89], v6 offset:0
v_add_f32 v26, v26, v70
v_mfma_f32_16x16x32_bf16 v[60:63], a[232:235], a[8:11], v[60:63]
s_cbranch_scc1 L_tr11
L_rt11:
ds_read_b64_tr_b16 v[90:91], v6 offset:2048
v_add_f32 v26, v26, v71
v_mfma_f32_16x16x32_bf16 v[60:63], a[236:239], a[12:15], v[60:63]
ds_read_b64_tr_b16 v[92:93], v6 offset:4096
v_cvt_pk_bf16_f32 v69, v70, v71
v_mfma_f32_16x16x32_bf16 v[60:63], a[240:243], a[16:19], v[60:63]
ds_write_b64 v11, v[68:69] offset:2048
v_add_f32 v27, v27, v72
v_mfma_f32_16x16x32_bf16 v[60:63], a[244:247], a[20:23], v[60:63]
ds_read_b64_tr_b16 v[94:95], v6 offset:6144
v_add_f32 v27, v27, v73
v_mfma_f32_16x16x32_bf16 v[60:63], a[248:251], a[24:27], v[60:63]
ds_read_b64_tr_b16 v[96:97], v7 offset:0
v_cvt_pk_bf16_f32 v72, v72, v73
v_mfma_f32_16x16x32_bf16 v[60:63], a[252:255], a[28:31], v[60:63]
ds_read_b64_tr_b16 v[98:99], v7 offset:2048
v_add_f32 v27, v27, v74
v_mfma_f32_16x16x32_bf16 v[64:67], a[224:227], a[32:35], v[36:39]
ds_read_b64_tr_b16 v[100:101], v7 offset:4096
v_add_f32 v27, v27, v75
v_mfma_f32_16x16x32_bf16 v[64:67], a[228:231], a[36:39], v[64:67]
ds_read_b64_tr_b16 v[102:103], v7 offset:6144
v_cvt_pk_bf16_f32 v73, v74, v75
v_mfma_f32_16x16x32_bf16 v[64:67], a[232:235], a[40:43], v[64:67]
ds_write_b64 v11, v[72:73] offset:3072
v_max3_f32 v13, v60, v61, v62
v_mfma_f32_16x16x32_bf16 v[64:67], a[236:239], a[44:47], v[64:67]
ds_read_b64_tr_b16 v[104:105], v8 offset:0
v_max_f32 v13, v13, v63
v_mfma_f32_16x16x32_bf16 v[64:67], a[240:243], a[48:51], v[64:67]
ds_read_b64_tr_b16 v[106:107], v8 offset:2048
v_add_f32 v28, v28, v76
v_mfma_f32_16x16x32_bf16 v[64:67], a[244:247], a[52:55], v[64:67]
ds_read_b64_tr_b16 v[108:109], v8 offset:4096
v_add_f32 v28, v28, v77
v_mfma_f32_16x16x32_bf16 v[64:67], a[248:251], a[56:59], v[64:67]
ds_read_b64_tr_b16 v[110:111], v8 offset:6144
v_cvt_pk_bf16_f32 v76, v76, v77
v_mfma_f32_16x16x32_bf16 v[64:67], a[252:255], a[60:63], v[64:67]
ds_read_b64_tr_b16 v[112:113], v9 offset:0
v_add_f32 v28, v28, v78
v_mfma_f32_16x16x32_bf16 v[68:71], a[224:227], a[64:67], v[40:43]
ds_read_b64_tr_b16 v[114:115], v9 offset:2048
v_add_f32 v28, v28, v79
v_mfma_f32_16x16x32_bf16 v[68:71], a[228:231], a[68:71], v[68:71]
ds_read_b64_tr_b16 v[116:117], v9 offset:4096
v_cvt_pk_bf16_f32 v77, v78, v79
v_mfma_f32_16x16x32_bf16 v[68:71], a[232:235], a[72:75], v[68:71]
ds_write_b64 v11, v[76:77] offset:4096
v_max3_f32 v13, v13, v64, v65
v_mfma_f32_16x16x32_bf16 v[68:71], a[236:239], a[76:79], v[68:71]
ds_read_b64_tr_b16 v[118:119], v9 offset:6144
v_max3_f32 v13, v13, v66, v67
v_mfma_f32_16x16x32_bf16 v[68:71], a[240:243], a[80:83], v[68:71]
v_add_f32 v29, v29, v80
v_add_f32 v29, v29, v81
v_mfma_f32_16x16x32_bf16 v[68:71], a[244:247], a[84:87], v[68:71]
v_cvt_pk_bf16_f32 v80, v80, v81
v_add_f32 v29, v29, v82
v_mfma_f32_16x16x32_bf16 v[68:71], a[248:251], a[88:91], v[68:71]
v_add_f32 v29, v29, v83
v_cvt_pk_bf16_f32 v81, v82, v83
v_mfma_f32_16x16x32_bf16 v[68:71], a[252:255], a[92:95], v[68:71]
ds_write_b64 v11, v[80:81] offset:5120
v_add_f32 v30, v30, v84
v_mfma_f32_16x16x32_bf16 v[72:75], a[224:227], a[96:99], v[44:47]
v_add_f32 v30, v30, v85
v_cvt_pk_bf16_f32 v84, v84, v85
v_mfma_f32_16x16x32_bf16 v[72:75], a[228:231], a[100:103], v[72:75]
v_add_f32 v30, v30, v86
v_add_f32 v30, v30, v87
v_mfma_f32_16x16x32_bf16 v[72:75], a[232:235], a[104:107], v[72:75]
v_max3_f32 v13, v13, v68, v69
v_max3_f32 v13, v13, v70, v71
v_mfma_f32_16x16x32_bf16 v[72:75], a[236:239], a[108:111], v[72:75]
v_cvt_pk_bf16_f32 v85, v86, v87
v_subrev_u32 v10, s40, v10
v_mfma_f32_16x16x32_bf16 v[72:75], a[240:243], a[112:115], v[72:75]
ds_write_b64 v11, v[84:85] offset:6144
v_add_u32 v11, s40, v11
v_mfma_f32_16x16x32_bf16 v[72:75], a[244:247], a[116:119], v[72:75]
s_sub_u32 s40, 0, s40
v_xor_b32 v6, 8192, v6
v_xor_b32 v7, 8192, v7
v_mfma_f32_16x16x32_bf16 v[72:75], a[248:251], a[120:123], v[72:75]
s_add_u32 s39, s39, 1
v_xor_b32 v8, 8192, v8
v_xor_b32 v9, 8192, v9
v_mfma_f32_16x16x32_bf16 v[72:75], a[252:255], a[124:127], v[72:75]
v_add_u32 v1, 0, v0
v_mul_u32_u24 v15, 1171, v1
v_mfma_f32_16x16x32_bf16 v[76:79], a[224:227], a[128:131], v[48:51]
v_bfe_u32 v15, v15, 17, 2
v_lshlrev_b32 v15, 1, v15
v_mfma_f32_16x16x32_bf16 v[76:79], a[228:231], a[132:135], v[76:79]
v_xor_b32 v1, v1, v15
v_lshl_add_u32 v1, v1, 4, s52
v_mfma_f32_16x16x32_bf16 v[76:79], a[232:235], a[136:139], v[76:79]
v_max3_f32 v13, v13, v72, v73
v_max3_f32 v13, v13, v74, v75
v_mfma_f32_16x16x32_bf16 v[76:79], a[236:239], a[140:143], v[76:79]
v_add_u32 v1, 256, v1
v_add_u32 v2, 64, v0
v_mfma_f32_16x16x32_bf16 v[76:79], a[240:243], a[144:147], v[76:79]
v_mul_u32_u24 v15, 1171, v2
v_bfe_u32 v15, v15, 17, 2
v_mfma_f32_16x16x32_bf16 v[76:79], a[244:247], a[148:151], v[76:79]
v_lshlrev_b32 v15, 1, v15
v_xor_b32 v2, v2, v15
v_mfma_f32_16x16x32_bf16 v[76:79], a[248:251], a[152:155], v[76:79]
v_lshl_add_u32 v2, v2, 4, s52
v_add_u32 v2, -768, v2
v_mfma_f32_16x16x32_bf16 v[76:79], a[252:255], a[156:159], v[76:79]
v_add_u32 v4, 192, v0
v_mul_u32_u24 v15, 1171, v4
v_mfma_f32_16x16x32_bf16 v[80:83], a[224:227], a[160:163], v[52:55]
v_bfe_u32 v15, v15, 17, 2
v_lshlrev_b32 v15, 1, v15
v_mfma_f32_16x16x32_bf16 v[80:83], a[228:231], a[164:167], v[80:83]
v_xor_b32 v4, v4, v15
v_lshl_add_u32 v4, v4, 4, s52
v_mfma_f32_16x16x32_bf16 v[80:83], a[232:235], a[168:171], v[80:83]
v_max3_f32 v13, v13, v76, v77
v_max3_f32 v13, v13, v78, v79
v_mfma_f32_16x16x32_bf16 v[80:83], a[236:239], a[172:175], v[80:83]
v_add_u32 v4, -2816, v4
v_add_u32 v5, 256, v0
v_mfma_f32_16x16x32_bf16 v[80:83], a[240:243], a[176:179], v[80:83]
v_mul_u32_u24 v15, 1171, v5
v_bfe_u32 v15, v15, 17, 2
v_mfma_f32_16x16x32_bf16 v[80:83], a[244:247], a[180:183], v[80:83]
v_lshlrev_b32 v15, 1, v15
v_xor_b32 v5, v5, v15
v_mfma_f32_16x16x32_bf16 v[80:83], a[248:251], a[184:187], v[80:83]
v_lshl_add_u32 v5, v5, 4, s52
v_add_u32 v5, 256, v5
v_mfma_f32_16x16x32_bf16 v[80:83], a[252:255], a[188:191], v[80:83]
v_add_u32 v3, 128, v0
v_mul_u32_u24 v15, 1171, v3
v_mfma_f32_16x16x32_bf16 v[84:87], a[224:227], a[192:195], v[56:59]
v_bfe_u32 v15, v15, 17, 2
v_lshlrev_b32 v15, 1, v15
v_mfma_f32_16x16x32_bf16 v[84:87], a[228:231], a[196:199], v[84:87]
v_xor_b32 v3, v3, v15
v_lshl_add_u32 v3, v3, 4, s52
v_mfma_f32_16x16x32_bf16 v[84:87], a[232:235], a[200:203], v[84:87]
v_max3_f32 v13, v13, v80, v81
v_max3_f32 v13, v13, v82, v83
v_mfma_f32_16x16x32_bf16 v[84:87], a[236:239], a[204:207], v[84:87]
v_add_u32 v3, -1792, v3
v_mfma_f32_16x16x32_bf16 v[84:87], a[240:243], a[208:211], v[84:87]
v_mfma_f32_16x16x32_bf16 v[84:87], a[244:247], a[212:215], v[84:87]
v_mfma_f32_16x16x32_bf16 v[84:87], a[248:251], a[216:219], v[84:87]
v_mfma_f32_16x16x32_bf16 v[84:87], a[252:255], a[220:223], v[84:87]
s_nop 8
v_max3_f32 v13, v13, v84, v85
v_max3_f32 v13, v13, v86, v87
v_cmp_lt_f32 vcc, s43, v13
s_nop 0
s_cbranch_vccnz L_tr12
L_rt12:
s_waitcnt lgkmcnt(0)
s_barrier
ds_read_b32 v15, v14
ds_read_b128 v[120:123], v10 offset:0
ds_read_b128 v[124:127], v10 offset:7168
ds_read_b128 v[128:131], v10 offset:1024
ds_read_b128 v[132:135], v10 offset:8192
ds_read_b128 v[136:139], v10 offset:2048
ds_read_b128 v[140:143], v10 offset:9216
s_waitcnt lgkmcnt(4)
v_mfma_f32_16x16x32_bf16 v[144:147], v[88:91], v[120:123], v[144:147]
s_nop 0
v_cmp_eq_u32 vcc, s39, v15
s_mul_i32 s52, s32, 7168
v_mfma_f32_16x16x32_bf16 v[144:147], v[92:95], v[124:127], v[144:147]
s_cbranch_vccnz L_tr13
L_rt13:
v_add_u32 v13, 320, v0
v_mul_u32_u24 v15, 1171, v13
v_mfma_f32_16x16x32_bf16 v[148:151], v[96:99], v[120:123], v[148:151]
s_mov_b32 s53, 0
v_bfe_u32 v15, v15, 17, 2
v_lshlrev_b32 v15, 1, v15
v_mfma_f32_16x16x32_bf16 v[148:151], v[100:103], v[124:127], v[148:151]
s_add_u32 m0, s52, 0
v_xor_b32 v13, v13, v15
v_lshl_add_u32 v13, v13, 4, s52
v_mfma_f32_16x16x32_bf16 v[152:155], v[104:107], v[120:123], v[152:155]
buffer_load_dwordx4 v1, s[24:27], s53 offen offset:0 lds
v_mfma_f32_16x16x32_bf16 v[152:155], v[108:111], v[124:127], v[152:155]
v_add_u32 v13, -768, v13
v_add_u32 v14, 384, v0
v_mfma_f32_16x16x32_bf16 v[156:159], v[112:115], v[120:123], v[156:159]
v_mul_u32_u24 v15, 1171, v14
v_bfe_u32 v15, v15, 17, 2
v_mfma_f32_16x16x32_bf16 v[156:159], v[116:119], v[124:127], v[156:159]
s_waitcnt lgkmcnt(2)
v_lshlrev_b32 v15, 1, v15
v_xor_b32 v14, v14, v15
v_mfma_f32_16x16x32_bf16 v[160:163], v[88:91], v[128:131], v[160:163]
ds_read_b128 v[120:123], v10 offset:3072
v_lshl_add_u32 v14, v14, 4, s52
v_mfma_f32_16x16x32_bf16 v[160:163], v[92:95], v[132:135], v[160:163]
ds_read_b128 v[124:127], v10 offset:10240
v_add_u32 v14, -1792, v14
v_mfma_f32_16x16x32_bf16 v[164:167], v[96:99], v[128:131], v[164:167]
buffer_load_dwordx4 v2, s[24:27], s53 offen offset:1024 lds
v_mfma_f32_16x16x32_bf16 v[164:167], v[100:103], v[132:135], v[164:167]
v_exp_f32 v60, v60
v_mfma_f32_16x16x32_bf16 v[168:171], v[104:107], v[128:131], v[168:171]
v_exp_f32 v61, v61
v_mfma_f32_16x16x32_bf16 v[168:171], v[108:111], v[132:135], v[168:171]
v_exp_f32 v62, v62
v_mfma_f32_16x16x32_bf16 v[172:175], v[112:115], v[128:131], v[172:175]
buffer_load_dwordx4 v3, s[24:27], s53 offen offset:2048 lds
v_mfma_f32_16x16x32_bf16 v[172:175], v[116:119], v[132:135], v[172:175]
s_waitcnt lgkmcnt(2)
v_exp_f32 v63, v63
v_mfma_f32_16x16x32_bf16 v[176:179], v[88:91], v[136:139], v[176:179]
ds_read_b128 v[128:131], v10 offset:4096
v_add_f32 v24, v24, v60
v_mfma_f32_16x16x32_bf16 v[176:179], v[92:95], v[140:143], v[176:179]
ds_read_b128 v[132:135], v10 offset:11264
v_add_f32 v24, v24, v61
v_mfma_f32_16x16x32_bf16 v[180:183], v[96:99], v[136:139], v[180:183]
buffer_load_dwordx4 v4, s[24:27], s53 offen offset:3072 lds
v_mfma_f32_16x16x32_bf16 v[180:183], v[100:103], v[140:143], v[180:183]
s_add_u32 m0, s52, 4096
v_exp_f32 v64, v64
v_mfma_f32_16x16x32_bf16 v[184:187], v[104:107], v[136:139], v[184:187]
v_exp_f32 v65, v65
v_mfma_f32_16x16x32_bf16 v[184:187], v[108:111], v[140:143], v[184:187]
v_exp_f32 v66, v66
v_mfma_f32_16x16x32_bf16 v[188:191], v[112:115], v[136:139], v[188:191]
buffer_load_dwordx4 v5, s[24:27], s53 offen offset:0 lds
v_mfma_f32_16x16x32_bf16 v[188:191], v[116:119], v[140:143], v[188:191]
s_waitcnt lgkmcnt(2)
v_exp_f32 v67, v67
v_mfma_f32_16x16x32_bf16 v[192:195], v[88:91], v[120:123], v[192:195]
ds_read_b128 v[136:139], v10 offset:5120
v_cvt_pk_bf16_f32 v60, v60, v61
v_mfma_f32_16x16x32_bf16 v[192:195], v[92:95], v[124:127], v[192:195]
ds_read_b128 v[140:143], v10 offset:12288
v_add_f32 v24, v24, v62
v_mfma_f32_16x16x32_bf16 v[196:199], v[96:99], v[120:123], v[196:199]
buffer_load_dwordx4 v13, s[24:27], s53 offen offset:1024 lds
v_mfma_f32_16x16x32_bf16 v[196:199], v[100:103], v[124:127], v[196:199]
v_exp_f32 v68, v68
v_mfma_f32_16x16x32_bf16 v[200:203], v[104:107], v[120:123], v[200:203]
v_exp_f32 v69, v69
v_mfma_f32_16x16x32_bf16 v[200:203], v[108:111], v[124:127], v[200:203]
v_exp_f32 v70, v70
v_mfma_f32_16x16x32_bf16 v[204:207], v[112:115], v[120:123], v[204:207]
buffer_load_dwordx4 v14, s[24:27], s53 offen offset:2048 lds
v_mfma_f32_16x16x32_bf16 v[204:207], v[116:119], v[124:127], v[204:207]
s_waitcnt lgkmcnt(2)
v_exp_f32 v71, v71
v_mfma_f32_16x16x32_bf16 v[208:211], v[88:91], v[128:131], v[208:211]
s_mov_b32 s53, 28672
ds_read_b128 v[120:123], v10 offset:6144
v_add_f32 v24, v24, v63
v_mfma_f32_16x16x32_bf16 v[208:211], v[92:95], v[132:135], v[208:211]
s_add_u32 m0, s52, 28672
ds_read_b128 v[124:127], v10 offset:13312
v_cvt_pk_bf16_f32 v61, v62, v63
v_mfma_f32_16x16x32_bf16 v[212:215], v[96:99], v[128:131], v[212:215]
ds_write_b64 v11, v[60:61] offset:0
v_add_f32 v25, v25, v64
v_mfma_f32_16x16x32_bf16 v[212:215], v[100:103], v[132:135], v[212:215]
buffer_load_dwordx4 v1, s[24:27], s53 offen offset:0 lds
v_mfma_f32_16x16x32_bf16 v[216:219], v[104:107], v[128:131], v[216:219]
v_exp_f32 v72, v72
v_mfma_f32_16x16x32_bf16 v[216:219], v[108:111], v[132:135], v[216:219]
v_exp_f32 v73, v73
v_mfma_f32_16x16x32_bf16 v[220:223], v[112:115], v[128:131], v[220:223]
v_exp_f32 v74, v74
v_mfma_f32_16x16x32_bf16 v[220:223], v[116:119], v[132:135], v[220:223]
s_waitcnt lgkmcnt(3)
buffer_load_dwordx4 v2, s[24:27], s53 offen offset:1024 lds
v_mfma_f32_16x16x32_bf16 v[224:227], v[88:91], v[136:139], v[224:227]
v_exp_f32 v75, v75
v_mfma_f32_16x16x32_bf16 v[224:227], v[92:95], v[140:143], v[224:227]
v_exp_f32 v76, v76
v_mfma_f32_16x16x32_bf16 v[228:231], v[96:99], v[136:139], v[228:231]
v_exp_f32 v77, v77
v_mfma_f32_16x16x32_bf16 v[228:231], v[100:103], v[140:143], v[228:231]
buffer_load_dwordx4 v3, s[24:27], s53 offen offset:2048 lds
v_mfma_f32_16x16x32_bf16 v[232:235], v[104:107], v[136:139], v[232:235]
v_exp_f32 v78, v78
v_mfma_f32_16x16x32_bf16 v[232:235], v[108:111], v[140:143], v[232:235]
v_exp_f32 v79, v79
v_mfma_f32_16x16x32_bf16 v[236:239], v[112:115], v[136:139], v[236:239]
v_exp_f32 v80, v80
v_mfma_f32_16x16x32_bf16 v[236:239], v[116:119], v[140:143], v[236:239]
s_waitcnt lgkmcnt(1)
buffer_load_dwordx4 v4, s[24:27], s53 offen offset:3072 lds
v_mfma_f32_16x16x32_bf16 v[240:243], v[88:91], v[120:123], v[240:243]
s_add_u32 m0, s52, 32768
v_exp_f32 v81, v81
v_mfma_f32_16x16x32_bf16 v[240:243], v[92:95], v[124:127], v[240:243]
s_mul_i32 s37, s32, 7
v_exp_f32 v82, v82
v_mfma_f32_16x16x32_bf16 v[244:247], v[96:99], v[120:123], v[244:247]
v_exp_f32 v83, v83
v_mfma_f32_16x16x32_bf16 v[244:247], v[100:103], v[124:127], v[244:247]
buffer_load_dwordx4 v5, s[24:27], s53 offen offset:0 lds
v_mfma_f32_16x16x32_bf16 v[248:251], v[104:107], v[120:123], v[248:251]
v_exp_f32 v84, v84
v_mfma_f32_16x16x32_bf16 v[248:251], v[108:111], v[124:127], v[248:251]
v_exp_f32 v85, v85
v_mfma_f32_16x16x32_bf16 v[252:255], v[112:115], v[120:123], v[252:255]
v_exp_f32 v86, v86
v_mfma_f32_16x16x32_bf16 v[252:255], v[116:119], v[124:127], v[252:255]
buffer_load_dwordx4 v13, s[24:27], s53 offen offset:1024 lds
s_waitcnt vmcnt(13)
ds_read_b64_tr_b16 v[88:89], v6 offset:0
buffer_load_dwordx4 v14, s[24:27], s53 offen offset:2048 lds
v_add_f32 v25, v25, v65
v_add_f32 v25, v25, v66
v_add_f32 v25, v25, v67
v_cvt_pk_bf16_f32 v64, v64, v65
v_cvt_pk_bf16_f32 v65, v66, v67
ds_write_b64 v11, v[64:65] offset:1024
v_add_f32 v26, v26, v68
v_add_f32 v26, v26, v69
v_add_f32 v26, v26, v70
v_add_f32 v26, v26, v71
v_cvt_pk_bf16_f32 v68, v68, v69
v_cvt_pk_bf16_f32 v69, v70, v71
ds_write_b64 v11, v[68:69] offset:2048
v_add_f32 v27, v27, v72
v_add_f32 v27, v27, v73
v_add_f32 v27, v27, v74
v_add_f32 v27, v27, v75
v_cvt_pk_bf16_f32 v72, v72, v73
v_cvt_pk_bf16_f32 v73, v74, v75
ds_write_b64 v11, v[72:73] offset:3072
v_add_f32 v28, v28, v76
v_add_f32 v28, v28, v77
v_add_f32 v28, v28, v78
v_add_f32 v28, v28, v79
v_cvt_pk_bf16_f32 v76, v76, v77
v_cvt_pk_bf16_f32 v77, v78, v79
ds_write_b64 v11, v[76:77] offset:4096
v_add_f32 v29, v29, v80
v_add_f32 v29, v29, v81
v_add_f32 v29, v29, v82
v_add_f32 v29, v29, v83
v_cvt_pk_bf16_f32 v80, v80, v81
v_cvt_pk_bf16_f32 v81, v82, v83
ds_write_b64 v11, v[80:81] offset:5120
v_add_f32 v30, v30, v84
v_add_f32 v30, v30, v85
v_add_f32 v30, v30, v86
v_exp_f32 v87, v87
v_cvt_pk_bf16_f32 v84, v84, v85
v_subrev_u32 v10, s40, v10
v_lshrrev_b32 v40, 2, v0
v_mul_u32_u24 v40, 896, v40
v_and_b32 v41, 3, v0
v_lshl_add_u32 v40, v41, 3, v40
v_bfe_u32 v41, v0, 3, 2
v_mov_b32 v42, s37
v_add_u32 v48, 0, v42
v_xor_b32 v48, v48, v41
v_lshl_add_u32 v48, v48, 5, v40
v_add_u32 v49, 1, v42
v_xor_b32 v49, v49, v41
v_lshl_add_u32 v49, v49, 5, v40
v_add_u32 v50, 2, v42
v_xor_b32 v50, v50, v41
v_lshl_add_u32 v50, v50, 5, v40
v_add_u32 v51, 3, v42
v_xor_b32 v51, v51, v41
v_lshl_add_u32 v51, v51, 5, v40
v_add_u32 v52, 4, v42
v_xor_b32 v52, v52, v41
v_lshl_add_u32 v52, v52, 5, v40
v_add_u32 v53, 5, v42
v_xor_b32 v53, v53, v41
v_lshl_add_u32 v53, v53, 5, v40
v_add_u32 v54, 6, v42
v_xor_b32 v54, v54, v41
v_lshl_add_u32 v54, v54, 5, v40
s_cmp_lg_u32 s42, 0
ds_read_b64_tr_b16 v[90:91], v6 offset:2048
v_add_f32 v30, v30, v87
v_cvt_pk_bf16_f32 v85, v86, v87
ds_write_b64 v11, v[84:85] offset:6144
v_add_u32 v11, s40, v11
s_cbranch_scc1 L_tr14
L_rt14:
ds_read_b64_tr_b16 v[92:93], v6 offset:4096
s_sub_u32 s40, 0, s40
ds_read_b64_tr_b16 v[94:95], v6 offset:6144
s_add_u32 s39, s39, 1
ds_read_b64_tr_b16 v[96:97], v7 offset:0
ds_read_b64_tr_b16 v[98:99], v7 offset:2048
ds_read_b64_tr_b16 v[100:101], v7 offset:4096
ds_read_b64_tr_b16 v[102:103], v7 offset:6144
ds_read_b64_tr_b16 v[104:105], v8 offset:0
ds_read_b64_tr_b16 v[106:107], v8 offset:2048
ds_read_b64_tr_b16 v[108:109], v8 offset:4096
ds_read_b64_tr_b16 v[110:111], v8 offset:6144
ds_read_b64_tr_b16 v[112:113], v9 offset:0
ds_read_b64_tr_b16 v[114:115], v9 offset:2048
ds_read_b64_tr_b16 v[116:117], v9 offset:4096
ds_read_b64_tr_b16 v[118:119], v9 offset:6144
v_xor_b32 v6, 8192, v6
v_xor_b32 v7, 8192, v7
v_xor_b32 v8, 8192, v8
v_xor_b32 v9, 8192, v9
s_waitcnt vmcnt(0)
s_waitcnt lgkmcnt(0)
s_barrier
ds_read_b128 v[120:123], v10 offset:0
ds_read_b128 v[124:127], v10 offset:7168
ds_read_b128 v[128:131], v10 offset:1024
ds_read_b128 v[132:135], v10 offset:8192
ds_read_b128 v[136:139], v10 offset:2048
ds_read_b128 v[140:143], v10 offset:9216
s_waitcnt lgkmcnt(4)
v_mfma_f32_16x16x32_bf16 v[144:147], v[88:91], v[120:123], v[144:147]
s_mov_b32 s53, 57344
v_mov_b32 v60, v24
v_mov_b32 v61, v25
v_mfma_f32_16x16x32_bf16 v[144:147], v[92:95], v[124:127], v[144:147]
s_add_u32 m0, s52, 57344
v_permlane32_swap_b32 v24, v60
v_permlane32_swap_b32 v25, v61
v_mfma_f32_16x16x32_bf16 v[148:151], v[96:99], v[120:123], v[148:151]
ds_read_b64_tr_b16 a[200:201], v48 offset:0
v_add_f32 v24, v24, v60
v_mfma_f32_16x16x32_bf16 v[148:151], v[100:103], v[124:127], v[148:151]
ds_read_b64_tr_b16 a[202:203], v48 offset:14336
v_add_f32 v25, v25, v61
v_mfma_f32_16x16x32_bf16 v[152:155], v[104:107], v[120:123], v[152:155]
buffer_load_dwordx4 v1, s[24:27], s53 offen offset:0 lds
v_mfma_f32_16x16x32_bf16 v[152:155], v[108:111], v[124:127], v[152:155]
ds_read_b64_tr_b16 a[204:205], v49 offset:0
v_mov_b32 v60, v24
v_mfma_f32_16x16x32_bf16 v[156:159], v[112:115], v[120:123], v[156:159]
ds_read_b64_tr_b16 a[206:207], v49 offset:14336
v_permlane16_swap_b32 v24, v60
v_mfma_f32_16x16x32_bf16 v[156:159], v[116:119], v[124:127], v[156:159]
s_waitcnt lgkmcnt(6)
v_add_f32 v24, v24, v60
v_mov_b32 v61, v25
v_mfma_f32_16x16x32_bf16 v[160:163], v[88:91], v[128:131], v[160:163]
ds_read_b128 v[120:123], v10 offset:3072
v_permlane16_swap_b32 v25, v61
v_mfma_f32_16x16x32_bf16 v[160:163], v[92:95], v[132:135], v[160:163]
ds_read_b128 v[124:127], v10 offset:10240
v_add_f32 v25, v25, v61
v_mfma_f32_16x16x32_bf16 v[164:167], v[96:99], v[128:131], v[164:167]
ds_read_b64_tr_b16 a[208:209], v50 offset:0
v_mov_b32 v62, v26
v_mfma_f32_16x16x32_bf16 v[164:167], v[100:103], v[132:135], v[164:167]
ds_read_b64_tr_b16 a[210:211], v50 offset:14336
v_permlane32_swap_b32 v26, v62
v_mfma_f32_16x16x32_bf16 v[168:171], v[104:107], v[128:131], v[168:171]
ds_read_b64_tr_b16 a[212:213], v51 offset:0
v_add_f32 v26, v26, v62
v_mfma_f32_16x16x32_bf16 v[168:171], v[108:111], v[132:135], v[168:171]
ds_read_b64_tr_b16 a[214:215], v51 offset:14336
v_mov_b32 v62, v26
v_mfma_f32_16x16x32_bf16 v[172:175], v[112:115], v[128:131], v[172:175]
ds_read_b64_tr_b16 a[216:217], v52 offset:0
v_permlane16_swap_b32 v26, v62
v_mfma_f32_16x16x32_bf16 v[172:175], v[116:119], v[132:135], v[172:175]
s_waitcnt lgkmcnt(11)
ds_read_b64_tr_b16 a[218:219], v52 offset:14336
v_add_f32 v26, v26, v62
v_mfma_f32_16x16x32_bf16 v[176:179], v[88:91], v[136:139], v[176:179]
ds_read_b128 v[128:131], v10 offset:4096
v_mov_b32 v63, v27
v_mfma_f32_16x16x32_bf16 v[176:179], v[92:95], v[140:143], v[176:179]
ds_read_b128 v[132:135], v10 offset:11264
v_permlane32_swap_b32 v27, v63
v_mfma_f32_16x16x32_bf16 v[180:183], v[96:99], v[136:139], v[180:183]
ds_read_b64_tr_b16 a[220:221], v53 offset:0
v_add_f32 v27, v27, v63
v_mfma_f32_16x16x32_bf16 v[180:183], v[100:103], v[140:143], v[180:183]
ds_read_b64_tr_b16 a[222:223], v53 offset:14336
v_mov_b32 v63, v27
v_mfma_f32_16x16x32_bf16 v[184:187], v[104:107], v[136:139], v[184:187]
ds_read_b64_tr_b16 a[224:225], v54 offset:0
v_permlane16_swap_b32 v27, v63
v_mfma_f32_16x16x32_bf16 v[184:187], v[108:111], v[140:143], v[184:187]
ds_read_b64_tr_b16 a[226:227], v54 offset:14336
v_add_f32 v27, v27, v63
v_mfma_f32_16x16x32_bf16 v[188:191], v[112:115], v[136:139], v[188:191]
buffer_load_dwordx4 v2, s[24:27], s53 offen offset:1024 lds
v_mfma_f32_16x16x32_bf16 v[188:191], v[116:119], v[140:143], v[188:191]
s_waitcnt lgkmcnt(12)
ds_read_b64_tr_b16 a[228:229], v48 offset:28672
v_mov_b32 v64, v28
v_mfma_f32_16x16x32_bf16 v[192:195], v[88:91], v[120:123], v[192:195]
ds_read_b64_tr_b16 a[230:231], v48 offset:43008
v_permlane32_swap_b32 v28, v64
v_mfma_f32_16x16x32_bf16 v[192:195], v[92:95], v[124:127], v[192:195]
ds_read_b128 v[136:139], v10 offset:5120
v_add_f32 v28, v28, v64
v_mfma_f32_16x16x32_bf16 v[196:199], v[96:99], v[120:123], v[196:199]
ds_read_b128 v[140:143], v10 offset:12288
v_mov_b32 v64, v28
v_mfma_f32_16x16x32_bf16 v[196:199], v[100:103], v[124:127], v[196:199]
ds_read_b64_tr_b16 a[232:233], v49 offset:28672
v_permlane16_swap_b32 v28, v64
v_mfma_f32_16x16x32_bf16 v[200:203], v[104:107], v[120:123], v[200:203]
ds_read_b64_tr_b16 a[234:235], v49 offset:43008
v_add_f32 v28, v28, v64
v_mfma_f32_16x16x32_bf16 v[200:203], v[108:111], v[124:127], v[200:203]
ds_read_b64_tr_b16 a[236:237], v50 offset:28672
v_mov_b32 v65, v29
v_mfma_f32_16x16x32_bf16 v[204:207], v[112:115], v[120:123], v[204:207]
ds_read_b64_tr_b16 a[238:239], v50 offset:43008
v_permlane32_swap_b32 v29, v65
v_mfma_f32_16x16x32_bf16 v[204:207], v[116:119], v[124:127], v[204:207]
s_waitcnt lgkmcnt(12)
buffer_load_dwordx4 v3, s[24:27], s53 offen offset:2048 lds
v_mfma_f32_16x16x32_bf16 v[208:211], v[88:91], v[128:131], v[208:211]
ds_read_b128 v[120:123], v10 offset:6144
v_add_f32 v29, v29, v65
v_mfma_f32_16x16x32_bf16 v[208:211], v[92:95], v[132:135], v[208:211]
ds_read_b128 v[124:127], v10 offset:13312
v_mov_b32 v65, v29
v_mfma_f32_16x16x32_bf16 v[212:215], v[96:99], v[128:131], v[212:215]
ds_read_b64_tr_b16 a[240:241], v51 offset:28672
v_permlane16_swap_b32 v29, v65
v_mfma_f32_16x16x32_bf16 v[212:215], v[100:103], v[132:135], v[212:215]
ds_read_b64_tr_b16 a[242:243], v51 offset:43008
v_add_f32 v29, v29, v65
v_mfma_f32_16x16x32_bf16 v[216:219], v[104:107], v[128:131], v[216:219]
ds_read_b64_tr_b16 a[244:245], v52 offset:28672
v_mov_b32 v66, v30
v_mfma_f32_16x16x32_bf16 v[216:219], v[108:111], v[132:135], v[216:219]
ds_read_b64_tr_b16 a[246:247], v52 offset:43008
v_permlane32_swap_b32 v30, v66
v_mfma_f32_16x16x32_bf16 v[220:223], v[112:115], v[128:131], v[220:223]
ds_read_b64_tr_b16 a[248:249], v53 offset:28672
v_add_f32 v30, v30, v66
v_mfma_f32_16x16x32_bf16 v[220:223], v[116:119], v[132:135], v[220:223]
s_waitcnt lgkmcnt(11)
ds_read_b64_tr_b16 a[250:251], v53 offset:43008
v_mov_b32 v66, v30
v_mfma_f32_16x16x32_bf16 v[224:227], v[88:91], v[136:139], v[224:227]
buffer_load_dwordx4 v4, s[24:27], s53 offen offset:3072 lds
v_mfma_f32_16x16x32_bf16 v[224:227], v[92:95], v[140:143], v[224:227]
s_add_u32 m0, s52, 61440
ds_read_b64_tr_b16 a[252:253], v54 offset:28672
v_permlane16_swap_b32 v30, v66
v_mfma_f32_16x16x32_bf16 v[228:231], v[96:99], v[136:139], v[228:231]
ds_read_b64_tr_b16 a[254:255], v54 offset:43008
v_add_f32 v30, v30, v66
v_mfma_f32_16x16x32_bf16 v[228:231], v[100:103], v[140:143], v[228:231]
v_and_b32 v12, 15, v0
v_lshlrev_b32 v12, 4, v12
v_mfma_f32_16x16x32_bf16 v[232:235], v[104:107], v[136:139], v[232:235]
buffer_load_dwordx4 v5, s[24:27], s53 offen offset:0 lds
v_mfma_f32_16x16x32_bf16 v[232:235], v[108:111], v[140:143], v[232:235]
v_add_u32 v12, 160320, v12
v_lshl_add_u32 v15, s32, 2, v12
v_mfma_f32_16x16x32_bf16 v[236:239], v[112:115], v[136:139], v[236:239]
ds_write_b32 v15, v24 offset:0
v_mfma_f32_16x16x32_bf16 v[236:239], v[116:119], v[140:143], v[236:239]
s_waitcnt lgkmcnt(9)
ds_write_b32 v15, v25 offset:256
v_mfma_f32_16x16x32_bf16 v[240:243], v[88:91], v[120:123], v[240:243]
ds_write_b32 v15, v26 offset:512
v_mfma_f32_16x16x32_bf16 v[240:243], v[92:95], v[124:127], v[240:243]
ds_write_b32 v15, v27 offset:768
v_mfma_f32_16x16x32_bf16 v[244:247], v[96:99], v[120:123], v[244:247]
ds_write_b32 v15, v28 offset:1024
v_mfma_f32_16x16x32_bf16 v[244:247], v[100:103], v[124:127], v[244:247]
ds_write_b32 v15, v29 offset:1280
v_mfma_f32_16x16x32_bf16 v[248:251], v[104:107], v[120:123], v[248:251]
ds_write_b32 v15, v30 offset:1536
v_mfma_f32_16x16x32_bf16 v[248:251], v[108:111], v[124:127], v[248:251]
buffer_load_dwordx4 v13, s[24:27], s53 offen offset:1024 lds
v_mfma_f32_16x16x32_bf16 v[252:255], v[112:115], v[120:123], v[252:255]
v_mfma_f32_16x16x32_bf16 v[252:255], v[116:119], v[124:127], v[252:255]
v_lshlrev_b32 v10, 4, v0
v_mov_b32 v15, v12
s_lshl_b32 s44, s32, 13
s_add_u32 s44, s44, 86016
v_add_u32 v11, s44, v10
v_and_b32 v12, 0x37, v0
s_lshl_b32 s45, s51, 3
v_or_b32 v12, s45, v12
v_lshlrev_b32 v12, 4, v12
v_bfe_u32 v6, v0, 3, 1
v_lshl_add_u32 v12, v6, 15, v12
v_add_u32 v12, s44, v12
s_waitcnt lgkmcnt(0)
s_barrier
ds_read_b128 v[60:63], v15 offset:0
ds_read_b128 v[64:67], v15 offset:256
ds_read_b128 v[68:71], v15 offset:512
ds_read_b128 v[72:75], v15 offset:768
ds_read_b128 v[76:79], v15 offset:1024
ds_read_b128 v[80:83], v15 offset:1280
ds_read_b128 v[84:87], v15 offset:1536
buffer_load_dwordx4 v14, s[24:27], s53 offen offset:2048 lds
v_add_u32 v48, 57344, v48
v_add_u32 v49, 57344, v49
v_add_u32 v50, 57344, v50
v_add_u32 v51, 57344, v51
v_add_u32 v52, 57344, v52
v_add_u32 v53, 57344, v53
v_add_u32 v54, 57344, v54
v_add_u32 v6, 86016, v10
s_waitcnt lgkmcnt(0)
v_add_f32 v60, v60, v61
v_add_f32 v62, v62, v63
v_add_f32 v64, v64, v65
v_add_f32 v66, v66, v67
v_add_f32 v68, v68, v69
v_add_f32 v70, v70, v71
v_add_f32 v72, v72, v73
v_add_f32 v74, v74, v75
v_add_f32 v76, v76, v77
v_add_f32 v78, v78, v79
v_add_f32 v80, v80, v81
v_add_f32 v82, v82, v83
v_add_f32 v84, v84, v85
v_add_f32 v86, v86, v87
v_add_f32 v60, v60, v62
v_add_f32 v64, v64, v66
v_add_f32 v68, v68, v70
v_add_f32 v72, v72, v74
v_add_f32 v76, v76, v78
v_add_f32 v80, v80, v82
v_add_f32 v84, v84, v86
v_rcp_f32 v16, v60
v_rcp_f32 v18, v64
v_rcp_f32 v20, v68
v_rcp_f32 v22, v72
v_rcp_f32 v24, v76
v_rcp_f32 v26, v80
v_rcp_f32 v28, v84
v_pk_mul_f32 v[144:145], v[144:145], v[16:17] op_sel_hi:[1,0]
v_pk_mul_f32 v[146:147], v[146:147], v[16:17] op_sel_hi:[1,0]
v_pk_mul_f32 v[148:149], v[148:149], v[16:17] op_sel_hi:[1,0]
v_pk_mul_f32 v[150:151], v[150:151], v[16:17] op_sel_hi:[1,0]
v_cvt_pk_bf16_f32 v144, v144, v145
v_cvt_pk_bf16_f32 v145, v146, v147
v_cvt_pk_bf16_f32 v146, v148, v149
v_cvt_pk_bf16_f32 v147, v150, v151
ds_write_b128 v11, v[144:147] offset:0
s_mov_b32 s53, 86016
s_add_u32 m0, s52, 0
s_nop 0
buffer_load_dwordx4 v1, s[24:27], s53 offen offset:0 lds
v_pk_mul_f32 v[152:153], v[152:153], v[16:17] op_sel_hi:[1,0]
v_pk_mul_f32 v[154:155], v[154:155], v[16:17] op_sel_hi:[1,0]
v_pk_mul_f32 v[156:157], v[156:157], v[16:17] op_sel_hi:[1,0]
v_pk_mul_f32 v[158:159], v[158:159], v[16:17] op_sel_hi:[1,0]
v_cvt_pk_bf16_f32 v152, v152, v153
v_cvt_pk_bf16_f32 v153, v154, v155
v_cvt_pk_bf16_f32 v154, v156, v157
v_cvt_pk_bf16_f32 v155, v158, v159
ds_write_b128 v11, v[152:155] offset:4096
buffer_load_dwordx4 v2, s[24:27], s53 offen offset:1024 lds
v_pk_mul_f32 v[160:161], v[160:161], v[18:19] op_sel_hi:[1,0]
v_pk_mul_f32 v[162:163], v[162:163], v[18:19] op_sel_hi:[1,0]
v_pk_mul_f32 v[164:165], v[164:165], v[18:19] op_sel_hi:[1,0]
v_pk_mul_f32 v[166:167], v[166:167], v[18:19] op_sel_hi:[1,0]
v_cvt_pk_bf16_f32 v160, v160, v161
v_cvt_pk_bf16_f32 v161, v162, v163
v_cvt_pk_bf16_f32 v162, v164, v165
v_cvt_pk_bf16_f32 v163, v166, v167
ds_write_b128 v11, v[160:163] offset:1024
buffer_load_dwordx4 v3, s[24:27], s53 offen offset:2048 lds
v_pk_mul_f32 v[168:169], v[168:169], v[18:19] op_sel_hi:[1,0]
v_pk_mul_f32 v[170:171], v[170:171], v[18:19] op_sel_hi:[1,0]
v_pk_mul_f32 v[172:173], v[172:173], v[18:19] op_sel_hi:[1,0]
v_pk_mul_f32 v[174:175], v[174:175], v[18:19] op_sel_hi:[1,0]
v_cvt_pk_bf16_f32 v168, v168, v169
v_cvt_pk_bf16_f32 v169, v170, v171
v_cvt_pk_bf16_f32 v170, v172, v173
v_cvt_pk_bf16_f32 v171, v174, v175
ds_write_b128 v11, v[168:171] offset:5120
buffer_load_dwordx4 v4, s[24:27], s53 offen offset:3072 lds
v_pk_mul_f32 v[176:177], v[176:177], v[20:21] op_sel_hi:[1,0]
v_pk_mul_f32 v[178:179], v[178:179], v[20:21] op_sel_hi:[1,0]
v_pk_mul_f32 v[180:181], v[180:181], v[20:21] op_sel_hi:[1,0]
v_pk_mul_f32 v[182:183], v[182:183], v[20:21] op_sel_hi:[1,0]
v_cvt_pk_bf16_f32 v176, v176, v177
v_cvt_pk_bf16_f32 v177, v178, v179
v_cvt_pk_bf16_f32 v178, v180, v181
v_cvt_pk_bf16_f32 v179, v182, v183
ds_write_b128 v11, v[176:179] offset:2048
s_add_u32 m0, s52, 4096
s_nop 0
buffer_load_dwordx4 v5, s[24:27], s53 offen offset:0 lds
v_pk_mul_f32 v[184:185], v[184:185], v[20:21] op_sel_hi:[1,0]
v_pk_mul_f32 v[186:187], v[186:187], v[20:21] op_sel_hi:[1,0]
v_pk_mul_f32 v[188:189], v[188:189], v[20:21] op_sel_hi:[1,0]
v_pk_mul_f32 v[190:191], v[190:191], v[20:21] op_sel_hi:[1,0]
v_cvt_pk_bf16_f32 v184, v184, v185
v_cvt_pk_bf16_f32 v185, v186, v187
v_cvt_pk_bf16_f32 v186, v188, v189
v_cvt_pk_bf16_f32 v187, v190, v191
ds_write_b128 v11, v[184:187] offset:6144
buffer_load_dwordx4 v13, s[24:27], s53 offen offset:1024 lds
v_pk_mul_f32 v[192:193], v[192:193], v[22:23] op_sel_hi:[1,0]
v_pk_mul_f32 v[194:195], v[194:195], v[22:23] op_sel_hi:[1,0]
v_pk_mul_f32 v[196:197], v[196:197], v[22:23] op_sel_hi:[1,0]
v_pk_mul_f32 v[198:199], v[198:199], v[22:23] op_sel_hi:[1,0]
v_cvt_pk_bf16_f32 v192, v192, v193
v_cvt_pk_bf16_f32 v193, v194, v195
v_cvt_pk_bf16_f32 v194, v196, v197
v_cvt_pk_bf16_f32 v195, v198, v199
ds_write_b128 v12, v[192:195] offset:3072
buffer_load_dwordx4 v14, s[24:27], s53 offen offset:2048 lds
v_pk_mul_f32 v[200:201], v[200:201], v[22:23] op_sel_hi:[1,0]
v_pk_mul_f32 v[202:203], v[202:203], v[22:23] op_sel_hi:[1,0]
v_pk_mul_f32 v[204:205], v[204:205], v[22:23] op_sel_hi:[1,0]
v_pk_mul_f32 v[206:207], v[206:207], v[22:23] op_sel_hi:[1,0]
v_cvt_pk_bf16_f32 v200, v200, v201
v_cvt_pk_bf16_f32 v201, v202, v203
v_cvt_pk_bf16_f32 v202, v204, v205
v_cvt_pk_bf16_f32 v203, v206, v207
ds_write_b128 v12, v[200:203] offset:7168
s_waitcnt lgkmcnt(0)
s_waitcnt vmcnt(7)
s_barrier
ds_read_b128 a[0:3], v6 offset:0
ds_read_b128 a[4:7], v6 offset:1024
ds_read_b128 a[8:11], v6 offset:2048
ds_read_b128 a[12:15], v6 offset:3072
ds_read_b128 a[16:19], v6 offset:4096
ds_read_b128 a[20:23], v6 offset:5120
ds_read_b128 a[24:27], v6 offset:6144
ds_read_b128 a[28:31], v6 offset:7168
s_waitcnt lgkmcnt(7)
v_mfma_f32_16x16x32_bf16 v[96:99], a[200:203], a[0:3], 0
s_waitcnt lgkmcnt(6)
ds_read_b128 a[32:35], v6 offset:8192
v_mul_f32 v208, v24, v208
v_mfma_f32_16x16x32_bf16 v[100:103], a[200:203], a[4:7], 0
s_waitcnt lgkmcnt(6)
ds_read_b128 a[36:39], v6 offset:9216
v_mul_f32 v209, v24, v209
v_mfma_f32_16x16x32_bf16 v[104:107], a[200:203], a[8:11], 0
s_waitcnt lgkmcnt(6)
ds_read_b128 a[40:43], v6 offset:10240
v_mul_f32 v210, v24, v210
v_mfma_f32_16x16x32_bf16 v[108:111], a[200:203], a[12:15], 0
s_mov_b32 s53, 114688
ds_read_b128 a[44:47], v6 offset:11264
v_mul_f32 v211, v24, v211
v_mfma_f32_16x16x32_bf16 v[112:115], a[204:207], a[0:3], 0
s_add_u32 m0, s52, 28672
ds_read_b128 a[48:51], v6 offset:12288
v_mul_f32 v212, v24, v212
v_mfma_f32_16x16x32_bf16 v[116:119], a[204:207], a[4:7], 0
buffer_load_dwordx4 v1, s[24:27], s53 offen offset:0 lds
v_mfma_f32_16x16x32_bf16 v[120:123], a[204:207], a[8:11], 0
ds_read_b128 a[52:55], v6 offset:13312
v_mul_f32 v213, v24, v213
v_mfma_f32_16x16x32_bf16 v[124:127], a[204:207], a[12:15], 0
ds_read_b128 a[56:59], v6 offset:14336
v_mul_f32 v214, v24, v214
v_mfma_f32_16x16x32_bf16 v[128:131], a[208:211], a[0:3], 0
buffer_load_dwordx4 v2, s[24:27], s53 offen offset:1024 lds
v_mfma_f32_16x16x32_bf16 v[132:135], a[208:211], a[4:7], 0
ds_read_b128 a[60:63], v6 offset:15360
v_mul_f32 v215, v24, v215
v_mfma_f32_16x16x32_bf16 v[136:139], a[208:211], a[8:11], 0
ds_read_b128 a[64:67], v6 offset:16384
v_cvt_pk_bf16_f32 v208, v208, v209
v_mfma_f32_16x16x32_bf16 v[140:143], a[208:211], a[12:15], 0
buffer_load_dwordx4 v3, s[24:27], s53 offen offset:2048 lds
v_mfma_f32_16x16x32_bf16 v[144:147], a[212:215], a[0:3], 0
ds_read_b128 a[68:71], v6 offset:17408
v_cvt_pk_bf16_f32 v209, v210, v211
v_mfma_f32_16x16x32_bf16 v[148:151], a[212:215], a[4:7], 0
ds_read_b128 a[72:75], v6 offset:18432
v_cvt_pk_bf16_f32 v210, v212, v213
v_mfma_f32_16x16x32_bf16 v[152:155], a[212:215], a[8:11], 0
buffer_load_dwordx4 v4, s[24:27], s53 offen offset:3072 lds
v_mfma_f32_16x16x32_bf16 v[156:159], a[212:215], a[12:15], 0
s_add_u32 m0, s52, 32768
ds_read_b128 a[76:79], v6 offset:19456
v_cvt_pk_bf16_f32 v211, v214, v215
v_mfma_f32_16x16x32_bf16 v[160:163], a[216:219], a[0:3], 0
ds_write_b128 v11, v[208:211] offset:32768
v_mul_f32 v216, v24, v216
v_mfma_f32_16x16x32_bf16 v[164:167], a[216:219], a[4:7], 0
buffer_load_dwordx4 v5, s[24:27], s53 offen offset:0 lds
v_mfma_f32_16x16x32_bf16 v[168:171], a[216:219], a[8:11], 0
ds_read_b128 a[80:83], v6 offset:20480
v_mul_f32 v217, v24, v217
v_mfma_f32_16x16x32_bf16 v[172:175], a[216:219], a[12:15], 0
ds_read_b128 a[84:87], v6 offset:21504
v_mul_f32 v218, v24, v218
v_mfma_f32_16x16x32_bf16 v[176:179], a[220:223], a[0:3], 0
buffer_load_dwordx4 v13, s[24:27], s53 offen offset:1024 lds
v_mfma_f32_16x16x32_bf16 v[180:183], a[220:223], a[4:7], 0
ds_read_b128 a[88:91], v6 offset:22528
v_mul_f32 v219, v24, v219
v_mfma_f32_16x16x32_bf16 v[184:187], a[220:223], a[8:11], 0
ds_read_b128 a[92:95], v6 offset:23552
v_mul_f32 v220, v24, v220
v_mfma_f32_16x16x32_bf16 v[188:191], a[220:223], a[12:15], 0
buffer_load_dwordx4 v14, s[24:27], s53 offen offset:2048 lds
v_mfma_f32_16x16x32_bf16 v[192:195], a[224:227], a[0:3], 0
ds_read_b128 a[96:99], v6 offset:24576
v_mul_f32 v221, v24, v221
v_mfma_f32_16x16x32_bf16 v[196:199], a[224:227], a[4:7], 0
ds_read_b128 a[100:103], v6 offset:25600
v_mul_f32 v222, v24, v222
v_mfma_f32_16x16x32_bf16 v[200:203], a[224:227], a[8:11], 0
ds_read_b128 a[104:107], v6 offset:26624
v_mul_f32 v223, v24, v223
v_mfma_f32_16x16x32_bf16 v[204:207], a[224:227], a[12:15], 0
s_waitcnt lgkmcnt(15)
ds_read_b128 a[108:111], v6 offset:27648
v_cvt_pk_bf16_f32 v216, v216, v217
v_mfma_f32_16x16x32_bf16 v[96:99], a[228:231], a[16:19], v[96:99]
s_waitcnt lgkmcnt(0)
s_barrier
ds_read_b128 a[112:115], v6 offset:28672
v_mfma_f32_16x16x32_bf16 v[100:103], a[228:231], a[20:23], v[100:103]
s_mov_b32 s53, 143360
ds_read_b128 a[116:119], v6 offset:29696
v_cvt_pk_bf16_f32 v217, v218, v219
v_mfma_f32_16x16x32_bf16 v[104:107], a[228:231], a[24:27], v[104:107]
s_add_u32 m0, s52, 86016
ds_read_b128 a[120:123], v6 offset:30720
v_cvt_pk_bf16_f32 v218, v220, v221
v_mfma_f32_16x16x32_bf16 v[108:111], a[228:231], a[28:31], v[108:111]
buffer_load_dwordx4 v1, s[24:27], s53 offen offset:0 lds
v_mfma_f32_16x16x32_bf16 v[112:115], a[232:235], a[16:19], v[112:115]
ds_read_b128 a[124:127], v6 offset:31744
v_cvt_pk_bf16_f32 v219, v222, v223
v_mfma_f32_16x16x32_bf16 v[116:119], a[232:235], a[20:23], v[116:119]
ds_write_b128 v11, v[216:219] offset:36864
v_mul_f32 v224, v26, v224
v_mfma_f32_16x16x32_bf16 v[120:123], a[232:235], a[24:27], v[120:123]
buffer_load_dwordx4 v2, s[24:27], s53 offen offset:1024 lds
v_mfma_f32_16x16x32_bf16 v[124:127], a[232:235], a[28:31], v[124:127]
v_mul_f32 v225, v26, v225
v_mul_f32 v226, v26, v226
v_mfma_f32_16x16x32_bf16 v[128:131], a[236:239], a[16:19], v[128:131]
s_nop 0
ds_read_b64_tr_b16 v[84:85], v48 offset:0
ds_read_b64_tr_b16 v[86:87], v48 offset:14336
v_mfma_f32_16x16x32_bf16 v[132:135], a[236:239], a[20:23], v[132:135]
buffer_load_dwordx4 v3, s[24:27], s53 offen offset:2048 lds
v_mfma_f32_16x16x32_bf16 v[136:139], a[236:239], a[24:27], v[136:139]
v_add_u32 v48, -57344, v48
v_mul_f32 v227, v26, v227
v_mfma_f32_16x16x32_bf16 v[140:143], a[236:239], a[28:31], v[140:143]
v_mul_f32 v228, v26, v228
v_mul_f32 v229, v26, v229
v_mfma_f32_16x16x32_bf16 v[144:147], a[240:243], a[16:19], v[144:147]
buffer_load_dwordx4 v4, s[24:27], s53 offen offset:3072 lds
v_mfma_f32_16x16x32_bf16 v[148:151], a[240:243], a[20:23], v[148:151]
s_add_u32 m0, s52, 90112
ds_read_b64_tr_b16 v[88:89], v49 offset:0
ds_read_b64_tr_b16 v[90:91], v49 offset:14336
v_mfma_f32_16x16x32_bf16 v[152:155], a[240:243], a[24:27], v[152:155]
v_add_u32 v49, -57344, v49
v_mul_f32 v230, v26, v230
v_mfma_f32_16x16x32_bf16 v[156:159], a[240:243], a[28:31], v[156:159]
buffer_load_dwordx4 v5, s[24:27], s53 offen offset:0 lds
v_mfma_f32_16x16x32_bf16 v[160:163], a[244:247], a[16:19], v[160:163]
s_nop 0
ds_read_b64_tr_b16 v[60:61], v50 offset:0
ds_read_b64_tr_b16 v[62:63], v50 offset:14336
v_mfma_f32_16x16x32_bf16 v[164:167], a[244:247], a[20:23], v[164:167]
v_add_u32 v50, -57344, v50
v_mul_f32 v231, v26, v231
v_mfma_f32_16x16x32_bf16 v[168:171], a[244:247], a[24:27], v[168:171]
buffer_load_dwordx4 v13, s[24:27], s53 offen offset:1024 lds
v_mfma_f32_16x16x32_bf16 v[172:175], a[244:247], a[28:31], v[172:175]
v_cvt_pk_bf16_f32 v224, v224, v225
v_cvt_pk_bf16_f32 v225, v226, v227
v_mfma_f32_16x16x32_bf16 v[176:179], a[248:251], a[16:19], v[176:179]
s_nop 0
ds_read_b64_tr_b16 v[64:65], v51 offset:0
ds_read_b64_tr_b16 v[66:67], v51 offset:14336
v_mfma_f32_16x16x32_bf16 v[180:183], a[248:251], a[20:23], v[180:183]
buffer_load_dwordx4 v14, s[24:27], s53 offen offset:2048 lds
v_mfma_f32_16x16x32_bf16 v[184:187], a[248:251], a[24:27], v[184:187]
v_add_u32 v51, -57344, v51
v_cvt_pk_bf16_f32 v226, v228, v229
v_mfma_f32_16x16x32_bf16 v[188:191], a[248:251], a[28:31], v[188:191]
v_cvt_pk_bf16_f32 v227, v230, v231
v_mul_f32 v232, v26, v232
v_mfma_f32_16x16x32_bf16 v[192:195], a[252:255], a[16:19], v[192:195]
ds_write_b128 v11, v[224:227] offset:33792
v_mul_f32 v233, v26, v233
v_mfma_f32_16x16x32_bf16 v[196:199], a[252:255], a[20:23], v[196:199]
s_nop 0
ds_read_b64_tr_b16 v[68:69], v52 offset:0
ds_read_b64_tr_b16 v[70:71], v52 offset:14336
v_mfma_f32_16x16x32_bf16 v[200:203], a[252:255], a[24:27], v[200:203]
v_add_u32 v52, -57344, v52
v_mul_f32 v234, v26, v234
v_mfma_f32_16x16x32_bf16 v[204:207], a[252:255], a[28:31], v[204:207]
s_waitcnt lgkmcnt(9)
v_mul_f32 v235, v26, v235
v_mul_f32 v236, v26, v236
v_mfma_f32_16x16x32_bf16 v[96:99], v[84:87], a[32:35], v[96:99]
s_nop 0
ds_read_b64_tr_b16 v[72:73], v53 offset:0
ds_read_b64_tr_b16 v[74:75], v53 offset:14336
v_mfma_f32_16x16x32_bf16 v[100:103], v[84:87], a[36:39], v[100:103]
v_add_u32 v53, -57344, v53
v_mul_f32 v237, v26, v237
v_mfma_f32_16x16x32_bf16 v[104:107], v[84:87], a[40:43], v[104:107]
v_mul_f32 v238, v26, v238
v_mul_f32 v239, v26, v239
v_mfma_f32_16x16x32_bf16 v[108:111], v[84:87], a[44:47], v[108:111]
s_waitcnt lgkmcnt(9)
v_cvt_pk_bf16_f32 v232, v232, v233
v_cvt_pk_bf16_f32 v233, v234, v235
v_mfma_f32_16x16x32_bf16 v[112:115], v[88:91], a[32:35], v[112:115]
s_nop 0
ds_read_b64_tr_b16 v[76:77], v54 offset:0
ds_read_b64_tr_b16 v[78:79], v54 offset:14336
v_mfma_f32_16x16x32_bf16 v[116:119], v[88:91], a[36:39], v[116:119]
s_waitcnt vmcnt(14)
v_add_u32 v54, -57344, v54
v_cvt_pk_bf16_f32 v234, v236, v237
v_mfma_f32_16x16x32_bf16 v[120:123], v[88:91], a[40:43], v[120:123]
v_cvt_pk_bf16_f32 v235, v238, v239
v_mul_f32 v240, v28, v240
v_mfma_f32_16x16x32_bf16 v[124:127], v[88:91], a[44:47], v[124:127]
s_waitcnt lgkmcnt(9)
ds_write_b128 v11, v[232:235] offset:37888
v_mul_f32 v241, v28, v241
v_mfma_f32_16x16x32_bf16 v[128:131], v[60:63], a[32:35], v[128:131]
v_mul_f32 v242, v28, v242
v_mul_f32 v243, v28, v243
v_mfma_f32_16x16x32_bf16 v[132:135], v[60:63], a[36:39], v[132:135]
v_mul_f32 v244, v28, v244
v_mul_f32 v245, v28, v245
v_mfma_f32_16x16x32_bf16 v[136:139], v[60:63], a[40:43], v[136:139]
v_mul_f32 v246, v28, v246
v_mul_f32 v247, v28, v247
v_mfma_f32_16x16x32_bf16 v[140:143], v[60:63], a[44:47], v[140:143]
s_waitcnt lgkmcnt(8)
v_cvt_pk_bf16_f32 v240, v240, v241
v_cvt_pk_bf16_f32 v241, v242, v243
v_mfma_f32_16x16x32_bf16 v[144:147], v[64:67], a[32:35], v[144:147]
v_cvt_pk_bf16_f32 v242, v244, v245
v_cvt_pk_bf16_f32 v243, v246, v247
v_mfma_f32_16x16x32_bf16 v[148:151], v[64:67], a[36:39], v[148:151]
ds_write_b128 v11, v[240:243] offset:34816
v_mul_f32 v248, v28, v248
v_mfma_f32_16x16x32_bf16 v[152:155], v[64:67], a[40:43], v[152:155]
v_mul_f32 v249, v28, v249
v_mul_f32 v250, v28, v250
v_mfma_f32_16x16x32_bf16 v[156:159], v[64:67], a[44:47], v[156:159]
s_waitcnt lgkmcnt(6)
v_mul_f32 v251, v28, v251
v_mul_f32 v252, v28, v252
v_mfma_f32_16x16x32_bf16 v[160:163], v[68:71], a[32:35], v[160:163]
v_mul_f32 v253, v28, v253
v_mul_f32 v254, v28, v254
v_mfma_f32_16x16x32_bf16 v[164:167], v[68:71], a[36:39], v[164:167]
v_mul_f32 v255, v28, v255
v_cvt_pk_bf16_f32 v248, v248, v249
v_mfma_f32_16x16x32_bf16 v[168:171], v[68:71], a[40:43], v[168:171]
v_cvt_pk_bf16_f32 v249, v250, v251
v_cvt_pk_bf16_f32 v250, v252, v253
v_mfma_f32_16x16x32_bf16 v[172:175], v[68:71], a[44:47], v[172:175]
s_waitcnt lgkmcnt(4)
v_cvt_pk_bf16_f32 v251, v254, v255
v_mfma_f32_16x16x32_bf16 v[176:179], v[72:75], a[32:35], v[176:179]
ds_write_b128 v11, v[248:251] offset:38912
v_mfma_f32_16x16x32_bf16 v[180:183], v[72:75], a[36:39], v[180:183]
s_waitcnt lgkmcnt(0)
s_barrier
ds_read_b128 a[128:131], v6 offset:32768
v_mfma_f32_16x16x32_bf16 v[184:187], v[72:75], a[40:43], v[184:187]
ds_read_b128 a[132:135], v6 offset:33792
v_mfma_f32_16x16x32_bf16 v[188:191], v[72:75], a[44:47], v[188:191]
s_nop 0
ds_read_b64_tr_b16 v[80:81], v48 offset:0
ds_read_b64_tr_b16 v[82:83], v48 offset:14336
v_mfma_f32_16x16x32_bf16 v[192:195], v[76:79], a[32:35], v[192:195]
ds_read_b128 a[136:139], v6 offset:34816
v_add_u32 v48, 28672, v48
v_mfma_f32_16x16x32_bf16 v[196:199], v[76:79], a[36:39], v[196:199]
ds_read_b128 a[140:143], v6 offset:35840
v_mfma_f32_16x16x32_bf16 v[200:203], v[76:79], a[40:43], v[200:203]
s_nop 0
ds_read_b64_tr_b16 v[84:85], v49 offset:0
ds_read_b64_tr_b16 v[86:87], v49 offset:14336
v_mfma_f32_16x16x32_bf16 v[204:207], v[76:79], a[44:47], v[204:207]
s_waitcnt lgkmcnt(4)
ds_read_b128 a[144:147], v6 offset:36864
v_add_u32 v49, 28672, v49
v_mfma_f32_16x16x32_bf16 v[96:99], v[80:83], a[48:51], v[96:99]
ds_read_b128 a[148:151], v6 offset:37888
v_mfma_f32_16x16x32_bf16 v[100:103], v[80:83], a[52:55], v[100:103]
s_nop 0
ds_read_b64_tr_b16 v[88:89], v50 offset:0
ds_read_b64_tr_b16 v[90:91], v50 offset:14336
v_mfma_f32_16x16x32_bf16 v[104:107], v[80:83], a[56:59], v[104:107]
ds_read_b128 a[152:155], v6 offset:38912
v_add_u32 v50, 28672, v50
v_mfma_f32_16x16x32_bf16 v[108:111], v[80:83], a[60:63], v[108:111]
s_waitcnt lgkmcnt(5)
ds_read_b128 a[156:159], v6 offset:39936
v_mfma_f32_16x16x32_bf16 v[112:115], v[84:87], a[48:51], v[112:115]
s_nop 0
ds_read_b64_tr_b16 v[60:61], v51 offset:0
ds_read_b64_tr_b16 v[62:63], v51 offset:14336
v_mfma_f32_16x16x32_bf16 v[116:119], v[84:87], a[52:55], v[116:119]
s_waitcnt vmcnt(7)
s_barrier
ds_read_b128 a[160:163], v6 offset:40960
v_mfma_f32_16x16x32_bf16 v[120:123], v[84:87], a[56:59], v[120:123]
s_mov_b32 s53, 172032
ds_read_b128 a[164:167], v6 offset:41984
v_add_u32 v51, 28672, v51
v_mfma_f32_16x16x32_bf16 v[124:127], v[84:87], a[60:63], v[124:127]
s_waitcnt lgkmcnt(6)
ds_read_b64_tr_b16 v[64:65], v52 offset:0
ds_read_b64_tr_b16 v[66:67], v52 offset:14336
v_mfma_f32_16x16x32_bf16 v[128:131], v[88:91], a[48:51], v[128:131]
s_add_u32 m0, s52, 57344
ds_read_b128 a[168:171], v6 offset:43008
v_add_u32 v52, 28672, v52
v_mfma_f32_16x16x32_bf16 v[132:135], v[88:91], a[52:55], v[132:135]
buffer_load_dwordx4 v1, s[24:27], s53 offen offset:0 lds
v_mfma_f32_16x16x32_bf16 v[136:139], v[88:91], a[56:59], v[136:139]
ds_read_b128 a[172:175], v6 offset:44032
v_mfma_f32_16x16x32_bf16 v[140:143], v[88:91], a[60:63], v[140:143]
s_waitcnt lgkmcnt(6)
ds_read_b64_tr_b16 v[68:69], v53 offset:0
ds_read_b64_tr_b16 v[70:71], v53 offset:14336
v_mfma_f32_16x16x32_bf16 v[144:147], v[60:63], a[48:51], v[144:147]
buffer_load_dwordx4 v2, s[24:27], s53 offen offset:1024 lds
v_mfma_f32_16x16x32_bf16 v[148:151], v[60:63], a[52:55], v[148:151]
ds_read_b128 a[176:179], v6 offset:45056
v_add_u32 v53, 28672, v53
v_mfma_f32_16x16x32_bf16 v[152:155], v[60:63], a[56:59], v[152:155]
ds_read_b128 a[180:183], v6 offset:46080
v_mfma_f32_16x16x32_bf16 v[156:159], v[60:63], a[60:63], v[156:159]
s_waitcnt lgkmcnt(6)
ds_read_b64_tr_b16 v[72:73], v54 offset:0
ds_read_b64_tr_b16 v[74:75], v54 offset:14336
v_mfma_f32_16x16x32_bf16 v[160:163], v[64:67], a[48:51], v[160:163]
buffer_load_dwordx4 v3, s[24:27], s53 offen offset:2048 lds
v_mfma_f32_16x16x32_bf16 v[164:167], v[64:67], a[52:55], v[164:167]
ds_read_b128 a[184:187], v6 offset:47104
v_add_u32 v54, 28672, v54
v_mfma_f32_16x16x32_bf16 v[168:171], v[64:67], a[56:59], v[168:171]
ds_read_b128 a[188:191], v6 offset:48128
v_mfma_f32_16x16x32_bf16 v[172:175], v[64:67], a[60:63], v[172:175]
s_waitcnt lgkmcnt(6)
ds_read_b64_tr_b16 v[76:77], v48 offset:0
ds_read_b64_tr_b16 v[78:79], v48 offset:14336
v_mfma_f32_16x16x32_bf16 v[176:179], v[68:71], a[48:51], v[176:179]
buffer_load_dwordx4 v4, s[24:27], s53 offen offset:3072 lds
v_mfma_f32_16x16x32_bf16 v[180:183], v[68:71], a[52:55], v[180:183]
s_add_u32 m0, s52, 61440
ds_read_b128 a[192:195], v6 offset:49152
v_add_u32 v48, 57344, v48
v_mfma_f32_16x16x32_bf16 v[184:187], v[68:71], a[56:59], v[184:187]
ds_read_b128 a[196:199], v6 offset:50176
v_mfma_f32_16x16x32_bf16 v[188:191], v[68:71], a[60:63], v[188:191]
s_waitcnt lgkmcnt(6)
ds_read_b64_tr_b16 v[80:81], v49 offset:0
ds_read_b64_tr_b16 v[82:83], v49 offset:14336
v_mfma_f32_16x16x32_bf16 v[192:195], v[72:75], a[48:51], v[192:195]
buffer_load_dwordx4 v5, s[24:27], s53 offen offset:0 lds
v_mfma_f32_16x16x32_bf16 v[196:199], v[72:75], a[52:55], v[196:199]
ds_read_b128 a[200:203], v6 offset:51200
v_add_u32 v49, 57344, v49
v_mfma_f32_16x16x32_bf16 v[200:203], v[72:75], a[56:59], v[200:203]
ds_read_b128 a[204:207], v6 offset:52224
v_mfma_f32_16x16x32_bf16 v[204:207], v[72:75], a[60:63], v[204:207]
s_waitcnt lgkmcnt(6)
ds_read_b64_tr_b16 v[84:85], v50 offset:0
ds_read_b64_tr_b16 v[86:87], v50 offset:14336
v_mfma_f32_16x16x32_bf16 v[96:99], v[76:79], a[64:67], v[96:99]
buffer_load_dwordx4 v13, s[24:27], s53 offen offset:1024 lds
v_mfma_f32_16x16x32_bf16 v[100:103], v[76:79], a[68:71], v[100:103]
ds_read_b128 a[208:211], v6 offset:53248
v_add_u32 v50, 57344, v50
v_mfma_f32_16x16x32_bf16 v[104:107], v[76:79], a[72:75], v[104:107]
ds_read_b128 a[212:215], v6 offset:54272
v_mfma_f32_16x16x32_bf16 v[108:111], v[76:79], a[76:79], v[108:111]
s_waitcnt lgkmcnt(6)
ds_read_b64_tr_b16 v[88:89], v51 offset:0
ds_read_b64_tr_b16 v[90:91], v51 offset:14336
v_mfma_f32_16x16x32_bf16 v[112:115], v[80:83], a[64:67], v[112:115]
buffer_load_dwordx4 v14, s[24:27], s53 offen offset:2048 lds
v_mfma_f32_16x16x32_bf16 v[116:119], v[80:83], a[68:71], v[116:119]
s_waitcnt vmcnt(7)
ds_read_b128 a[216:219], v6 offset:55296
v_add_u32 v51, 57344, v51
v_mfma_f32_16x16x32_bf16 v[120:123], v[80:83], a[72:75], v[120:123]
ds_read_b128 a[220:223], v6 offset:56320
v_mfma_f32_16x16x32_bf16 v[124:127], v[80:83], a[76:79], v[124:127]
s_waitcnt lgkmcnt(6)
s_waitcnt lgkmcnt(0)
ds_read_b64_tr_b16 v[60:61], v52 offset:0
v_mfma_f32_16x16x32_bf16 v[128:131], v[84:87], a[64:67], v[128:131]
s_barrier
ds_read_b64_tr_b16 v[62:63], v52 offset:14336
v_add_u32 v52, 57344, v52
v_mfma_f32_16x16x32_bf16 v[132:135], v[84:87], a[68:71], v[132:135]
s_mov_b32 s53, 200704
ds_read_b128 a[224:227], v6 offset:57344
s_add_u32 m0, s52, 0
v_mfma_f32_16x16x32_bf16 v[136:139], v[84:87], a[72:75], v[136:139]
buffer_load_dwordx4 v1, s[24:27], s53 offen offset:0 lds
v_mfma_f32_16x16x32_bf16 v[140:143], v[84:87], a[76:79], v[140:143]
ds_read_b128 a[228:231], v6 offset:58368
v_mfma_f32_16x16x32_bf16 v[144:147], v[88:91], a[64:67], v[144:147]
s_nop 0
ds_read_b64_tr_b16 v[64:65], v53 offset:0
ds_read_b64_tr_b16 v[66:67], v53 offset:14336
v_mfma_f32_16x16x32_bf16 v[148:151], v[88:91], a[68:71], v[148:151]
buffer_load_dwordx4 v2, s[24:27], s53 offen offset:1024 lds
v_mfma_f32_16x16x32_bf16 v[152:155], v[88:91], a[72:75], v[152:155]
ds_read_b128 a[232:235], v6 offset:59392
v_add_u32 v53, 57344, v53
v_mfma_f32_16x16x32_bf16 v[156:159], v[88:91], a[76:79], v[156:159]
s_waitcnt lgkmcnt(5)
ds_read_b128 a[236:239], v6 offset:60416
v_mfma_f32_16x16x32_bf16 v[160:163], v[60:63], a[64:67], v[160:163]
s_nop 0
ds_read_b64_tr_b16 v[68:69], v54 offset:0
ds_read_b64_tr_b16 v[70:71], v54 offset:14336
v_mfma_f32_16x16x32_bf16 v[164:167], v[60:63], a[68:71], v[164:167]
buffer_load_dwordx4 v3, s[24:27], s53 offen offset:2048 lds
v_mfma_f32_16x16x32_bf16 v[168:171], v[60:63], a[72:75], v[168:171]
ds_read_b128 a[240:243], v6 offset:61440
v_add_u32 v54, 57344, v54
v_mfma_f32_16x16x32_bf16 v[172:175], v[60:63], a[76:79], v[172:175]
s_waitcnt lgkmcnt(5)
ds_read_b128 a[244:247], v6 offset:62464
v_mfma_f32_16x16x32_bf16 v[176:179], v[64:67], a[64:67], v[176:179]
s_nop 0
ds_read_b64_tr_b16 v[72:73], v48 offset:0
ds_read_b64_tr_b16 v[74:75], v48 offset:14336
v_mfma_f32_16x16x32_bf16 v[180:183], v[64:67], a[68:71], v[180:183]
buffer_load_dwordx4 v4, s[24:27], s53 offen offset:3072 lds
v_mfma_f32_16x16x32_bf16 v[184:187], v[64:67], a[72:75], v[184:187]
s_add_u32 m0, s52, 4096
ds_read_b128 a[248:251], v6 offset:63488
v_add_u32 v48, -28672, v48
v_mfma_f32_16x16x32_bf16 v[188:191], v[64:67], a[76:79], v[188:191]
s_waitcnt lgkmcnt(5)
ds_read_b128 a[252:255], v6 offset:64512
v_mfma_f32_16x16x32_bf16 v[192:195], v[68:71], a[64:67], v[192:195]
s_nop 0
ds_read_b64_tr_b16 v[76:77], v49 offset:0
ds_read_b64_tr_b16 v[78:79], v49 offset:14336
v_mfma_f32_16x16x32_bf16 v[196:199], v[68:71], a[68:71], v[196:199]
s_nop 0
ds_read_b64_tr_b16 v[80:81], v50 offset:0
ds_read_b64_tr_b16 v[82:83], v50 offset:14336
v_mfma_f32_16x16x32_bf16 v[200:203], v[68:71], a[72:75], v[200:203]
s_nop 0
ds_read_b64_tr_b16 v[84:85], v51 offset:0
ds_read_b64_tr_b16 v[86:87], v51 offset:14336
v_mfma_f32_16x16x32_bf16 v[204:207], v[68:71], a[76:79], v[204:207]
s_waitcnt lgkmcnt(8)
ds_read_b64_tr_b16 v[88:89], v52 offset:0
ds_read_b64_tr_b16 v[90:91], v52 offset:14336
v_mfma_f32_16x16x32_bf16 v[96:99], v[72:75], a[80:83], v[96:99]
buffer_load_dwordx4 v5, s[24:27], s53 offen offset:0 lds
v_mfma_f32_16x16x32_bf16 v[100:103], v[72:75], a[84:87], v[100:103]
s_nop 0
ds_read_b64_tr_b16 v[60:61], v53 offset:0
ds_read_b64_tr_b16 v[62:63], v53 offset:14336
v_mfma_f32_16x16x32_bf16 v[104:107], v[72:75], a[88:91], v[104:107]
v_add_u32 v49, -28672, v49
v_add_u32 v50, -28672, v50
v_mfma_f32_16x16x32_bf16 v[108:111], v[72:75], a[92:95], v[108:111]
s_waitcnt lgkmcnt(8)
buffer_load_dwordx4 v13, s[24:27], s53 offen offset:1024 lds
v_mfma_f32_16x16x32_bf16 v[112:115], v[76:79], a[80:83], v[112:115]
s_nop 0
ds_read_b64_tr_b16 v[64:65], v54 offset:0
ds_read_b64_tr_b16 v[66:67], v54 offset:14336
v_mfma_f32_16x16x32_bf16 v[116:119], v[76:79], a[84:87], v[116:119]
s_waitcnt vmcnt(6)
s_barrier
v_add_u32 v51, -28672, v51
v_mfma_f32_16x16x32_bf16 v[120:123], v[76:79], a[88:91], v[120:123]
buffer_load_dwordx4 v14, s[24:27], s53 offen offset:2048 lds
v_mfma_f32_16x16x32_bf16 v[124:127], v[76:79], a[92:95], v[124:127]
s_waitcnt lgkmcnt(8)
v_add_u32 v52, -28672, v52
v_add_u32 v53, -28672, v53
v_mfma_f32_16x16x32_bf16 v[128:131], v[80:83], a[80:83], v[128:131]
s_mov_b32 s53, 229376
ds_read_b64_tr_b16 v[68:69], v48 offset:0
ds_read_b64_tr_b16 v[70:71], v48 offset:14336
v_mfma_f32_16x16x32_bf16 v[132:135], v[80:83], a[84:87], v[132:135]
s_add_u32 m0, s52, 114688
v_add_u32 v54, -28672, v54
v_add_u32 v48, -57344, v48
v_mfma_f32_16x16x32_bf16 v[136:139], v[80:83], a[88:91], v[136:139]
buffer_load_dwordx4 v1, s[24:27], s53 offen offset:0 lds
v_mfma_f32_16x16x32_bf16 v[140:143], v[80:83], a[92:95], v[140:143]
s_waitcnt lgkmcnt(8)
v_mfma_f32_16x16x32_bf16 v[144:147], v[84:87], a[80:83], v[144:147]
s_nop 0
ds_read_b64_tr_b16 v[72:73], v49 offset:0
ds_read_b64_tr_b16 v[74:75], v49 offset:14336
v_mfma_f32_16x16x32_bf16 v[148:151], v[84:87], a[84:87], v[148:151]
buffer_load_dwordx4 v2, s[24:27], s53 offen offset:1024 lds
v_mfma_f32_16x16x32_bf16 v[152:155], v[84:87], a[88:91], v[152:155]
v_add_u32 v49, -57344, v49
v_mfma_f32_16x16x32_bf16 v[156:159], v[84:87], a[92:95], v[156:159]
s_waitcnt lgkmcnt(8)
v_mfma_f32_16x16x32_bf16 v[160:163], v[88:91], a[80:83], v[160:163]
buffer_load_dwordx4 v3, s[24:27], s53 offen offset:2048 lds
v_mfma_f32_16x16x32_bf16 v[164:167], v[88:91], a[84:87], v[164:167]
s_nop 0
ds_read_b64_tr_b16 v[76:77], v50 offset:0
ds_read_b64_tr_b16 v[78:79], v50 offset:14336
v_mfma_f32_16x16x32_bf16 v[168:171], v[88:91], a[88:91], v[168:171]
v_add_u32 v50, -57344, v50
v_mfma_f32_16x16x32_bf16 v[172:175], v[88:91], a[92:95], v[172:175]
s_waitcnt lgkmcnt(8)
buffer_load_dwordx4 v4, s[24:27], s53 offen offset:3072 lds
v_mfma_f32_16x16x32_bf16 v[176:179], v[60:63], a[80:83], v[176:179]
s_add_u32 m0, s52, 118784
ds_read_b64_tr_b16 v[80:81], v51 offset:0
ds_read_b64_tr_b16 v[82:83], v51 offset:14336
v_mfma_f32_16x16x32_bf16 v[180:183], v[60:63], a[84:87], v[180:183]
v_add_u32 v51, -57344, v51
v_mfma_f32_16x16x32_bf16 v[184:187], v[60:63], a[88:91], v[184:187]
buffer_load_dwordx4 v5, s[24:27], s53 offen offset:0 lds
v_mfma_f32_16x16x32_bf16 v[188:191], v[60:63], a[92:95], v[188:191]
s_waitcnt lgkmcnt(8)
v_mfma_f32_16x16x32_bf16 v[192:195], v[64:67], a[80:83], v[192:195]
s_nop 0
ds_read_b64_tr_b16 v[84:85], v52 offset:0
ds_read_b64_tr_b16 v[86:87], v52 offset:14336
v_mfma_f32_16x16x32_bf16 v[196:199], v[64:67], a[84:87], v[196:199]
buffer_load_dwordx4 v13, s[24:27], s53 offen offset:1024 lds
v_mfma_f32_16x16x32_bf16 v[200:203], v[64:67], a[88:91], v[200:203]
v_add_u32 v52, -57344, v52
v_mfma_f32_16x16x32_bf16 v[204:207], v[64:67], a[92:95], v[204:207]
s_waitcnt lgkmcnt(8)
v_mfma_f32_16x16x32_bf16 v[96:99], v[68:71], a[96:99], v[96:99]
buffer_load_dwordx4 v14, s[24:27], s53 offen offset:2048 lds
v_mfma_f32_16x16x32_bf16 v[100:103], v[68:71], a[100:103], v[100:103]
s_mov_b32 s53, 258048
ds_read_b64_tr_b16 v[88:89], v53 offset:0
ds_read_b64_tr_b16 v[90:91], v53 offset:14336
v_mfma_f32_16x16x32_bf16 v[104:107], v[68:71], a[104:107], v[104:107]
s_add_u32 m0, s52, 28672
v_add_u32 v53, -57344, v53
v_mfma_f32_16x16x32_bf16 v[108:111], v[68:71], a[108:111], v[108:111]
s_waitcnt lgkmcnt(8)
buffer_load_dwordx4 v1, s[24:27], s53 offen offset:0 lds
v_mfma_f32_16x16x32_bf16 v[112:115], v[72:75], a[96:99], v[112:115]
s_nop 0
ds_read_b64_tr_b16 v[60:61], v54 offset:0
ds_read_b64_tr_b16 v[62:63], v54 offset:14336
v_mfma_f32_16x16x32_bf16 v[116:119], v[72:75], a[100:103], v[116:119]
s_waitcnt vmcnt(8)
s_barrier
v_add_u32 v54, -57344, v54
v_mfma_f32_16x16x32_bf16 v[120:123], v[72:75], a[104:107], v[120:123]
buffer_load_dwordx4 v2, s[24:27], s53 offen offset:1024 lds
v_mfma_f32_16x16x32_bf16 v[124:127], v[72:75], a[108:111], v[124:127]
s_waitcnt lgkmcnt(8)
v_mfma_f32_16x16x32_bf16 v[128:131], v[76:79], a[96:99], v[128:131]
s_nop 0
ds_read_b64_tr_b16 v[64:65], v48 offset:0
ds_read_b64_tr_b16 v[66:67], v48 offset:14336
v_mfma_f32_16x16x32_bf16 v[132:135], v[76:79], a[100:103], v[132:135]
buffer_load_dwordx4 v3, s[24:27], s53 offen offset:2048 lds
v_mfma_f32_16x16x32_bf16 v[136:139], v[76:79], a[104:107], v[136:139]
v_add_u32 v48, 114688, v48
v_mfma_f32_16x16x32_bf16 v[140:143], v[76:79], a[108:111], v[140:143]
s_waitcnt lgkmcnt(8)
v_mfma_f32_16x16x32_bf16 v[144:147], v[80:83], a[96:99], v[144:147]
buffer_load_dwordx4 v4, s[24:27], s53 offen offset:3072 lds
v_mfma_f32_16x16x32_bf16 v[148:151], v[80:83], a[100:103], v[148:151]
s_add_u32 m0, s52, 32768
ds_read_b64_tr_b16 v[68:69], v49 offset:0
ds_read_b64_tr_b16 v[70:71], v49 offset:14336
v_mfma_f32_16x16x32_bf16 v[152:155], v[80:83], a[104:107], v[152:155]
v_add_u32 v49, 114688, v49
v_mfma_f32_16x16x32_bf16 v[156:159], v[80:83], a[108:111], v[156:159]
s_waitcnt lgkmcnt(8)
buffer_load_dwordx4 v5, s[24:27], s53 offen offset:0 lds
v_mfma_f32_16x16x32_bf16 v[160:163], v[84:87], a[96:99], v[160:163]
s_nop 0
ds_read_b64_tr_b16 v[72:73], v50 offset:0
ds_read_b64_tr_b16 v[74:75], v50 offset:14336
v_mfma_f32_16x16x32_bf16 v[164:167], v[84:87], a[100:103], v[164:167]
v_add_u32 v50, 114688, v50
v_mfma_f32_16x16x32_bf16 v[168:171], v[84:87], a[104:107], v[168:171]
buffer_load_dwordx4 v13, s[24:27], s53 offen offset:1024 lds
v_mfma_f32_16x16x32_bf16 v[172:175], v[84:87], a[108:111], v[172:175]
s_waitcnt lgkmcnt(8)
v_mfma_f32_16x16x32_bf16 v[176:179], v[88:91], a[96:99], v[176:179]
s_nop 0
ds_read_b64_tr_b16 v[76:77], v51 offset:0
ds_read_b64_tr_b16 v[78:79], v51 offset:14336
v_mfma_f32_16x16x32_bf16 v[180:183], v[88:91], a[100:103], v[180:183]
buffer_load_dwordx4 v14, s[24:27], s53 offen offset:2048 lds
v_mfma_f32_16x16x32_bf16 v[184:187], v[88:91], a[104:107], v[184:187]
s_mov_b32 s53, 286720
v_add_u32 v51, 114688, v51
s_add_u32 m0, s52, 86016
v_mfma_f32_16x16x32_bf16 v[188:191], v[88:91], a[108:111], v[188:191]
s_waitcnt lgkmcnt(8)
v_mfma_f32_16x16x32_bf16 v[192:195], v[60:63], a[96:99], v[192:195]
buffer_load_dwordx4 v1, s[24:27], s53 offen offset:0 lds
v_mfma_f32_16x16x32_bf16 v[196:199], v[60:63], a[100:103], v[196:199]
s_nop 0
ds_read_b64_tr_b16 v[80:81], v52 offset:0
ds_read_b64_tr_b16 v[82:83], v52 offset:14336
v_mfma_f32_16x16x32_bf16 v[200:203], v[60:63], a[104:107], v[200:203]
v_add_u32 v52, 114688, v52
v_mfma_f32_16x16x32_bf16 v[204:207], v[60:63], a[108:111], v[204:207]
s_waitcnt lgkmcnt(8)
buffer_load_dwordx4 v2, s[24:27], s53 offen offset:1024 lds
v_mfma_f32_16x16x32_bf16 v[96:99], v[64:67], a[112:115], v[96:99]
s_nop 0
ds_read_b64_tr_b16 v[84:85], v53 offset:0
ds_read_b64_tr_b16 v[86:87], v53 offset:14336
v_mfma_f32_16x16x32_bf16 v[100:103], v[64:67], a[116:119], v[100:103]
v_add_u32 v53, 114688, v53
v_mfma_f32_16x16x32_bf16 v[104:107], v[64:67], a[120:123], v[104:107]
buffer_load_dwordx4 v3, s[24:27], s53 offen offset:2048 lds
v_mfma_f32_16x16x32_bf16 v[108:111], v[64:67], a[124:127], v[108:111]
s_waitcnt lgkmcnt(8)
v_mfma_f32_16x16x32_bf16 v[112:115], v[68:71], a[112:115], v[112:115]
s_nop 0
ds_read_b64_tr_b16 v[88:89], v54 offset:0
ds_read_b64_tr_b16 v[90:91], v54 offset:14336
v_mfma_f32_16x16x32_bf16 v[116:119], v[68:71], a[116:119], v[116:119]
s_waitcnt vmcnt(10)
s_barrier
v_add_u32 v54, 114688, v54
v_mfma_f32_16x16x32_bf16 v[120:123], v[68:71], a[120:123], v[120:123]
buffer_load_dwordx4 v4, s[24:27], s53 offen offset:3072 lds
v_mfma_f32_16x16x32_bf16 v[124:127], v[68:71], a[124:127], v[124:127]
s_waitcnt lgkmcnt(8)
s_add_u32 m0, s52, 90112
v_mfma_f32_16x16x32_bf16 v[128:131], v[72:75], a[112:115], v[128:131]
s_nop 0
ds_read_b64_tr_b16 v[60:61], v48 offset:0
ds_read_b64_tr_b16 v[62:63], v48 offset:14336
v_mfma_f32_16x16x32_bf16 v[132:135], v[72:75], a[116:119], v[132:135]
buffer_load_dwordx4 v5, s[24:27], s53 offen offset:0 lds
v_mfma_f32_16x16x32_bf16 v[136:139], v[72:75], a[120:123], v[136:139]
v_add_u32 v48, -86016, v48
v_mfma_f32_16x16x32_bf16 v[140:143], v[72:75], a[124:127], v[140:143]
s_waitcnt lgkmcnt(8)
v_mfma_f32_16x16x32_bf16 v[144:147], v[76:79], a[112:115], v[144:147]
buffer_load_dwordx4 v13, s[24:27], s53 offen offset:1024 lds
v_mfma_f32_16x16x32_bf16 v[148:151], v[76:79], a[116:119], v[148:151]
s_nop 0
ds_read_b64_tr_b16 v[64:65], v49 offset:0
ds_read_b64_tr_b16 v[66:67], v49 offset:14336
v_mfma_f32_16x16x32_bf16 v[152:155], v[76:79], a[120:123], v[152:155]
v_add_u32 v49, -86016, v49
v_mfma_f32_16x16x32_bf16 v[156:159], v[76:79], a[124:127], v[156:159]
s_waitcnt lgkmcnt(8)
buffer_load_dwordx4 v14, s[24:27], s53 offen offset:2048 lds
v_mfma_f32_16x16x32_bf16 v[160:163], v[80:83], a[112:115], v[160:163]
s_mov_b32 s53, 315392
ds_read_b64_tr_b16 v[68:69], v50 offset:0
ds_read_b64_tr_b16 v[70:71], v50 offset:14336
v_mfma_f32_16x16x32_bf16 v[164:167], v[80:83], a[116:119], v[164:167]
s_add_u32 m0, s52, 57344
v_add_u32 v50, -86016, v50
v_mfma_f32_16x16x32_bf16 v[168:171], v[80:83], a[120:123], v[168:171]
buffer_load_dwordx4 v1, s[24:27], s53 offen offset:0 lds
v_mfma_f32_16x16x32_bf16 v[172:175], v[80:83], a[124:127], v[172:175]
s_waitcnt lgkmcnt(8)
v_mfma_f32_16x16x32_bf16 v[176:179], v[84:87], a[112:115], v[176:179]
s_nop 0
ds_read_b64_tr_b16 v[72:73], v51 offset:0
ds_read_b64_tr_b16 v[74:75], v51 offset:14336
v_mfma_f32_16x16x32_bf16 v[180:183], v[84:87], a[116:119], v[180:183]
buffer_load_dwordx4 v2, s[24:27], s53 offen offset:1024 lds
v_mfma_f32_16x16x32_bf16 v[184:187], v[84:87], a[120:123], v[184:187]
v_add_u32 v51, -86016, v51
v_mfma_f32_16x16x32_bf16 v[188:191], v[84:87], a[124:127], v[188:191]
s_waitcnt lgkmcnt(8)
v_mfma_f32_16x16x32_bf16 v[192:195], v[88:91], a[112:115], v[192:195]
buffer_load_dwordx4 v3, s[24:27], s53 offen offset:2048 lds
v_mfma_f32_16x16x32_bf16 v[196:199], v[88:91], a[116:119], v[196:199]
s_nop 0
ds_read_b64_tr_b16 v[76:77], v52 offset:0
ds_read_b64_tr_b16 v[78:79], v52 offset:14336
v_mfma_f32_16x16x32_bf16 v[200:203], v[88:91], a[120:123], v[200:203]
v_add_u32 v52, -86016, v52
v_mfma_f32_16x16x32_bf16 v[204:207], v[88:91], a[124:127], v[204:207]
s_waitcnt lgkmcnt(8)
buffer_load_dwordx4 v4, s[24:27], s53 offen offset:3072 lds
v_mfma_f32_16x16x32_bf16 v[96:99], v[60:63], a[128:131], v[96:99]
s_add_u32 m0, s52, 61440
ds_read_b64_tr_b16 v[80:81], v53 offset:0
ds_read_b64_tr_b16 v[82:83], v53 offset:14336
v_mfma_f32_16x16x32_bf16 v[100:103], v[60:63], a[132:135], v[100:103]
v_add_u32 v53, -86016, v53
v_mfma_f32_16x16x32_bf16 v[104:107], v[60:63], a[136:139], v[104:107]
buffer_load_dwordx4 v5, s[24:27], s53 offen offset:0 lds
v_mfma_f32_16x16x32_bf16 v[108:111], v[60:63], a[140:143], v[108:111]
s_waitcnt lgkmcnt(8)
v_mfma_f32_16x16x32_bf16 v[112:115], v[64:67], a[128:131], v[112:115]
s_nop 0
ds_read_b64_tr_b16 v[84:85], v54 offset:0
ds_read_b64_tr_b16 v[86:87], v54 offset:14336
v_mfma_f32_16x16x32_bf16 v[116:119], v[64:67], a[132:135], v[116:119]
s_waitcnt vmcnt(12)
s_barrier
v_add_u32 v54, -86016, v54
v_mfma_f32_16x16x32_bf16 v[120:123], v[64:67], a[136:139], v[120:123]
buffer_load_dwordx4 v13, s[24:27], s53 offen offset:1024 lds
v_mfma_f32_16x16x32_bf16 v[124:127], v[64:67], a[140:143], v[124:127]
s_waitcnt lgkmcnt(8)
v_mfma_f32_16x16x32_bf16 v[128:131], v[68:71], a[128:131], v[128:131]
s_nop 0
ds_read_b64_tr_b16 v[88:89], v48 offset:0
ds_read_b64_tr_b16 v[90:91], v48 offset:14336
v_mfma_f32_16x16x32_bf16 v[132:135], v[68:71], a[132:135], v[132:135]
buffer_load_dwordx4 v14, s[24:27], s53 offen offset:2048 lds
v_mfma_f32_16x16x32_bf16 v[136:139], v[68:71], a[136:139], v[136:139]
s_mov_b32 s53, 344064
v_add_u32 v48, 57344, v48
s_add_u32 m0, s52, 0
v_mfma_f32_16x16x32_bf16 v[140:143], v[68:71], a[140:143], v[140:143]
s_waitcnt lgkmcnt(8)
v_mfma_f32_16x16x32_bf16 v[144:147], v[72:75], a[128:131], v[144:147]
buffer_load_dwordx4 v1, s[24:27], s53 offen offset:0 lds
v_mfma_f32_16x16x32_bf16 v[148:151], v[72:75], a[132:135], v[148:151]
s_nop 0
ds_read_b64_tr_b16 v[60:61], v49 offset:0
ds_read_b64_tr_b16 v[62:63], v49 offset:14336
v_mfma_f32_16x16x32_bf16 v[152:155], v[72:75], a[136:139], v[152:155]
v_add_u32 v49, 57344, v49
v_mfma_f32_16x16x32_bf16 v[156:159], v[72:75], a[140:143], v[156:159]
s_waitcnt lgkmcnt(8)
buffer_load_dwordx4 v2, s[24:27], s53 offen offset:1024 lds
v_mfma_f32_16x16x32_bf16 v[160:163], v[76:79], a[128:131], v[160:163]
s_nop 0
ds_read_b64_tr_b16 v[64:65], v50 offset:0
ds_read_b64_tr_b16 v[66:67], v50 offset:14336
v_mfma_f32_16x16x32_bf16 v[164:167], v[76:79], a[132:135], v[164:167]
v_add_u32 v50, 57344, v50
v_mfma_f32_16x16x32_bf16 v[168:171], v[76:79], a[136:139], v[168:171]
buffer_load_dwordx4 v3, s[24:27], s53 offen offset:2048 lds
v_mfma_f32_16x16x32_bf16 v[172:175], v[76:79], a[140:143], v[172:175]
s_waitcnt lgkmcnt(8)
v_mfma_f32_16x16x32_bf16 v[176:179], v[80:83], a[128:131], v[176:179]
s_nop 0
ds_read_b64_tr_b16 v[68:69], v51 offset:0
ds_read_b64_tr_b16 v[70:71], v51 offset:14336
v_mfma_f32_16x16x32_bf16 v[180:183], v[80:83], a[132:135], v[180:183]
buffer_load_dwordx4 v4, s[24:27], s53 offen offset:3072 lds
v_mfma_f32_16x16x32_bf16 v[184:187], v[80:83], a[136:139], v[184:187]
s_add_u32 m0, s52, 4096
v_add_u32 v51, 57344, v51
v_mfma_f32_16x16x32_bf16 v[188:191], v[80:83], a[140:143], v[188:191]
s_waitcnt lgkmcnt(8)
v_mfma_f32_16x16x32_bf16 v[192:195], v[84:87], a[128:131], v[192:195]
buffer_load_dwordx4 v5, s[24:27], s53 offen offset:0 lds
v_mfma_f32_16x16x32_bf16 v[196:199], v[84:87], a[132:135], v[196:199]
s_nop 0
ds_read_b64_tr_b16 v[72:73], v52 offset:0
ds_read_b64_tr_b16 v[74:75], v52 offset:14336
v_mfma_f32_16x16x32_bf16 v[200:203], v[84:87], a[136:139], v[200:203]
v_add_u32 v52, 57344, v52
v_mfma_f32_16x16x32_bf16 v[204:207], v[84:87], a[140:143], v[204:207]
s_waitcnt lgkmcnt(8)
buffer_load_dwordx4 v13, s[24:27], s53 offen offset:1024 lds
v_mfma_f32_16x16x32_bf16 v[96:99], v[88:91], a[144:147], v[96:99]
s_nop 0
ds_read_b64_tr_b16 v[76:77], v53 offset:0
ds_read_b64_tr_b16 v[78:79], v53 offset:14336
v_mfma_f32_16x16x32_bf16 v[100:103], v[88:91], a[148:151], v[100:103]
v_add_u32 v53, 57344, v53
v_mfma_f32_16x16x32_bf16 v[104:107], v[88:91], a[152:155], v[104:107]
buffer_load_dwordx4 v14, s[24:27], s53 offen offset:2048 lds
v_mfma_f32_16x16x32_bf16 v[108:111], v[88:91], a[156:159], v[108:111]
s_waitcnt lgkmcnt(8)
v_mfma_f32_16x16x32_bf16 v[112:115], v[60:63], a[144:147], v[112:115]
s_nop 0
ds_read_b64_tr_b16 v[80:81], v54 offset:0
ds_read_b64_tr_b16 v[82:83], v54 offset:14336
v_mfma_f32_16x16x32_bf16 v[116:119], v[60:63], a[148:151], v[116:119]
s_waitcnt vmcnt(14)
s_barrier
v_add_u32 v54, 57344, v54
v_mfma_f32_16x16x32_bf16 v[120:123], v[60:63], a[152:155], v[120:123]
s_mov_b32 s53, 372736
s_add_u32 m0, s52, 114688
v_mfma_f32_16x16x32_bf16 v[124:127], v[60:63], a[156:159], v[124:127]
s_waitcnt lgkmcnt(8)
buffer_load_dwordx4 v1, s[24:27], s53 offen offset:0 lds
v_mfma_f32_16x16x32_bf16 v[128:131], v[64:67], a[144:147], v[128:131]
s_nop 0
ds_read_b64_tr_b16 v[84:85], v48 offset:0
ds_read_b64_tr_b16 v[86:87], v48 offset:14336
v_mfma_f32_16x16x32_bf16 v[132:135], v[64:67], a[148:151], v[132:135]
v_add_u32 v48, -28672, v48
v_mfma_f32_16x16x32_bf16 v[136:139], v[64:67], a[152:155], v[136:139]
buffer_load_dwordx4 v2, s[24:27], s53 offen offset:1024 lds
v_mfma_f32_16x16x32_bf16 v[140:143], v[64:67], a[156:159], v[140:143]
s_waitcnt lgkmcnt(8)
v_mfma_f32_16x16x32_bf16 v[144:147], v[68:71], a[144:147], v[144:147]
s_nop 0
ds_read_b64_tr_b16 v[88:89], v49 offset:0
ds_read_b64_tr_b16 v[90:91], v49 offset:14336
v_mfma_f32_16x16x32_bf16 v[148:151], v[68:71], a[148:151], v[148:151]
buffer_load_dwordx4 v3, s[24:27], s53 offen offset:2048 lds
v_mfma_f32_16x16x32_bf16 v[152:155], v[68:71], a[152:155], v[152:155]
v_add_u32 v49, -28672, v49
v_mfma_f32_16x16x32_bf16 v[156:159], v[68:71], a[156:159], v[156:159]
s_waitcnt lgkmcnt(8)
v_mfma_f32_16x16x32_bf16 v[160:163], v[72:75], a[144:147], v[160:163]
buffer_load_dwordx4 v4, s[24:27], s53 offen offset:3072 lds
v_mfma_f32_16x16x32_bf16 v[164:167], v[72:75], a[148:151], v[164:167]
s_add_u32 m0, s52, 118784
ds_read_b64_tr_b16 v[60:61], v50 offset:0
ds_read_b64_tr_b16 v[62:63], v50 offset:14336
v_mfma_f32_16x16x32_bf16 v[168:171], v[72:75], a[152:155], v[168:171]
v_add_u32 v50, -28672, v50
v_mfma_f32_16x16x32_bf16 v[172:175], v[72:75], a[156:159], v[172:175]
s_waitcnt lgkmcnt(8)
buffer_load_dwordx4 v5, s[24:27], s53 offen offset:0 lds
v_mfma_f32_16x16x32_bf16 v[176:179], v[76:79], a[144:147], v[176:179]
s_nop 0
ds_read_b64_tr_b16 v[64:65], v51 offset:0
ds_read_b64_tr_b16 v[66:67], v51 offset:14336
v_mfma_f32_16x16x32_bf16 v[180:183], v[76:79], a[148:151], v[180:183]
v_add_u32 v51, -28672, v51
v_mfma_f32_16x16x32_bf16 v[184:187], v[76:79], a[152:155], v[184:187]
buffer_load_dwordx4 v13, s[24:27], s53 offen offset:1024 lds
v_mfma_f32_16x16x32_bf16 v[188:191], v[76:79], a[156:159], v[188:191]
s_waitcnt lgkmcnt(8)
v_mfma_f32_16x16x32_bf16 v[192:195], v[80:83], a[144:147], v[192:195]
s_nop 0
ds_read_b64_tr_b16 v[68:69], v52 offset:0
ds_read_b64_tr_b16 v[70:71], v52 offset:14336
v_mfma_f32_16x16x32_bf16 v[196:199], v[80:83], a[148:151], v[196:199]
buffer_load_dwordx4 v14, s[24:27], s53 offen offset:2048 lds
v_mfma_f32_16x16x32_bf16 v[200:203], v[80:83], a[152:155], v[200:203]
v_add_u32 v52, -28672, v52
v_mfma_f32_16x16x32_bf16 v[204:207], v[80:83], a[156:159], v[204:207]
s_waitcnt lgkmcnt(8)
v_mfma_f32_16x16x32_bf16 v[96:99], v[84:87], a[160:163], v[96:99]
s_nop 0
ds_read_b64_tr_b16 v[72:73], v53 offset:0
ds_read_b64_tr_b16 v[74:75], v53 offset:14336
v_mfma_f32_16x16x32_bf16 v[100:103], v[84:87], a[164:167], v[100:103]
v_add_u32 v53, -28672, v53
v_mfma_f32_16x16x32_bf16 v[104:107], v[84:87], a[168:171], v[104:107]
v_mfma_f32_16x16x32_bf16 v[108:111], v[84:87], a[172:175], v[108:111]
s_waitcnt lgkmcnt(8)
v_mfma_f32_16x16x32_bf16 v[112:115], v[88:91], a[160:163], v[112:115]
s_nop 0
ds_read_b64_tr_b16 v[76:77], v54 offset:0
ds_read_b64_tr_b16 v[78:79], v54 offset:14336
v_mfma_f32_16x16x32_bf16 v[116:119], v[88:91], a[164:167], v[116:119]
s_waitcnt vmcnt(14)
s_barrier
v_add_u32 v54, -28672, v54
v_mfma_f32_16x16x32_bf16 v[120:123], v[88:91], a[168:171], v[120:123]
s_mov_b32 s53, 401408
s_add_u32 m0, s52, 28672
v_mfma_f32_16x16x32_bf16 v[124:127], v[88:91], a[172:175], v[124:127]
s_waitcnt lgkmcnt(8)
buffer_load_dwordx4 v1, s[24:27], s53 offen offset:0 lds
v_mfma_f32_16x16x32_bf16 v[128:131], v[60:63], a[160:163], v[128:131]
s_nop 0
ds_read_b64_tr_b16 v[80:81], v48 offset:0
ds_read_b64_tr_b16 v[82:83], v48 offset:14336
v_mfma_f32_16x16x32_bf16 v[132:135], v[60:63], a[164:167], v[132:135]
v_add_u32 v48, -57344, v48
v_mfma_f32_16x16x32_bf16 v[136:139], v[60:63], a[168:171], v[136:139]
buffer_load_dwordx4 v2, s[24:27], s53 offen offset:1024 lds
v_mfma_f32_16x16x32_bf16 v[140:143], v[60:63], a[172:175], v[140:143]
s_waitcnt lgkmcnt(8)
v_mfma_f32_16x16x32_bf16 v[144:147], v[64:67], a[160:163], v[144:147]
s_nop 0
ds_read_b64_tr_b16 v[84:85], v49 offset:0
ds_read_b64_tr_b16 v[86:87], v49 offset:14336
v_mfma_f32_16x16x32_bf16 v[148:151], v[64:67], a[164:167], v[148:151]
buffer_load_dwordx4 v3, s[24:27], s53 offen offset:2048 lds
v_mfma_f32_16x16x32_bf16 v[152:155], v[64:67], a[168:171], v[152:155]
v_add_u32 v49, -57344, v49
v_mfma_f32_16x16x32_bf16 v[156:159], v[64:67], a[172:175], v[156:159]
s_waitcnt lgkmcnt(8)
v_mfma_f32_16x16x32_bf16 v[160:163], v[68:71], a[160:163], v[160:163]
buffer_load_dwordx4 v4, s[24:27], s53 offen offset:3072 lds
v_mfma_f32_16x16x32_bf16 v[164:167], v[68:71], a[164:167], v[164:167]
s_add_u32 m0, s52, 32768
ds_read_b64_tr_b16 v[88:89], v50 offset:0
ds_read_b64_tr_b16 v[90:91], v50 offset:14336
v_mfma_f32_16x16x32_bf16 v[168:171], v[68:71], a[168:171], v[168:171]
v_add_u32 v50, -57344, v50
v_mfma_f32_16x16x32_bf16 v[172:175], v[68:71], a[172:175], v[172:175]
s_waitcnt lgkmcnt(8)
buffer_load_dwordx4 v5, s[24:27], s53 offen offset:0 lds
v_mfma_f32_16x16x32_bf16 v[176:179], v[72:75], a[160:163], v[176:179]
s_nop 0
ds_read_b64_tr_b16 v[60:61], v51 offset:0
ds_read_b64_tr_b16 v[62:63], v51 offset:14336
v_mfma_f32_16x16x32_bf16 v[180:183], v[72:75], a[164:167], v[180:183]
v_add_u32 v51, -57344, v51
v_mfma_f32_16x16x32_bf16 v[184:187], v[72:75], a[168:171], v[184:187]
buffer_load_dwordx4 v13, s[24:27], s53 offen offset:1024 lds
v_mfma_f32_16x16x32_bf16 v[188:191], v[72:75], a[172:175], v[188:191]
s_waitcnt lgkmcnt(8)
v_mfma_f32_16x16x32_bf16 v[192:195], v[76:79], a[160:163], v[192:195]
s_nop 0
ds_read_b64_tr_b16 v[64:65], v52 offset:0
ds_read_b64_tr_b16 v[66:67], v52 offset:14336
v_mfma_f32_16x16x32_bf16 v[196:199], v[76:79], a[164:167], v[196:199]
buffer_load_dwordx4 v14, s[24:27], s53 offen offset:2048 lds
v_mfma_f32_16x16x32_bf16 v[200:203], v[76:79], a[168:171], v[200:203]
v_add_u32 v52, -57344, v52
v_mfma_f32_16x16x32_bf16 v[204:207], v[76:79], a[172:175], v[204:207]
s_waitcnt lgkmcnt(8)
v_mfma_f32_16x16x32_bf16 v[96:99], v[80:83], a[176:179], v[96:99]
s_nop 0
ds_read_b64_tr_b16 v[68:69], v53 offset:0
ds_read_b64_tr_b16 v[70:71], v53 offset:14336
v_mfma_f32_16x16x32_bf16 v[100:103], v[80:83], a[180:183], v[100:103]
v_add_u32 v53, -57344, v53
v_mfma_f32_16x16x32_bf16 v[104:107], v[80:83], a[184:187], v[104:107]
v_mfma_f32_16x16x32_bf16 v[108:111], v[80:83], a[188:191], v[108:111]
s_waitcnt lgkmcnt(8)
v_mfma_f32_16x16x32_bf16 v[112:115], v[84:87], a[176:179], v[112:115]
s_nop 0
ds_read_b64_tr_b16 v[72:73], v54 offset:0
ds_read_b64_tr_b16 v[74:75], v54 offset:14336
v_mfma_f32_16x16x32_bf16 v[116:119], v[84:87], a[180:183], v[116:119]
s_waitcnt vmcnt(14)
s_barrier
v_add_u32 v54, -57344, v54
v_mfma_f32_16x16x32_bf16 v[120:123], v[84:87], a[184:187], v[120:123]
s_mov_b32 s53, 430080
s_add_u32 m0, s52, 86016
v_mfma_f32_16x16x32_bf16 v[124:127], v[84:87], a[188:191], v[124:127]
s_waitcnt lgkmcnt(8)
buffer_load_dwordx4 v1, s[24:27], s53 offen offset:0 lds
v_mfma_f32_16x16x32_bf16 v[128:131], v[88:91], a[176:179], v[128:131]
s_nop 0
ds_read_b64_tr_b16 v[76:77], v48 offset:0
ds_read_b64_tr_b16 v[78:79], v48 offset:14336
v_mfma_f32_16x16x32_bf16 v[132:135], v[88:91], a[180:183], v[132:135]
v_add_u32 v48, 114688, v48
v_mfma_f32_16x16x32_bf16 v[136:139], v[88:91], a[184:187], v[136:139]
buffer_load_dwordx4 v2, s[24:27], s53 offen offset:1024 lds
v_mfma_f32_16x16x32_bf16 v[140:143], v[88:91], a[188:191], v[140:143]
s_waitcnt lgkmcnt(8)
v_mfma_f32_16x16x32_bf16 v[144:147], v[60:63], a[176:179], v[144:147]
s_nop 0
ds_read_b64_tr_b16 v[80:81], v49 offset:0
ds_read_b64_tr_b16 v[82:83], v49 offset:14336
v_mfma_f32_16x16x32_bf16 v[148:151], v[60:63], a[180:183], v[148:151]
buffer_load_dwordx4 v3, s[24:27], s53 offen offset:2048 lds
v_mfma_f32_16x16x32_bf16 v[152:155], v[60:63], a[184:187], v[152:155]
v_add_u32 v49, 114688, v49
v_mfma_f32_16x16x32_bf16 v[156:159], v[60:63], a[188:191], v[156:159]
s_waitcnt lgkmcnt(8)
v_mfma_f32_16x16x32_bf16 v[160:163], v[64:67], a[176:179], v[160:163]
buffer_load_dwordx4 v4, s[24:27], s53 offen offset:3072 lds
v_mfma_f32_16x16x32_bf16 v[164:167], v[64:67], a[180:183], v[164:167]
s_add_u32 m0, s52, 90112
ds_read_b64_tr_b16 v[84:85], v50 offset:0
ds_read_b64_tr_b16 v[86:87], v50 offset:14336
v_mfma_f32_16x16x32_bf16 v[168:171], v[64:67], a[184:187], v[168:171]
s_mul_i32 s44, s33, 57344
v_add_u32 v50, 114688, v50
s_mul_i32 s45, s32, 14336
v_mfma_f32_16x16x32_bf16 v[172:175], v[64:67], a[188:191], v[172:175]
s_waitcnt lgkmcnt(8)
buffer_load_dwordx4 v5, s[24:27], s53 offen offset:0 lds
v_mfma_f32_16x16x32_bf16 v[176:179], v[68:71], a[176:179], v[176:179]
s_add_u32 s44, s44, s45
ds_read_b64_tr_b16 v[88:89], v51 offset:0
ds_read_b64_tr_b16 v[90:91], v51 offset:14336
v_mfma_f32_16x16x32_bf16 v[180:183], v[68:71], a[180:183], v[180:183]
s_add_u32 s44, s44, 1048576
v_add_u32 v51, 114688, v51
s_mul_i32 s37, s34, 7
v_mfma_f32_16x16x32_bf16 v[184:187], v[68:71], a[184:187], v[184:187]
s_lshl_b32 s45, s32, 1
buffer_load_dwordx4 v13, s[24:27], s53 offen offset:1024 lds
v_mfma_f32_16x16x32_bf16 v[188:191], v[68:71], a[188:191], v[188:191]
s_waitcnt lgkmcnt(8)
s_add_u32 s37, s37, s45
s_lshr_b32 s45, s33, 3
v_mfma_f32_16x16x32_bf16 v[192:195], v[72:75], a[176:179], v[192:195]
s_mul_i32 s38, s45, 458752
ds_read_b64_tr_b16 v[60:61], v52 offset:0
ds_read_b64_tr_b16 v[62:63], v52 offset:14336
v_mfma_f32_16x16x32_bf16 v[196:199], v[72:75], a[180:183], v[196:199]
s_lshl_b32 s47, s37, 10
buffer_load_dwordx4 v14, s[24:27], s53 offen offset:2048 lds
v_mfma_f32_16x16x32_bf16 v[200:203], v[72:75], a[184:187], v[200:203]
s_add_u32 s38, s38, s47
v_add_u32 v52, 114688, v52
s_add_u32 s38, s38, 1048576
v_mfma_f32_16x16x32_bf16 v[204:207], v[72:75], a[188:191], v[204:207]
s_waitcnt lgkmcnt(8)
s_bfe_u32 s47, s33, 0x30004
s_mul_i32 s39, s47, 200704
v_mfma_f32_16x16x32_bf16 v[96:99], v[76:79], a[192:195], v[96:99]
s_lshr_b32 s47, s33, 7
ds_read_b64_tr_b16 v[64:65], v53 offset:0
ds_read_b64_tr_b16 v[66:67], v53 offset:14336
v_mfma_f32_16x16x32_bf16 v[100:103], v[76:79], a[196:199], v[100:103]
s_mul_i32 s47, s47, 896
v_add_u32 v53, 114688, v53
s_add_u32 s39, s39, s47
v_mfma_f32_16x16x32_bf16 v[104:107], v[76:79], a[200:203], v[104:107]
s_and_b32 s40, s33, 0xf8
s_lshl_b32 s47, s32, 1
s_add_u32 s40, s40, s47
v_mfma_f32_16x16x32_bf16 v[108:111], v[76:79], a[204:207], v[108:111]
s_waitcnt lgkmcnt(8)
s_lshl_b32 s40, s40, 8
s_lshl_b32 s46, s34, 3
v_mfma_f32_16x16x32_bf16 v[112:115], v[80:83], a[192:195], v[112:115]
s_add_u32 s40, s40, s46
ds_read_b64_tr_b16 v[68:69], v54 offset:0
ds_read_b64_tr_b16 v[70:71], v54 offset:14336
v_mfma_f32_16x16x32_bf16 v[116:119], v[80:83], a[196:199], v[116:119]
s_waitcnt vmcnt(0)
s_barrier
v_add_u32 v54, 114688, v54
v_mfma_f32_16x16x32_bf16 v[120:123], v[80:83], a[200:203], v[120:123]
s_add_u32 s40, s40, 65664
s_lshl_b32 s46, s33, 8
s_add_u32 s46, s46, 65664
v_mfma_f32_16x16x32_bf16 v[124:127], v[80:83], a[204:207], v[124:127]
s_waitcnt lgkmcnt(8)
s_mov_b32 s41, 0x80000
s_add_u32 s56, s56, 1
s_addc_u32 s57, s57, 0
v_mfma_f32_16x16x32_bf16 v[128:131], v[84:87], a[192:195], v[128:131]
s_add_u32 s58, s58, 1
s_addc_u32 s59, s59, 0
ds_read_b64_tr_b16 v[72:73], v48 offset:0
ds_read_b64_tr_b16 v[74:75], v48 offset:14336
v_mfma_f32_16x16x32_bf16 v[132:135], v[84:87], a[196:199], v[132:135]
s_add_u32 s60, s60, 1
s_addc_u32 s61, s61, 0
v_add_u32 v48, -86016, v48
v_and_b32 v7, 15, v0
v_mfma_f32_16x16x32_bf16 v[136:139], v[84:87], a[200:203], v[136:139]
v_mul_u32_u24 v8, 1792, v7
v_lshrrev_b32 v9, 4, v0
v_mfma_f32_16x16x32_bf16 v[140:143], v[84:87], a[204:207], v[140:143]
s_waitcnt lgkmcnt(8)
v_lshl_add_u32 v8, v9, 3, v8
v_lshrrev_b32 v7, 3, v7
v_mfma_f32_16x16x32_bf16 v[144:147], v[88:91], a[192:195], v[144:147]
s_nop 0
ds_read_b64_tr_b16 v[76:77], v48 offset:0
ds_read_b64_tr_b16 v[78:79], v48 offset:14336
v_mfma_f32_16x16x32_bf16 v[148:151], v[88:91], a[196:199], v[148:151]
v_add_u32 v48, 57344, v48
v_cmp_eq_u32 vcc, s51, v7
v_mfma_f32_16x16x32_bf16 v[152:155], v[88:91], a[200:203], v[152:155]
v_mov_b32 v9, 0x40000000
v_and_b32 v7, 7, v0
v_mfma_f32_16x16x32_bf16 v[156:159], v[88:91], a[204:207], v[156:159]
s_waitcnt lgkmcnt(8)
v_cndmask_b32 v9, v9, v8, vcc
v_lshlrev_b32 v7, 3, v7
v_mfma_f32_16x16x32_bf16 v[160:163], v[60:63], a[192:195], v[160:163]
s_nop 0
ds_read_b64_tr_b16 v[80:81], v48 offset:0
ds_read_b64_tr_b16 v[82:83], v48 offset:14336
v_mfma_f32_16x16x32_bf16 v[164:167], v[60:63], a[196:199], v[164:167]
v_mov_b32 v56, s58
v_mov_b32 v57, s59
v_mfma_f32_16x16x32_bf16 v[168:171], v[60:63], a[200:203], v[168:171]
v_mov_b32 v58, s60
v_mov_b32 v59, s61
v_mfma_f32_16x16x32_bf16 v[172:175], v[60:63], a[204:207], v[172:175]
s_waitcnt lgkmcnt(8)
v_mfma_f32_16x16x32_bf16 v[176:179], v[64:67], a[192:195], v[176:179]
s_nop 0
ds_read_b64_tr_b16 v[84:85], v49 offset:0
ds_read_b64_tr_b16 v[86:87], v49 offset:14336
v_mfma_f32_16x16x32_bf16 v[180:183], v[64:67], a[196:199], v[180:183]
v_add_u32 v49, -86016, v49
v_mfma_f32_16x16x32_bf16 v[184:187], v[64:67], a[200:203], v[184:187]
v_mfma_f32_16x16x32_bf16 v[188:191], v[64:67], a[204:207], v[188:191]
s_waitcnt lgkmcnt(8)
v_mfma_f32_16x16x32_bf16 v[192:195], v[68:71], a[192:195], v[192:195]
s_nop 0
ds_read_b64_tr_b16 v[88:89], v49 offset:0
ds_read_b64_tr_b16 v[90:91], v49 offset:14336
v_mfma_f32_16x16x32_bf16 v[196:199], v[68:71], a[196:199], v[196:199]
v_add_u32 v49, 57344, v49
v_mfma_f32_16x16x32_bf16 v[200:203], v[68:71], a[200:203], v[200:203]
v_mfma_f32_16x16x32_bf16 v[204:207], v[68:71], a[204:207], v[204:207]
s_waitcnt lgkmcnt(8)
v_mfma_f32_16x16x32_bf16 v[96:99], v[72:75], a[208:211], v[96:99]
s_waitcnt lgkmcnt(6)
ds_read_b64_tr_b16 v[60:61], v49 offset:0
ds_read_b64_tr_b16 v[62:63], v49 offset:14336
v_mfma_f32_16x16x32_bf16 v[96:99], v[76:79], a[224:227], v[96:99]
s_waitcnt lgkmcnt(6)
ds_read_b64_tr_b16 v[64:65], v50 offset:0
ds_read_b64_tr_b16 v[66:67], v50 offset:14336
v_mfma_f32_16x16x32_bf16 v[96:99], v[80:83], a[240:243], v[96:99]
v_add_u32 v50, -86016, v50
v_mfma_f32_16x16x32_bf16 v[100:103], v[72:75], a[212:215], v[100:103]
s_nop 0
ds_read_b64_tr_b16 v[68:69], v50 offset:0
ds_read_b64_tr_b16 v[70:71], v50 offset:14336
v_mfma_f32_16x16x32_bf16 v[100:103], v[76:79], a[228:231], v[100:103]
v_add_u32 v50, 57344, v50
v_mfma_f32_16x16x32_bf16 v[100:103], v[80:83], a[244:247], v[100:103]
v_mfma_f32_16x16x32_bf16 v[104:107], v[72:75], a[216:219], v[104:107]
v_cvt_pk_bf16_f32 v16, v96, v97
v_cvt_pk_bf16_f32 v17, v98, v99
v_mfma_f32_16x16x32_bf16 v[104:107], v[76:79], a[232:235], v[104:107]
v_mfma_f32_16x16x32_bf16 v[104:107], v[80:83], a[248:251], v[104:107]
v_mfma_f32_16x16x32_bf16 v[108:111], v[72:75], a[220:223], v[108:111]
v_mfma_f32_16x16x32_bf16 v[108:111], v[76:79], a[236:239], v[108:111]
v_mfma_f32_16x16x32_bf16 v[108:111], v[80:83], a[252:255], v[108:111]
s_waitcnt lgkmcnt(8)
v_cvt_pk_bf16_f32 v18, v100, v101
v_cvt_pk_bf16_f32 v19, v102, v103
v_mfma_f32_16x16x32_bf16 v[112:115], v[84:87], a[208:211], v[112:115]
s_waitcnt lgkmcnt(6)
buffer_store_dwordx4 v[16:19], v10, s[20:23], s44 offen offset:0 sc1
v_mfma_f32_16x16x32_bf16 v[112:115], v[88:91], a[224:227], v[112:115]
s_waitcnt lgkmcnt(4)
ds_read_b64_tr_b16 v[72:73], v50 offset:0
ds_read_b64_tr_b16 v[74:75], v50 offset:14336
v_mfma_f32_16x16x32_bf16 v[112:115], v[60:63], a[240:243], v[112:115]
s_nop 0
ds_read_b64_tr_b16 v[76:77], v51 offset:0
ds_read_b64_tr_b16 v[78:79], v51 offset:14336
v_mfma_f32_16x16x32_bf16 v[116:119], v[84:87], a[212:215], v[116:119]
v_add_u32 v51, -86016, v51
v_cvt_pk_bf16_f32 v20, v104, v105
v_mfma_f32_16x16x32_bf16 v[116:119], v[88:91], a[228:231], v[116:119]
s_nop 0
ds_read_b64_tr_b16 v[80:81], v51 offset:0
ds_read_b64_tr_b16 v[82:83], v51 offset:14336
v_mfma_f32_16x16x32_bf16 v[116:119], v[60:63], a[244:247], v[116:119]
v_add_u32 v51, 57344, v51
v_cvt_pk_bf16_f32 v21, v106, v107
v_mfma_f32_16x16x32_bf16 v[120:123], v[84:87], a[216:219], v[120:123]
v_cvt_pk_bf16_f32 v22, v108, v109
v_cvt_pk_bf16_f32 v23, v110, v111
v_mfma_f32_16x16x32_bf16 v[120:123], v[88:91], a[232:235], v[120:123]
buffer_store_dwordx4 v[20:23], v10, s[20:23], s44 offen offset:1024 sc1
v_mfma_f32_16x16x32_bf16 v[120:123], v[60:63], a[248:251], v[120:123]
v_cvt_pk_bf16_f32 v24, v112, v113
v_cvt_pk_bf16_f32 v25, v114, v115
v_mfma_f32_16x16x32_bf16 v[124:127], v[84:87], a[220:223], v[124:127]
v_cvt_pk_bf16_f32 v26, v116, v117
v_cvt_pk_bf16_f32 v27, v118, v119
v_mfma_f32_16x16x32_bf16 v[124:127], v[88:91], a[236:239], v[124:127]
buffer_store_dwordx4 v[24:27], v10, s[20:23], s44 offen offset:2048 sc1
v_mfma_f32_16x16x32_bf16 v[124:127], v[60:63], a[252:255], v[124:127]
s_waitcnt lgkmcnt(8)
v_cvt_pk_bf16_f32 v28, v120, v121
v_cvt_pk_bf16_f32 v29, v122, v123
v_mfma_f32_16x16x32_bf16 v[128:131], v[64:67], a[208:211], v[128:131]
s_waitcnt lgkmcnt(6)
ds_read_b64_tr_b16 v[84:85], v51 offset:0
ds_read_b64_tr_b16 v[86:87], v51 offset:14336
v_mfma_f32_16x16x32_bf16 v[128:131], v[68:71], a[224:227], v[128:131]
s_waitcnt lgkmcnt(6)
ds_read_b64_tr_b16 v[88:89], v52 offset:0
ds_read_b64_tr_b16 v[90:91], v52 offset:14336
v_mfma_f32_16x16x32_bf16 v[128:131], v[72:75], a[240:243], v[128:131]
v_add_u32 v52, -86016, v52
v_cvt_pk_bf16_f32 v30, v124, v125
v_mfma_f32_16x16x32_bf16 v[132:135], v[64:67], a[212:215], v[132:135]
s_nop 0
ds_read_b64_tr_b16 v[60:61], v52 offset:0
ds_read_b64_tr_b16 v[62:63], v52 offset:14336
v_mfma_f32_16x16x32_bf16 v[132:135], v[68:71], a[228:231], v[132:135]
v_add_u32 v52, 57344, v52
v_cvt_pk_bf16_f32 v31, v126, v127
v_mfma_f32_16x16x32_bf16 v[132:135], v[72:75], a[244:247], v[132:135]
buffer_store_dwordx4 v[28:31], v10, s[20:23], s44 offen offset:3072 sc1
v_mfma_f32_16x16x32_bf16 v[136:139], v[64:67], a[216:219], v[136:139]
s_add_u32 s44, s44, 4096
v_cvt_pk_bf16_f32 v32, v128, v129
v_cvt_pk_bf16_f32 v33, v130, v131
v_mfma_f32_16x16x32_bf16 v[136:139], v[68:71], a[232:235], v[136:139]
v_mfma_f32_16x16x32_bf16 v[136:139], v[72:75], a[248:251], v[136:139]
v_mfma_f32_16x16x32_bf16 v[140:143], v[64:67], a[220:223], v[140:143]
v_mfma_f32_16x16x32_bf16 v[140:143], v[68:71], a[236:239], v[140:143]
v_cvt_pk_bf16_f32 v34, v132, v133
v_cvt_pk_bf16_f32 v35, v134, v135
v_mfma_f32_16x16x32_bf16 v[140:143], v[72:75], a[252:255], v[140:143]
s_waitcnt lgkmcnt(8)
buffer_store_dwordx4 v[32:35], v10, s[20:23], s44 offen offset:0 sc1
v_mfma_f32_16x16x32_bf16 v[144:147], v[76:79], a[208:211], v[144:147]
s_waitcnt lgkmcnt(6)
ds_read_b64_tr_b16 v[64:65], v52 offset:0
ds_read_b64_tr_b16 v[66:67], v52 offset:14336
v_mfma_f32_16x16x32_bf16 v[144:147], v[80:83], a[224:227], v[144:147]
s_waitcnt lgkmcnt(6)
ds_read_b64_tr_b16 v[68:69], v53 offset:0
ds_read_b64_tr_b16 v[70:71], v53 offset:14336
v_mfma_f32_16x16x32_bf16 v[144:147], v[84:87], a[240:243], v[144:147]
v_add_u32 v53, -86016, v53
v_cvt_pk_bf16_f32 v36, v136, v137
v_mfma_f32_16x16x32_bf16 v[148:151], v[76:79], a[212:215], v[148:151]
s_nop 0
ds_read_b64_tr_b16 v[72:73], v53 offset:0
ds_read_b64_tr_b16 v[74:75], v53 offset:14336
v_mfma_f32_16x16x32_bf16 v[148:151], v[80:83], a[228:231], v[148:151]
v_add_u32 v53, 57344, v53
v_cvt_pk_bf16_f32 v37, v138, v139
v_mfma_f32_16x16x32_bf16 v[148:151], v[84:87], a[244:247], v[148:151]
v_cvt_pk_bf16_f32 v38, v140, v141
v_cvt_pk_bf16_f32 v39, v142, v143
v_mfma_f32_16x16x32_bf16 v[152:155], v[76:79], a[216:219], v[152:155]
buffer_store_dwordx4 v[36:39], v10, s[20:23], s44 offen offset:1024 sc1
v_mfma_f32_16x16x32_bf16 v[152:155], v[80:83], a[232:235], v[152:155]
v_cvt_pk_bf16_f32 v40, v144, v145
v_cvt_pk_bf16_f32 v41, v146, v147
v_mfma_f32_16x16x32_bf16 v[152:155], v[84:87], a[248:251], v[152:155]
v_mfma_f32_16x16x32_bf16 v[156:159], v[76:79], a[220:223], v[156:159]
v_cvt_pk_bf16_f32 v42, v148, v149
v_cvt_pk_bf16_f32 v43, v150, v151
v_mfma_f32_16x16x32_bf16 v[156:159], v[80:83], a[236:239], v[156:159]
buffer_store_dwordx4 v[40:43], v10, s[20:23], s44 offen offset:2048 sc1
v_mfma_f32_16x16x32_bf16 v[156:159], v[84:87], a[252:255], v[156:159]
s_waitcnt lgkmcnt(8)
v_mfma_f32_16x16x32_bf16 v[160:163], v[88:91], a[208:211], v[160:163]
s_waitcnt lgkmcnt(6)
ds_read_b64_tr_b16 v[76:77], v53 offset:0
ds_read_b64_tr_b16 v[78:79], v53 offset:14336
v_mfma_f32_16x16x32_bf16 v[160:163], v[60:63], a[224:227], v[160:163]
s_waitcnt lgkmcnt(6)
ds_read_b64_tr_b16 v[80:81], v54 offset:0
ds_read_b64_tr_b16 v[82:83], v54 offset:14336
v_mfma_f32_16x16x32_bf16 v[160:163], v[64:67], a[240:243], v[160:163]
v_add_u32 v54, -86016, v54
v_cvt_pk_bf16_f32 v44, v152, v153
v_mfma_f32_16x16x32_bf16 v[164:167], v[88:91], a[212:215], v[164:167]
s_nop 0
ds_read_b64_tr_b16 v[84:85], v54 offset:0
ds_read_b64_tr_b16 v[86:87], v54 offset:14336
v_mfma_f32_16x16x32_bf16 v[164:167], v[60:63], a[228:231], v[164:167]
v_add_u32 v54, 57344, v54
v_cvt_pk_bf16_f32 v45, v154, v155
v_mfma_f32_16x16x32_bf16 v[164:167], v[64:67], a[244:247], v[164:167]
v_cvt_pk_bf16_f32 v46, v156, v157
v_cvt_pk_bf16_f32 v47, v158, v159
v_mfma_f32_16x16x32_bf16 v[168:171], v[88:91], a[216:219], v[168:171]
buffer_store_dwordx4 v[44:47], v10, s[20:23], s44 offen offset:3072 sc1
v_mfma_f32_16x16x32_bf16 v[168:171], v[60:63], a[232:235], v[168:171]
s_add_u32 s44, s44, 4096
v_cvt_pk_bf16_f32 v16, v160, v161
v_cvt_pk_bf16_f32 v17, v162, v163
v_mfma_f32_16x16x32_bf16 v[168:171], v[64:67], a[248:251], v[168:171]
v_cvt_pk_bf16_f32 v18, v164, v165
v_cvt_pk_bf16_f32 v19, v166, v167
v_mfma_f32_16x16x32_bf16 v[172:175], v[88:91], a[220:223], v[172:175]
buffer_store_dwordx4 v[16:19], v10, s[20:23], s44 offen offset:0 sc1
v_mfma_f32_16x16x32_bf16 v[172:175], v[60:63], a[236:239], v[172:175]
v_mfma_f32_16x16x32_bf16 v[172:175], v[64:67], a[252:255], v[172:175]
s_waitcnt lgkmcnt(8)
v_mfma_f32_16x16x32_bf16 v[176:179], v[68:71], a[208:211], v[176:179]
s_waitcnt lgkmcnt(6)
ds_read_b64_tr_b16 v[88:89], v54 offset:0
ds_read_b64_tr_b16 v[90:91], v54 offset:14336
v_mfma_f32_16x16x32_bf16 v[176:179], v[72:75], a[224:227], v[176:179]
s_waitcnt lgkmcnt(6)
v_cvt_pk_bf16_f32 v20, v168, v169
v_cvt_pk_bf16_f32 v21, v170, v171
v_mfma_f32_16x16x32_bf16 v[176:179], v[76:79], a[240:243], v[176:179]
v_cvt_pk_bf16_f32 v22, v172, v173
v_cvt_pk_bf16_f32 v23, v174, v175
v_mfma_f32_16x16x32_bf16 v[180:183], v[68:71], a[212:215], v[180:183]
buffer_store_dwordx4 v[20:23], v10, s[20:23], s44 offen offset:1024 sc1
v_mfma_f32_16x16x32_bf16 v[180:183], v[72:75], a[228:231], v[180:183]
v_mfma_f32_16x16x32_bf16 v[180:183], v[76:79], a[244:247], v[180:183]
v_mfma_f32_16x16x32_bf16 v[184:187], v[68:71], a[216:219], v[184:187]
v_mfma_f32_16x16x32_bf16 v[184:187], v[72:75], a[232:235], v[184:187]
v_mfma_f32_16x16x32_bf16 v[184:187], v[76:79], a[248:251], v[184:187]
v_cvt_pk_bf16_f32 v24, v176, v177
v_cvt_pk_bf16_f32 v25, v178, v179
v_mfma_f32_16x16x32_bf16 v[188:191], v[68:71], a[220:223], v[188:191]
v_mfma_f32_16x16x32_bf16 v[188:191], v[72:75], a[236:239], v[188:191]
v_mfma_f32_16x16x32_bf16 v[188:191], v[76:79], a[252:255], v[188:191]
s_waitcnt lgkmcnt(4)
v_cvt_pk_bf16_f32 v26, v180, v181
v_cvt_pk_bf16_f32 v27, v182, v183
v_mfma_f32_16x16x32_bf16 v[192:195], v[80:83], a[208:211], v[192:195]
s_waitcnt lgkmcnt(2)
buffer_store_dwordx4 v[24:27], v10, s[20:23], s44 offen offset:2048 sc1
v_mfma_f32_16x16x32_bf16 v[192:195], v[84:87], a[224:227], v[192:195]
s_waitcnt lgkmcnt(0)
v_cvt_pk_bf16_f32 v28, v184, v185
v_cvt_pk_bf16_f32 v29, v186, v187
v_mfma_f32_16x16x32_bf16 v[192:195], v[88:91], a[240:243], v[192:195]
v_cvt_pk_bf16_f32 v30, v188, v189
v_cvt_pk_bf16_f32 v31, v190, v191
v_mfma_f32_16x16x32_bf16 v[196:199], v[80:83], a[212:215], v[196:199]
buffer_store_dwordx4 v[28:31], v10, s[20:23], s44 offen offset:3072 sc1
v_mfma_f32_16x16x32_bf16 v[196:199], v[84:87], a[228:231], v[196:199]
s_add_u32 s44, s44, 4096
v_mfma_f32_16x16x32_bf16 v[196:199], v[88:91], a[244:247], v[196:199]
v_mfma_f32_16x16x32_bf16 v[200:203], v[80:83], a[216:219], v[200:203]
v_mfma_f32_16x16x32_bf16 v[200:203], v[84:87], a[232:235], v[200:203]
v_cvt_pk_bf16_f32 v32, v192, v193
v_cvt_pk_bf16_f32 v33, v194, v195
v_mfma_f32_16x16x32_bf16 v[200:203], v[88:91], a[248:251], v[200:203]
v_mfma_f32_16x16x32_bf16 v[204:207], v[80:83], a[220:223], v[204:207]
v_mfma_f32_16x16x32_bf16 v[204:207], v[84:87], a[236:239], v[204:207]
v_mfma_f32_16x16x32_bf16 v[204:207], v[88:91], a[252:255], v[204:207]
s_nop 0
v_cvt_pk_bf16_f32 v34, v196, v197
v_cvt_pk_bf16_f32 v35, v198, v199
buffer_store_dwordx4 v[32:35], v10, s[20:23], s44 offen offset:0 sc1
s_nop 1
v_cvt_pk_bf16_f32 v36, v200, v201
v_cvt_pk_bf16_f32 v37, v202, v203
s_nop 0
v_cvt_pk_bf16_f32 v38, v204, v205
v_cvt_pk_bf16_f32 v39, v206, v207
buffer_store_dwordx4 v[36:39], v10, s[20:23], s44 offen offset:1024 sc1
s_waitcnt vmcnt(0)
s_mov_b64 exec, 1
buffer_store_dwordx2 v[56:57], off, s[20:23], s40 sc1
buffer_store_dwordx2 v[58:59], off, s[20:23], s40 offset:256 sc1
s_mov_b64 exec, -1
s_cmp_eq_u32 s32, 3
s_cselect_b32 s45, 0, 1024
v_add_u32 v11, s45, v10
buffer_load_dwordx2 v[12:13], v7, s[20:23], s46 offen sc1
L_poll:
buffer_load_dwordx2 v[14:15], v7, s[20:23], s46 offen sc1
s_waitcnt vmcnt(1)
v_cmp_ne_u64 vcc, s[56:57], v[12:13]
s_sub_u32 s41, s41, 1
s_cbranch_vccz L_poll_out
buffer_load_dwordx2 v[12:13], v7, s[20:23], s46 offen sc1
s_waitcnt vmcnt(1)
v_cmp_ne_u64 vcc, s[56:57], v[14:15]
s_cbranch_scc1 L_poll_out
s_cbranch_vccnz L_poll
L_poll_out:
s_add_u32 s44, s38, 0
buffer_load_dwordx4 v[64:67], v10, s[20:23], s44 offen sc1
buffer_load_dwordx4 v[96:99], v11, s[20:23], s44 offen sc1
s_add_u32 s44, s38, 57344
buffer_load_dwordx4 v[68:71], v10, s[20:23], s44 offen sc1
buffer_load_dwordx4 v[100:103], v11, s[20:23], s44 offen sc1
s_add_u32 s44, s38, 114688
buffer_load_dwordx4 v[72:75], v10, s[20:23], s44 offen sc1
buffer_load_dwordx4 v[104:107], v11, s[20:23], s44 offen sc1
s_add_u32 s44, s38, 172032
buffer_load_dwordx4 v[76:79], v10, s[20:23], s44 offen sc1
buffer_load_dwordx4 v[108:111], v11, s[20:23], s44 offen sc1
s_add_u32 s44, s38, 229376
buffer_load_dwordx4 v[80:83], v10, s[20:23], s44 offen sc1
buffer_load_dwordx4 v[112:115], v11, s[20:23], s44 offen sc1
s_add_u32 s44, s38, 286720
buffer_load_dwordx4 v[84:87], v10, s[20:23], s44 offen sc1
buffer_load_dwordx4 v[116:119], v11, s[20:23], s44 offen sc1
s_add_u32 s44, s38, 344064
buffer_load_dwordx4 v[88:91], v10, s[20:23], s44 offen sc1
buffer_load_dwordx4 v[120:123], v11, s[20:23], s44 offen sc1
s_add_u32 s44, s38, 401408
buffer_load_dwordx4 v[92:95], v10, s[20:23], s44 offen sc1
buffer_load_dwordx4 v[124:127], v11, s[20:23], s44 offen sc1
s_waitcnt vmcnt(14)
v_lshlrev_b32 v16, 16, v64
v_and_b32 v17, 0xffff0000, v64
v_lshlrev_b32 v18, 16, v65
v_and_b32 v19, 0xffff0000, v65
v_lshlrev_b32 v20, 16, v66
v_and_b32 v21, 0xffff0000, v66
v_lshlrev_b32 v22, 16, v67
v_and_b32 v23, 0xffff0000, v67
v_lshlrev_b32 v32, 16, v96
v_and_b32 v33, 0xffff0000, v96
v_lshlrev_b32 v34, 16, v97
v_and_b32 v35, 0xffff0000, v97
v_lshlrev_b32 v36, 16, v98
v_and_b32 v37, 0xffff0000, v98
v_lshlrev_b32 v38, 16, v99
v_and_b32 v39, 0xffff0000, v99
s_waitcnt vmcnt(12)
v_lshlrev_b32 v24, 16, v68
v_and_b32 v25, 0xffff0000, v68
v_lshlrev_b32 v26, 16, v69
v_and_b32 v27, 0xffff0000, v69
v_lshlrev_b32 v28, 16, v70
v_and_b32 v29, 0xffff0000, v70
v_lshlrev_b32 v30, 16, v71
v_and_b32 v31, 0xffff0000, v71
v_pk_add_f32 v[16:17], v[16:17], v[24:25]
v_pk_add_f32 v[18:19], v[18:19], v[26:27]
v_pk_add_f32 v[20:21], v[20:21], v[28:29]
v_pk_add_f32 v[22:23], v[22:23], v[30:31]
v_lshlrev_b32 v40, 16, v100
v_and_b32 v41, 0xffff0000, v100
v_lshlrev_b32 v42, 16, v101
v_and_b32 v43, 0xffff0000, v101
v_lshlrev_b32 v44, 16, v102
v_and_b32 v45, 0xffff0000, v102
v_lshlrev_b32 v46, 16, v103
v_and_b32 v47, 0xffff0000, v103
v_pk_add_f32 v[32:33], v[32:33], v[40:41]
v_pk_add_f32 v[34:35], v[34:35], v[42:43]
v_pk_add_f32 v[36:37], v[36:37], v[44:45]
v_pk_add_f32 v[38:39], v[38:39], v[46:47]
s_waitcnt vmcnt(10)
v_lshlrev_b32 v24, 16, v72
v_and_b32 v25, 0xffff0000, v72
v_lshlrev_b32 v26, 16, v73
v_and_b32 v27, 0xffff0000, v73
v_lshlrev_b32 v28, 16, v74
v_and_b32 v29, 0xffff0000, v74
v_lshlrev_b32 v30, 16, v75
v_and_b32 v31, 0xffff0000, v75
v_pk_add_f32 v[16:17], v[16:17], v[24:25]
v_pk_add_f32 v[18:19], v[18:19], v[26:27]
v_pk_add_f32 v[20:21], v[20:21], v[28:29]
v_pk_add_f32 v[22:23], v[22:23], v[30:31]
v_lshlrev_b32 v40, 16, v104
v_and_b32 v41, 0xffff0000, v104
v_lshlrev_b32 v42, 16, v105
v_and_b32 v43, 0xffff0000, v105
v_lshlrev_b32 v44, 16, v106
v_and_b32 v45, 0xffff0000, v106
v_lshlrev_b32 v46, 16, v107
v_and_b32 v47, 0xffff0000, v107
v_pk_add_f32 v[32:33], v[32:33], v[40:41]
v_pk_add_f32 v[34:35], v[34:35], v[42:43]
v_pk_add_f32 v[36:37], v[36:37], v[44:45]
v_pk_add_f32 v[38:39], v[38:39], v[46:47]
s_waitcnt vmcnt(8)
v_lshlrev_b32 v24, 16, v76
v_and_b32 v25, 0xffff0000, v76
v_lshlrev_b32 v26, 16, v77
v_and_b32 v27, 0xffff0000, v77
v_lshlrev_b32 v28, 16, v78
v_and_b32 v29, 0xffff0000, v78
v_lshlrev_b32 v30, 16, v79
v_and_b32 v31, 0xffff0000, v79
v_pk_add_f32 v[16:17], v[16:17], v[24:25]
v_pk_add_f32 v[18:19], v[18:19], v[26:27]
v_pk_add_f32 v[20:21], v[20:21], v[28:29]
v_pk_add_f32 v[22:23], v[22:23], v[30:31]
v_lshlrev_b32 v40, 16, v108
v_and_b32 v41, 0xffff0000, v108
v_lshlrev_b32 v42, 16, v109
v_and_b32 v43, 0xffff0000, v109
v_lshlrev_b32 v44, 16, v110
v_and_b32 v45, 0xffff0000, v110
v_lshlrev_b32 v46, 16, v111
v_and_b32 v47, 0xffff0000, v111
v_pk_add_f32 v[32:33], v[32:33], v[40:41]
v_pk_add_f32 v[34:35], v[34:35], v[42:43]
v_pk_add_f32 v[36:37], v[36:37], v[44:45]
v_pk_add_f32 v[38:39], v[38:39], v[46:47]
s_waitcnt vmcnt(6)
v_lshlrev_b32 v24, 16, v80
v_and_b32 v25, 0xffff0000, v80
v_lshlrev_b32 v26, 16, v81
v_and_b32 v27, 0xffff0000, v81
v_lshlrev_b32 v28, 16, v82
v_and_b32 v29, 0xffff0000, v82
v_lshlrev_b32 v30, 16, v83
v_and_b32 v31, 0xffff0000, v83
v_pk_add_f32 v[16:17], v[16:17], v[24:25]
v_pk_add_f32 v[18:19], v[18:19], v[26:27]
v_pk_add_f32 v[20:21], v[20:21], v[28:29]
v_pk_add_f32 v[22:23], v[22:23], v[30:31]
v_lshlrev_b32 v40, 16, v112
v_and_b32 v41, 0xffff0000, v112
v_lshlrev_b32 v42, 16, v113
v_and_b32 v43, 0xffff0000, v113
v_lshlrev_b32 v44, 16, v114
v_and_b32 v45, 0xffff0000, v114
v_lshlrev_b32 v46, 16, v115
v_and_b32 v47, 0xffff0000, v115
v_pk_add_f32 v[32:33], v[32:33], v[40:41]
v_pk_add_f32 v[34:35], v[34:35], v[42:43]
v_pk_add_f32 v[36:37], v[36:37], v[44:45]
v_pk_add_f32 v[38:39], v[38:39], v[46:47]
s_waitcnt vmcnt(4)
v_lshlrev_b32 v24, 16, v84
v_and_b32 v25, 0xffff0000, v84
v_lshlrev_b32 v26, 16, v85
v_and_b32 v27, 0xffff0000, v85
v_lshlrev_b32 v28, 16, v86
v_and_b32 v29, 0xffff0000, v86
v_lshlrev_b32 v30, 16, v87
v_and_b32 v31, 0xffff0000, v87
v_pk_add_f32 v[16:17], v[16:17], v[24:25]
v_pk_add_f32 v[18:19], v[18:19], v[26:27]
v_pk_add_f32 v[20:21], v[20:21], v[28:29]
v_pk_add_f32 v[22:23], v[22:23], v[30:31]
v_lshlrev_b32 v40, 16, v116
v_and_b32 v41, 0xffff0000, v116
v_lshlrev_b32 v42, 16, v117
v_and_b32 v43, 0xffff0000, v117
v_lshlrev_b32 v44, 16, v118
v_and_b32 v45, 0xffff0000, v118
v_lshlrev_b32 v46, 16, v119
v_and_b32 v47, 0xffff0000, v119
v_pk_add_f32 v[32:33], v[32:33], v[40:41]
v_pk_add_f32 v[34:35], v[34:35], v[42:43]
v_pk_add_f32 v[36:37], v[36:37], v[44:45]
v_pk_add_f32 v[38:39], v[38:39], v[46:47]
s_waitcnt vmcnt(2)
v_lshlrev_b32 v24, 16, v88
v_and_b32 v25, 0xffff0000, v88
v_lshlrev_b32 v26, 16, v89
v_and_b32 v27, 0xffff0000, v89
v_lshlrev_b32 v28, 16, v90
v_and_b32 v29, 0xffff0000, v90
v_lshlrev_b32 v30, 16, v91
v_and_b32 v31, 0xffff0000, v91
v_pk_add_f32 v[16:17], v[16:17], v[24:25]
v_pk_add_f32 v[18:19], v[18:19], v[26:27]
v_pk_add_f32 v[20:21], v[20:21], v[28:29]
v_pk_add_f32 v[22:23], v[22:23], v[30:31]
v_lshlrev_b32 v40, 16, v120
v_and_b32 v41, 0xffff0000, v120
v_lshlrev_b32 v42, 16, v121
v_and_b32 v43, 0xffff0000, v121
v_lshlrev_b32 v44, 16, v122
v_and_b32 v45, 0xffff0000, v122
v_lshlrev_b32 v46, 16, v123
v_and_b32 v47, 0xffff0000, v123
v_pk_add_f32 v[32:33], v[32:33], v[40:41]
v_pk_add_f32 v[34:35], v[34:35], v[42:43]
v_pk_add_f32 v[36:37], v[36:37], v[44:45]
v_pk_add_f32 v[38:39], v[38:39], v[46:47]
s_waitcnt vmcnt(0)
v_lshlrev_b32 v24, 16, v92
v_and_b32 v25, 0xffff0000, v92
v_lshlrev_b32 v26, 16, v93
v_and_b32 v27, 0xffff0000, v93
v_lshlrev_b32 v28, 16, v94
v_and_b32 v29, 0xffff0000, v94
v_lshlrev_b32 v30, 16, v95
v_and_b32 v31, 0xffff0000, v95
v_pk_add_f32 v[16:17], v[16:17], v[24:25]
v_pk_add_f32 v[18:19], v[18:19], v[26:27]
v_pk_add_f32 v[20:21], v[20:21], v[28:29]
v_pk_add_f32 v[22:23], v[22:23], v[30:31]
v_lshlrev_b32 v40, 16, v124
v_and_b32 v41, 0xffff0000, v124
v_lshlrev_b32 v42, 16, v125
v_and_b32 v43, 0xffff0000, v125
v_lshlrev_b32 v44, 16, v126
v_and_b32 v45, 0xffff0000, v126
v_lshlrev_b32 v46, 16, v127
v_and_b32 v47, 0xffff0000, v127
v_pk_add_f32 v[32:33], v[32:33], v[40:41]
v_pk_add_f32 v[34:35], v[34:35], v[42:43]
v_pk_add_f32 v[36:37], v[36:37], v[44:45]
v_pk_add_f32 v[38:39], v[38:39], v[46:47]
v_cvt_pk_bf16_f32 v48, v16, v17
v_cvt_pk_bf16_f32 v49, v18, v19
v_cvt_pk_bf16_f32 v50, v20, v21
v_cvt_pk_bf16_f32 v51, v22, v23
s_add_u32 s44, s37, 0
s_and_b32 s45, s44, 1
s_lshr_b32 s44, s44, 1
s_lshl_b32 s44, s44, 5
s_add_u32 s44, s44, s39
s_lshl_b32 s46, s51, 1
s_add_u32 s46, s46, s45
s_mul_i32 s46, s46, 57344
s_add_u32 s46, s46, s44
buffer_store_dwordx2 v[48:49], v8, s[28:31], s46 offen
s_add_u32 s46, s46, 28672
s_add_u32 s44, s44, 86016
s_cmp_eq_u32 s45, 0
s_cbranch_scc0 L_sh0
buffer_store_dwordx2 v[50:51], v8, s[28:31], s46 offen
s_branch L_st0
L_sh0:
buffer_store_dwordx2 v[50:51], v9, s[28:31], s44 offen
L_st0:
s_cmp_eq_u32 s32, 3
s_cbranch_scc1 L_red2
v_cvt_pk_bf16_f32 v52, v32, v33
v_cvt_pk_bf16_f32 v53, v34, v35
v_cvt_pk_bf16_f32 v54, v36, v37
v_cvt_pk_bf16_f32 v55, v38, v39
s_add_u32 s44, s37, 1
s_and_b32 s45, s44, 1
s_lshr_b32 s44, s44, 1
s_lshl_b32 s44, s44, 5
s_add_u32 s44, s44, s39
s_lshl_b32 s46, s51, 1
s_add_u32 s46, s46, s45
s_mul_i32 s46, s46, 57344
s_add_u32 s46, s46, s44
buffer_store_dwordx2 v[52:53], v8, s[28:31], s46 offen
s_add_u32 s46, s46, 28672
s_add_u32 s44, s44, 86016
s_cmp_eq_u32 s45, 0
s_cbranch_scc0 L_sh1
buffer_store_dwordx2 v[54:55], v8, s[28:31], s46 offen
s_branch L_st1
L_sh1:
buffer_store_dwordx2 v[54:55], v9, s[28:31], s44 offen
L_st1:
L_red2:
s_barrier
s_cmp_eq_u32 s32, 0
s_cbranch_scc0 L_fin
s_lshl_b32 s46, s33, 8
s_add_u32 s46, s46, 65536
v_mov_b32 v4, s56
v_mov_b32 v5, s57
s_mov_b64 exec, 1
buffer_store_dwordx2 v[4:5], off, s[20:23], s46 sc1
s_mov_b64 exec, -1
L_fin:
L_end:
s_endpgm
L_code_end:
L_tr0:
s_call_b64 s[54:55], L_pub
s_branch L_rt0
L_tr1:
s_call_b64 s[54:55], L_raise
s_branch L_rt1
L_tr2:
s_call_b64 s[54:55], L_resc
s_branch L_rt2
L_tr3:
s_call_b64 s[54:55], L_pub
s_branch L_rt3
L_tr4:
s_call_b64 s[54:55], L_raise
s_branch L_rt4
L_tr5:
s_call_b64 s[54:55], L_resc
s_branch L_rt5
L_tr6:
s_call_b64 s[54:55], L_pub
s_branch L_rt6
L_tr7:
s_call_b64 s[54:55], L_raise
s_branch L_rt7
L_tr8:
s_call_b64 s[54:55], L_resc
s_branch L_rt8
L_tr9:
s_call_b64 s[54:55], L_pub
s_branch L_rt9
L_tr10:
s_call_b64 s[54:55], L_raise
s_branch L_rt10
L_tr11:
s_call_b64 s[54:55], L_resc
s_branch L_rt11
L_tr12:
s_call_b64 s[54:55], L_pub
s_branch L_rt12
L_tr13:
s_call_b64 s[54:55], L_raise
s_branch L_rt13
L_tr14:
s_call_b64 s[54:55], L_resc
s_branch L_rt14
L_pub:
v_max3_f32 v15, v60, v61, v62
v_max_f32 v15, v15, v63
v_sub_f32 v15, v15, v32
ds_max_f32 v12, v15 offset:0
v_max3_f32 v15, v64, v65, v66
v_max_f32 v15, v15, v67
v_sub_f32 v15, v15, v36
ds_max_f32 v12, v15 offset:4
v_max3_f32 v15, v68, v69, v70
v_max_f32 v15, v15, v71
v_sub_f32 v15, v15, v40
ds_max_f32 v12, v15 offset:8
v_max3_f32 v15, v72, v73, v74
v_max_f32 v15, v15, v75
v_sub_f32 v15, v15, v44
ds_max_f32 v12, v15 offset:12
v_max3_f32 v15, v76, v77, v78
v_max_f32 v15, v15, v79
v_sub_f32 v15, v15, v48
ds_max_f32 v12, v15 offset:16
v_max3_f32 v15, v80, v81, v82
v_max_f32 v15, v15, v83
v_sub_f32 v15, v15, v52
ds_max_f32 v12, v15 offset:20
v_max3_f32 v15, v84, v85, v86
v_max_f32 v15, v15, v87
v_sub_f32 v15, v15, v56
ds_max_f32 v12, v15 offset:24
v_mov_b32 v15, s39
ds_write_b32 v14, v15
s_setpc_b64 s[54:55]
L_raise:
ds_read_b128 v[16:19], v12
ds_read_b128 v[20:23], v12 offset:16
s_waitcnt lgkmcnt(0)
s_barrier
v_add_f32 v16, v16, v32
v_max_f32 v16, 0, v16
v_sub_f32 v60, v60, v16
v_sub_f32 v32, v32, v16
v_sub_f32 v61, v61, v16
v_sub_f32 v33, v33, v16
v_sub_f32 v62, v62, v16
v_sub_f32 v34, v34, v16
v_sub_f32 v63, v63, v16
v_sub_f32 v35, v35, v16
v_exp_f32 v16, -v16
s_nop 0
v_mul_f32 v24, v24, v16
v_add_f32 v17, v17, v36
v_max_f32 v17, 0, v17
v_sub_f32 v64, v64, v17
v_sub_f32 v36, v36, v17
v_sub_f32 v65, v65, v17
v_sub_f32 v37, v37, v17
v_sub_f32 v66, v66, v17
v_sub_f32 v38, v38, v17
v_sub_f32 v67, v67, v17
v_sub_f32 v39, v39, v17
v_exp_f32 v17, -v17
s_nop 0
v_mul_f32 v25, v25, v17
v_add_f32 v18, v18, v40
v_max_f32 v18, 0, v18
v_sub_f32 v68, v68, v18
v_sub_f32 v40, v40, v18
v_sub_f32 v69, v69, v18
v_sub_f32 v41, v41, v18
v_sub_f32 v70, v70, v18
v_sub_f32 v42, v42, v18
v_sub_f32 v71, v71, v18
v_sub_f32 v43, v43, v18
v_exp_f32 v18, -v18
s_nop 0
v_mul_f32 v26, v26, v18
v_add_f32 v19, v19, v44
v_max_f32 v19, 0, v19
v_sub_f32 v72, v72, v19
v_sub_f32 v44, v44, v19
v_sub_f32 v73, v73, v19
v_sub_f32 v45, v45, v19
v_sub_f32 v74, v74, v19
v_sub_f32 v46, v46, v19
v_sub_f32 v75, v75, v19
v_sub_f32 v47, v47, v19
v_exp_f32 v19, -v19
s_nop 0
v_mul_f32 v27, v27, v19
v_add_f32 v20, v20, v48
v_max_f32 v20, 0, v20
v_sub_f32 v76, v76, v20
v_sub_f32 v48, v48, v20
v_sub_f32 v77, v77, v20
v_sub_f32 v49, v49, v20
v_sub_f32 v78, v78, v20
v_sub_f32 v50, v50, v20
v_sub_f32 v79, v79, v20
v_sub_f32 v51, v51, v20
v_exp_f32 v20, -v20
s_nop 0
v_mul_f32 v28, v28, v20
v_add_f32 v21, v21, v52
v_max_f32 v21, 0, v21
v_sub_f32 v80, v80, v21
v_sub_f32 v52, v52, v21
v_sub_f32 v81, v81, v21
v_sub_f32 v53, v53, v21
v_sub_f32 v82, v82, v21
v_sub_f32 v54, v54, v21
v_sub_f32 v83, v83, v21
v_sub_f32 v55, v55, v21
v_exp_f32 v21, -v21
s_nop 0
v_mul_f32 v29, v29, v21
v_add_f32 v22, v22, v56
v_max_f32 v22, 0, v22
v_sub_f32 v84, v84, v22
v_sub_f32 v56, v56, v22
v_sub_f32 v85, v85, v22
v_sub_f32 v57, v57, v22
v_sub_f32 v86, v86, v22
v_sub_f32 v58, v58, v22
v_sub_f32 v87, v87, v22
v_sub_f32 v59, v59, v22
v_exp_f32 v22, -v22
s_nop 0
v_mul_f32 v30, v30, v22
s_mov_b32 s42, 1
s_nop 1
s_setpc_b64 s[54:55]
L_resc:
s_nop 7
s_nop 7
v_mul_f32 v144, v144, v16
v_mul_f32 v145, v145, v16
v_mul_f32 v146, v146, v16
v_mul_f32 v147, v147, v16
v_mul_f32 v148, v148, v16
v_mul_f32 v149, v149, v16
v_mul_f32 v150, v150, v16
v_mul_f32 v151, v151, v16
v_mul_f32 v152, v152, v16
v_mul_f32 v153, v153, v16
v_mul_f32 v154, v154, v16
v_mul_f32 v155, v155, v16
v_mul_f32 v156, v156, v16
v_mul_f32 v157, v157, v16
v_mul_f32 v158, v158, v16
v_mul_f32 v159, v159, v16
v_mul_f32 v160, v160, v17
v_mul_f32 v161, v161, v17
v_mul_f32 v162, v162, v17
v_mul_f32 v163, v163, v17
v_mul_f32 v164, v164, v17
v_mul_f32 v165, v165, v17
v_mul_f32 v166, v166, v17
v_mul_f32 v167, v167, v17
v_mul_f32 v168, v168, v17
v_mul_f32 v169, v169, v17
v_mul_f32 v170, v170, v17
v_mul_f32 v171, v171, v17
v_mul_f32 v172, v172, v17
v_mul_f32 v173, v173, v17
v_mul_f32 v174, v174, v17
v_mul_f32 v175, v175, v17
v_mul_f32 v176, v176, v18
v_mul_f32 v177, v177, v18
v_mul_f32 v178, v178, v18
v_mul_f32 v179, v179, v18
v_mul_f32 v180, v180, v18
v_mul_f32 v181, v181, v18
v_mul_f32 v182, v182, v18
v_mul_f32 v183, v183, v18
v_mul_f32 v184, v184, v18
v_mul_f32 v185, v185, v18
v_mul_f32 v186, v186, v18
v_mul_f32 v187, v187, v18
v_mul_f32 v188, v188, v18
v_mul_f32 v189, v189, v18
v_mul_f32 v190, v190, v18
v_mul_f32 v191, v191, v18
v_mul_f32 v192, v192, v19
v_mul_f32 v193, v193, v19
v_mul_f32 v194, v194, v19
v_mul_f32 v195, v195, v19
v_mul_f32 v196, v196, v19
v_mul_f32 v197, v197, v19
v_mul_f32 v198, v198, v19
v_mul_f32 v199, v199, v19
v_mul_f32 v200, v200, v19
v_mul_f32 v201, v201, v19
v_mul_f32 v202, v202, v19
v_mul_f32 v203, v203, v19
v_mul_f32 v204, v204, v19
v_mul_f32 v205, v205, v19
v_mul_f32 v206, v206, v19
v_mul_f32 v207, v207, v19
v_mul_f32 v208, v208, v20
v_mul_f32 v209, v209, v20
v_mul_f32 v210, v210, v20
v_mul_f32 v211, v211, v20
v_mul_f32 v212, v212, v20
v_mul_f32 v213, v213, v20
v_mul_f32 v214, v214, v20
v_mul_f32 v215, v215, v20
v_mul_f32 v216, v216, v20
v_mul_f32 v217, v217, v20
v_mul_f32 v218, v218, v20
v_mul_f32 v219, v219, v20
v_mul_f32 v220, v220, v20
v_mul_f32 v221, v221, v20
v_mul_f32 v222, v222, v20
v_mul_f32 v223, v223, v20
v_mul_f32 v224, v224, v21
v_mul_f32 v225, v225, v21
v_mul_f32 v226, v226, v21
v_mul_f32 v227, v227, v21
v_mul_f32 v228, v228, v21
v_mul_f32 v229, v229, v21
v_mul_f32 v230, v230, v21
v_mul_f32 v231, v231, v21
v_mul_f32 v232, v232, v21
v_mul_f32 v233, v233, v21
v_mul_f32 v234, v234, v21
v_mul_f32 v235, v235, v21
v_mul_f32 v236, v236, v21
v_mul_f32 v237, v237, v21
v_mul_f32 v238, v238, v21
v_mul_f32 v239, v239, v21
v_mul_f32 v240, v240, v22
v_mul_f32 v241, v241, v22
v_mul_f32 v242, v242, v22
v_mul_f32 v243, v243, v22
v_mul_f32 v244, v244, v22
v_mul_f32 v245, v245, v22
v_mul_f32 v246, v246, v22
v_mul_f32 v247, v247, v22
v_mul_f32 v248, v248, v22
v_mul_f32 v249, v249, v22
v_mul_f32 v250, v250, v22
v_mul_f32 v251, v251, v22
v_mul_f32 v252, v252, v22
v_mul_f32 v253, v253, v22
v_mul_f32 v254, v254, v22
v_mul_f32 v255, v255, v22
s_mov_b32 s42, 0
s_nop 1
s_setpc_b64 s[54:55]
.section .rodata,"a"
.p2align 6
.amdhsa_kernel concat_heads__gqa_block_cached__gqa_block_cached__near_ridge_kernel
  .amdhsa_next_free_vgpr 512
  .amdhsa_next_free_sgpr 102
  .amdhsa_accum_offset 256
  .amdhsa_group_segment_fixed_size 0
  .amdhsa_kernarg_size 104
  .amdhsa_user_sgpr_count 2
  .amdhsa_user_sgpr_kernarg_segment_ptr 1
  .amdhsa_system_sgpr_workgroup_id_x 1
.end_amdhsa_kernel
```
